```python
import torch

def _softmax(x, axis=-1):
    return torch.softmax(x, dim=axis)
def _gelu(x):
    return torch.nn.functional.gelu(x, approximate="tanh")
def _silu(x):
    return torch.nn.functional.silu(x)
def _sigmoid(x):
    return torch.sigmoid(x)
def _layernorm(x, axis=-1, eps=1e-5):
    m = x.mean(dim=axis, keepdim=True)
    v = x.var(dim=axis, keepdim=True, unbiased=False)
    return (x - m) / torch.sqrt(v + eps)
def _scatter_add(tgt, idx, src, axis=0):
    return tgt.clone().index_add_(axis, idx, src)
def _segment_sum(src, seg, n):
    out = torch.zeros((n,) + src.shape[1:], dtype=src.dtype)
    return out.index_add_(0, seg, src)
def _pad(x, pw):
    flat = tuple(v for pair in reversed(pw) for v in pair)
    return torch.nn.functional.pad(x, flat)

kernel_name = 'standalone__kv_cache_quant_int4_int2_kv_with_per_channel_or_per_token_scales__prompt'

def setup_inputs():

    _w = (lambda a: (lambda t: t.to(torch.bfloat16) if t.is_floating_point() else t)(torch.as_tensor(a)))
    B = 1
    Sq = 2048
    Skv = 2048
    Hq = 32
    Hkv = 32
    Dh = 128
    bits = 3
    G = 128
    if G <= 0 or G >= Skv:
        G = max(1, Skv // 2)
    Skv = (Skv // G) * G
    ngk = Skv // G
    qmax = (1 << bits) - 1
    return {
        "q": _w((lambda *s: torch.randn(*s, dtype=torch.bfloat16) * 1.6)(B, Hq, Sq, Dh)),
        "qk": _w(torch.randint(0, qmax + 1, (B, Hkv, Skv, Dh)).to(torch.int32)),
        "qv": _w(torch.randint(0, qmax + 1, (B, Hkv, Skv, Dh)).to(torch.int32)),
        "k_scales": _w(torch.abs((lambda *s: torch.randn(*s, dtype=torch.bfloat16) * 1.6)(B, Hkv, ngk, Dh)) * 0.05 + 0.02),
        "k_zeros": _w((lambda *s: torch.randn(*s, dtype=torch.bfloat16) * 1.6)(B, Hkv, ngk, Dh) + float(qmax) / 2.0),
        "v_scales": _w(torch.abs((lambda *s: torch.randn(*s, dtype=torch.bfloat16) * 0.05)(B, Hkv, Skv, 1)) * 0.05 + 0.02),
        "v_zeros": _w((lambda *s: torch.randn(*s, dtype=torch.bfloat16) * 0.05)(B, Hkv, Skv, 1) + float(qmax) / 2.0),
    }

def reference(q, qk, qv, k_scales, k_zeros, v_scales, v_zeros):
    B, Hq, Sq, Dh = q.shape
    Hkv, Skv = qk.shape[1], qk.shape[2]
    ngk = k_scales.shape[2]
    G = Skv // ngk
    ks = (lambda x, n, axis: torch.repeat_interleave(x, n, dim=axis))(k_scales, G, axis=2)
    kz = (lambda x, n, axis: torch.repeat_interleave(x, n, dim=axis))(k_zeros, G, axis=2)
    k = ((lambda x, dt: x.to(dt))(qk, q.dtype) - kz) * ks
    v = ((lambda x, dt: x.to(dt))(qv, q.dtype) - v_zeros) * v_scales
    rep = Hq // Hkv
    if rep > 1:
        k = (lambda x, n, axis: torch.repeat_interleave(x, n, dim=axis))(k, rep, axis=1)
        v = (lambda x, n, axis: torch.repeat_interleave(x, n, dim=axis))(v, rep, axis=1)
    scale = float(Dh) ** -0.5
    logits = torch.einsum("bhqd,bhkd->bhqk", q, k) * scale
    p = _softmax(logits, axis=-1)
    o = torch.einsum("bhqk,bhkd->bhqd", p, v)
    return o
```

```asm
; @launch grid=(256,1,1) block=(256,1,1) lds=137216
.amdgcn_target "amdgcn-amd-amdhsa--gfx950"
.text
.globl standalone__kv_cache_quant_int4_int2_kv_with_per_channel_or_per_token_scales__prompt_kernel
.p2align 8
.type standalone__kv_cache_quant_int4_int2_kv_with_per_channel_or_per_token_scales__prompt_kernel,@function
standalone__kv_cache_quant_int4_int2_kv_with_per_channel_or_per_token_scales__prompt_kernel:
    s_cmp_ge_u32 s2, 0x100
    s_cbranch_scc1 at_done
    s_load_dwordx4 s[72:75], s[0:1], 8
    s_load_dwordx4 s[76:79], s[0:1], 24
    s_load_dwordx4 s[80:83], s[0:1], 40
    s_load_dwordx2 s[4:5], s[0:1], 0
    s_load_dwordx2 s[6:7], s[0:1], 56
    s_load_dwordx2 s[10:11], s[0:1], 64
    s_load_dwordx2 s[8:9], s[0:1], 72
    s_memrealtime s[92:93]
    v_lshrrev_b32_e32 v28, 6, v0
    v_and_b32_e32 v27, 63, v0
    v_readfirstlane_b32 s54, v28
    s_and_b32 s67, s2, 7
    s_lshl_b32 s67, s67, 2
    s_lshr_b32 s68, s2, 6
    s_add_u32 s52, s67, s68
    s_lshr_b32 s53, s2, 3
    s_and_b32 s53, s53, 7
    v_lshlrev_b32_e32 v2, 4, v27
    s_lshl_b32 s60, s53, 15
    s_lshl_b32 s89, s53, 10
    s_lshr_b32 s61, s53, 1
    s_lshl_b32 s61, s61, 8
    s_lshl_b32 s62, s53, 7
    s_lshl_b32 s87, s53, 3
    s_lshr_b32 s90, s54, 1
    s_and_b32 s91, s54, 1
    v_and_b32_e32 v28, 7, v27
    v_lshrrev_b32_e32 v29, 3, v27
    s_lshl_b32 s67, s90, 14
    s_lshl_b32 s68, s91, 8
    s_add_u32 s67, s67, s68
    v_lshlrev_b32_e32 v5, 9, v28
    v_lshl_add_u32 v5, v29, 5, v5
    v_add_u32_e32 v5, s67, v5
    s_lshl_b32 s95, s91, 7
    s_lshl_b32 s67, s90, 14
    s_lshl_b32 s68, s91, 11
    s_add_u32 s67, s67, s68
    v_lshrrev_b32_e32 v6, 2, v29
    v_lshlrev_b32_e32 v6, 10, v6
    v_and_b32_e32 v29, 3, v29
    v_lshl_add_u32 v6, v29, 8, v6
    v_lshl_add_u32 v6, v28, 4, v6
    v_add_u32_e32 v6, s67, v6
    v_and_b32_e32 v28, 15, v27
    v_lshrrev_b32_e32 v29, 4, v27
    s_lshl_b32 s67, s90, 14
    s_lshl_b32 s68, s91, 4
    s_add_u32 s67, s67, s68
    v_lshlrev_b32_e32 v8, 11, v29
    v_lshl_add_u32 v8, v28, 5, v8
    v_add_u32_e32 v8, s67, v8
    v_lshlrev_b32_e32 v10, 1, v27
    s_waitcnt lgkmcnt(0)
    s_lshl_b32 s63, s52, 20
    s_add_u32 s24, s72, s63
    s_addc_u32 s25, s73, 0
    s_and_b32 s25, s25, 0xffff
    s_mov_b32 s26, 0x100000
    s_mov_b32 s27, 0x20000
    s_lshl_b32 s67, s52, 12
    s_add_u32 s32, s76, s67
    s_addc_u32 s33, s77, 0
    s_and_b32 s33, s33, 0xffff
    s_mov_b32 s34, 0x1000
    s_mov_b32 s35, 0x20000
    s_add_u32 s36, s78, s67
    s_addc_u32 s37, s79, 0
    s_and_b32 s37, s37, 0xffff
    s_mov_b32 s38, 0x1000
    s_mov_b32 s39, 0x20000
    v_lshrrev_b32_e32 v228, 3, v2
    v_and_b32_e32 v228, 0x70, v228
    v_add_u32_e32 v228, s95, v228
    buffer_load_dwordx4 v[224:227], v228, s[32:35], s61 offen
    buffer_load_dwordx4 v[228:231], v228, s[36:39], s61 offen
    buffer_load_dwordx4 v[160:163], v5, s[24:27], s60 offen nt
    buffer_load_dwordx4 v[164:167], v5, s[24:27], s60 offen offset:16 nt
    s_add_u32 s67, s60, 0x1000
    buffer_load_dwordx4 v[168:171], v5, s[24:27], s67 offen nt
    buffer_load_dwordx4 v[172:175], v5, s[24:27], s67 offen offset:16 nt
    s_add_u32 s67, s60, 0x2000
    buffer_load_dwordx4 v[176:179], v5, s[24:27], s67 offen nt
    buffer_load_dwordx4 v[180:183], v5, s[24:27], s67 offen offset:16 nt
    s_add_u32 s67, s60, 0x3000
    buffer_load_dwordx4 v[184:187], v5, s[24:27], s67 offen nt
    buffer_load_dwordx4 v[188:191], v5, s[24:27], s67 offen offset:16 nt
    s_add_u32 s28, s74, s63
    s_addc_u32 s29, s75, 0
    s_and_b32 s29, s29, 0xffff
    s_mov_b32 s30, 0x100000
    s_mov_b32 s31, 0x20000
    s_lshl_b32 s67, s52, 12
    s_add_u32 s40, s80, s67
    s_addc_u32 s41, s81, 0
    s_and_b32 s41, s41, 0xffff
    s_mov_b32 s42, 0x1000
    s_mov_b32 s43, 0x20000
    s_add_u32 s44, s82, s67
    s_addc_u32 s45, s83, 0
    s_and_b32 s45, s45, 0xffff
    s_mov_b32 s46, 0x1000
    s_mov_b32 s47, 0x20000
    buffer_load_ushort v232, v10, s[40:43], s62 offen
    buffer_load_ushort v236, v10, s[44:47], s62 offen
    buffer_load_dwordx4 v[192:195], v8, s[28:31], s60 offen nt
    buffer_load_dwordx4 v[196:199], v8, s[28:31], s60 offen offset:512 nt
    buffer_load_dwordx4 v[200:203], v8, s[28:31], s60 offen offset:1024 nt
    buffer_load_dwordx4 v[204:207], v8, s[28:31], s60 offen offset:1536 nt
    s_add_u32 s67, s60, 0x2000
    buffer_load_dwordx4 v[208:211], v8, s[28:31], s67 offen nt
    buffer_load_dwordx4 v[212:215], v8, s[28:31], s67 offen offset:512 nt
    buffer_load_dwordx4 v[216:219], v8, s[28:31], s67 offen offset:1024 nt
    buffer_load_dwordx4 v[220:223], v8, s[28:31], s67 offen offset:1536 nt
    s_add_u32 s20, s8, s63
    s_addc_u32 s21, s9, 0
    s_and_b32 s21, s21, 0xffff
    s_mov_b32 s22, 0x100000
    s_mov_b32 s23, 0x20000
    s_lshl_b32 s67, s52, 19
    s_add_u32 s12, s4, s67
    s_addc_u32 s13, s5, 0
    s_and_b32 s13, s13, 0xffff
    s_mov_b32 s14, 0x80000
    s_mov_b32 s15, 0x20000
    s_add_u32 s16, s6, s67
    s_addc_u32 s17, s7, 0
    s_and_b32 s17, s17, 0xffff
    s_mov_b32 s18, 0x80000
    s_mov_b32 s19, 0x20000
    s_lshl_b32 s67, s52, 8
    s_add_u32 s67, s67, 0x4000000
    s_add_u32 s48, s8, s67
    s_addc_u32 s49, s9, 0
    s_and_b32 s49, s49, 0xffff
    s_mov_b32 s50, 0x100
    s_mov_b32 s51, 0x20000
    s_lshl_b32 s67, s52, 15
    s_add_u32 s67, s67, 0x3000000
    s_add_u32 s80, s8, s67
    s_addc_u32 s81, s9, 0
    s_and_b32 s81, s81, 0xffff
    s_mov_b32 s82, 0x8000
    s_mov_b32 s83, 0x20000
    s_lshl_b32 s67, s52, 3
    s_add_u32 s96, s10, s67
    s_addc_u32 s97, s11, 0
    s_and_b32 s97, s97, 0xffff
    s_mov_b32 s98, 8
    s_mov_b32 s99, 0x20000
    s_cmp_eq_u32 s54, 0
    s_cselect_b32 s68, 0, 0x20000
    v_cmp_eq_u32_e32 vcc, 0, v27
    v_mov_b32_e32 v0, 0x20000
    v_mov_b32_e32 v30, s68
    v_cndmask_b32_e32 v0, v0, v30, vcc
    v_mov_b32_e32 v20, s92
    v_mov_b32_e32 v21, s93
    v_mov_b32_e32 v22, 0
    v_mov_b32_e32 v23, 0
    buffer_atomic_cmpswap_x2 v[20:23], v0, s[96:99], 0 offen sc0 sc1
    s_lshl_b32 s67, s53, 16
    s_lshl_b32 s68, s54, 14
    s_add_u32 s86, s67, s68
    v_lshlrev_b32_e32 v25, 8, v28
    v_lshl_add_u32 v25, v29, 4, v25
    s_add_u32 s67, s86, 0
    buffer_load_dwordx4 a[144:147], v25, s[12:15], s67 offen nt
    buffer_load_dwordx4 a[148:151], v25, s[12:15], s67 offen offset:64 nt
    buffer_load_dwordx4 a[152:155], v25, s[12:15], s67 offen offset:128 nt
    buffer_load_dwordx4 a[156:159], v25, s[12:15], s67 offen offset:192 nt
    s_lshl_b32 s67, s90, 14
    s_lshl_b32 s68, s91, 12
    s_add_u32 s67, s67, s68
    s_add_u32 s67, s67, 0x2000
    v_add_u32_e32 v9, s67, v2
    s_add_u32 s67, s53, 0
    s_and_b32 s67, s67, 7
    s_lshl_b32 s70, s67, 15
    s_add_u32 s67, s53, 1
    s_and_b32 s67, s67, 7
    s_lshl_b32 s71, s67, 15
    s_add_u32 s67, s53, 2
    s_and_b32 s67, s67, 7
    s_lshl_b32 s72, s67, 15
    s_add_u32 s67, s53, 3
    s_and_b32 s67, s67, 7
    s_lshl_b32 s73, s67, 15
    s_add_u32 s67, s53, 4
    s_and_b32 s67, s67, 7
    s_lshl_b32 s74, s67, 15
    s_add_u32 s67, s53, 5
    s_and_b32 s67, s67, 7
    s_lshl_b32 s75, s67, 15
    s_add_u32 s67, s53, 6
    s_and_b32 s67, s67, 7
    s_lshl_b32 s76, s67, 15
    s_add_u32 s67, s53, 7
    s_and_b32 s67, s67, 7
    s_lshl_b32 s77, s67, 15
    v_lshlrev_b32_e32 v1, 4, v29
    v_add_u32_e32 v1, 0x20800, v1
    v_mul_u32_u24_e32 v14, 0x48, v28
    v_add_u32_e32 v14, 0x20000, v14
    v_mov_b32_e32 v31, 0x20c18
    v_cmp_gt_u32_e32 vcc, 3, v28
    s_lshl_b32 s67, s54, 8
    v_lshlrev_b32_e32 v15, 2, v27
    v_cndmask_b32_e32 v14, v31, v14, vcc
    v_lshl_add_u32 v14, v29, 3, v14
    v_add_u32_e32 v15, s67, v15
    s_add_u32 s10, s67, 0x20000
    s_mov_b32 s84, 0x100
    s_cmp_lt_u32 s54, 2
    s_cselect_b32 s84, 0x200, s84
    s_cselect_b32 s10, s10, 0x20800
    s_cmp_eq_u32 s54, 3
    s_cselect_b32 s84, 0, s84
    s_cselect_b32 s10, 0x21600, s10
    s_mul_i32 s85, s84, 3
    s_add_u32 s85, s85, s10
    v_lshlrev_b32_e32 v11, 2, v27
    v_add_u32_e32 v26, 0x20800, v11
    v_add_u32_e32 v11, 0x200, v11
    v_lshrrev_b32_e32 v7, 5, v27
    v_lshlrev_b32_e32 v7, 8, v7
    v_and_b32_e32 v30, 31, v27
    v_lshl_add_u32 v7, v30, 1, v7
    v_add_u32_e32 v33, 0x20000, v7
    s_cmp_eq_u32 s54, 0
    s_cselect_b32 s67, 0, 1
    v_mov_b32_e32 v31, 0x20000
    v_mov_b32_e32 v32, 0x21600
    v_mov_b32_e32 v30, s67
    v_cmp_eq_u32_e32 vcc, 0, v30
    v_and_b32_e32 v34, 1, v27
    v_or_b32_e32 v34, v30, v34
    v_cndmask_b32_e32 v11, v31, v11, vcc
    v_cndmask_b32_e32 v26, v32, v26, vcc
    v_cmp_eq_u32_e32 vcc, 0, v34
    s_nop 1
    v_cndmask_b32_e32 v7, v31, v7, vcc
    v_cndmask_b32_e32 v33, v32, v33, vcc
    v_mov_b32_e32 v36, 0
    v_mov_b32_e32 v37, 0
    v_mov_b32_e32 v38, 0
    v_mov_b32_e32 v39, 0
    s_mul_i32 s67, s54, 0x280
    s_add_u32 s67, s67, 0x20c00
    v_add_u32_e32 v35, s67, v2
    v_cmp_gt_u32_e32 vcc, 40, v27
    s_nop 1
    v_cndmask_b32_e32 v35, v32, v35, vcc
    ds_write_b128 v35, v[36:39]
    s_mov_b32 s69, 0x3e0293ee
    s_mov_b32 s58, 0
    s_mov_b32 s59, 0x40000
    s_mov_b32 s65, 0
    s_mov_b32 s66, 8
    s_lshl_b32 s88, s54, 12
    v_add_u32_e32 v4, s88, v2
    v_accvgpr_write_b32 a0, 0
    v_accvgpr_write_b32 a1, 0
    v_accvgpr_write_b32 a2, 0
    v_accvgpr_write_b32 a3, 0
    v_accvgpr_write_b32 a4, 0
    v_accvgpr_write_b32 a5, 0
    v_accvgpr_write_b32 a6, 0
    v_accvgpr_write_b32 a7, 0
    v_accvgpr_write_b32 a8, 0
    v_accvgpr_write_b32 a9, 0
    v_accvgpr_write_b32 a10, 0
    v_accvgpr_write_b32 a11, 0
    v_accvgpr_write_b32 a12, 0
    v_accvgpr_write_b32 a13, 0
    v_accvgpr_write_b32 a14, 0
    v_accvgpr_write_b32 a15, 0
    v_accvgpr_write_b32 a16, 0
    v_accvgpr_write_b32 a17, 0
    v_accvgpr_write_b32 a18, 0
    v_accvgpr_write_b32 a19, 0
    v_accvgpr_write_b32 a20, 0
    v_accvgpr_write_b32 a21, 0
    v_accvgpr_write_b32 a22, 0
    v_accvgpr_write_b32 a23, 0
    v_accvgpr_write_b32 a24, 0
    v_accvgpr_write_b32 a25, 0
    v_accvgpr_write_b32 a26, 0
    v_accvgpr_write_b32 a27, 0
    v_accvgpr_write_b32 a28, 0
    v_accvgpr_write_b32 a29, 0
    v_accvgpr_write_b32 a30, 0
    v_accvgpr_write_b32 a31, 0
    v_accvgpr_write_b32 a32, 0
    v_accvgpr_write_b32 a33, 0
    v_accvgpr_write_b32 a34, 0
    v_accvgpr_write_b32 a35, 0
    v_accvgpr_write_b32 a36, 0
    v_accvgpr_write_b32 a37, 0
    v_accvgpr_write_b32 a38, 0
    v_accvgpr_write_b32 a39, 0
    v_accvgpr_write_b32 a40, 0
    v_accvgpr_write_b32 a41, 0
    v_accvgpr_write_b32 a42, 0
    v_accvgpr_write_b32 a43, 0
    v_accvgpr_write_b32 a44, 0
    v_accvgpr_write_b32 a45, 0
    v_accvgpr_write_b32 a46, 0
    v_accvgpr_write_b32 a47, 0
    v_accvgpr_write_b32 a48, 0
    v_accvgpr_write_b32 a49, 0
    v_accvgpr_write_b32 a50, 0
    v_accvgpr_write_b32 a51, 0
    v_accvgpr_write_b32 a52, 0
    v_accvgpr_write_b32 a53, 0
    v_accvgpr_write_b32 a54, 0
    v_accvgpr_write_b32 a55, 0
    v_accvgpr_write_b32 a56, 0
    v_accvgpr_write_b32 a57, 0
    v_accvgpr_write_b32 a58, 0
    v_accvgpr_write_b32 a59, 0
    v_accvgpr_write_b32 a60, 0
    v_accvgpr_write_b32 a61, 0
    v_accvgpr_write_b32 a62, 0
    v_accvgpr_write_b32 a63, 0
    v_accvgpr_write_b32 a64, 0
    v_accvgpr_write_b32 a65, 0
    v_accvgpr_write_b32 a66, 0
    v_accvgpr_write_b32 a67, 0
    v_accvgpr_write_b32 a68, 0
    v_accvgpr_write_b32 a69, 0
    v_accvgpr_write_b32 a70, 0
    v_accvgpr_write_b32 a71, 0
    v_accvgpr_write_b32 a72, 0
    v_accvgpr_write_b32 a73, 0
    v_accvgpr_write_b32 a74, 0
    v_accvgpr_write_b32 a75, 0
    v_accvgpr_write_b32 a76, 0
    v_accvgpr_write_b32 a77, 0
    v_accvgpr_write_b32 a78, 0
    v_accvgpr_write_b32 a79, 0
    v_accvgpr_write_b32 a80, 0
    v_accvgpr_write_b32 a81, 0
    v_accvgpr_write_b32 a82, 0
    v_accvgpr_write_b32 a83, 0
    v_accvgpr_write_b32 a84, 0
    v_accvgpr_write_b32 a85, 0
    v_accvgpr_write_b32 a86, 0
    v_accvgpr_write_b32 a87, 0
    v_accvgpr_write_b32 a88, 0
    v_accvgpr_write_b32 a89, 0
    v_accvgpr_write_b32 a90, 0
    v_accvgpr_write_b32 a91, 0
    v_accvgpr_write_b32 a92, 0
    v_accvgpr_write_b32 a93, 0
    v_accvgpr_write_b32 a94, 0
    v_accvgpr_write_b32 a95, 0
    v_accvgpr_write_b32 a96, 0
    v_accvgpr_write_b32 a97, 0
    v_accvgpr_write_b32 a98, 0
    v_accvgpr_write_b32 a99, 0
    v_accvgpr_write_b32 a100, 0
    v_accvgpr_write_b32 a101, 0
    v_accvgpr_write_b32 a102, 0
    v_accvgpr_write_b32 a103, 0
    v_accvgpr_write_b32 a104, 0
    v_accvgpr_write_b32 a105, 0
    v_accvgpr_write_b32 a106, 0
    v_accvgpr_write_b32 a107, 0
    v_accvgpr_write_b32 a108, 0
    v_accvgpr_write_b32 a109, 0
    v_accvgpr_write_b32 a110, 0
    v_accvgpr_write_b32 a111, 0
    v_accvgpr_write_b32 a112, 0
    v_accvgpr_write_b32 a113, 0
    v_accvgpr_write_b32 a114, 0
    v_accvgpr_write_b32 a115, 0
    v_accvgpr_write_b32 a116, 0
    v_accvgpr_write_b32 a117, 0
    v_accvgpr_write_b32 a118, 0
    v_accvgpr_write_b32 a119, 0
    v_accvgpr_write_b32 a120, 0
    v_accvgpr_write_b32 a121, 0
    v_accvgpr_write_b32 a122, 0
    v_accvgpr_write_b32 a123, 0
    v_accvgpr_write_b32 a124, 0
    v_accvgpr_write_b32 a125, 0
    v_accvgpr_write_b32 a126, 0
    v_accvgpr_write_b32 a127, 0
    v_accvgpr_write_b32 a128, 0
    v_accvgpr_write_b32 a129, 0
    v_accvgpr_write_b32 a130, 0
    v_accvgpr_write_b32 a131, 0
    v_accvgpr_write_b32 a132, 0
    v_accvgpr_write_b32 a133, 0
    v_accvgpr_write_b32 a134, 0
    v_accvgpr_write_b32 a135, 0
    v_accvgpr_write_b32 a136, 0
    v_accvgpr_write_b32 a137, 0
    v_accvgpr_write_b32 a138, 0
    v_accvgpr_write_b32 a139, 0
    v_accvgpr_write_b32 a140, 0
    v_accvgpr_write_b32 a141, 0
    v_accvgpr_write_b32 a142, 0
    v_accvgpr_write_b32 a143, 0
    v_accvgpr_write_b32 a244, 0
    v_accvgpr_write_b32 a245, 0
    v_accvgpr_write_b32 a246, 0
    v_accvgpr_write_b32 a247, 0
    v_mov_b32_e32 v128, 0
    v_mov_b32_e32 v129, 0
    v_mov_b32_e32 v130, 0
    v_mov_b32_e32 v131, 0
    v_mov_b32_e32 v132, 0
    v_mov_b32_e32 v133, 0
    v_mov_b32_e32 v134, 0
    v_mov_b32_e32 v135, 0
    v_mov_b32_e32 v136, 0
    v_mov_b32_e32 v137, 0
    v_mov_b32_e32 v138, 0
    v_mov_b32_e32 v139, 0
    v_mov_b32_e32 v140, 0
    v_mov_b32_e32 v141, 0
    v_mov_b32_e32 v142, 0
    v_mov_b32_e32 v143, 0
    v_mov_b32_e32 v144, 0
    v_mov_b32_e32 v145, 0
    v_mov_b32_e32 v146, 0
    v_mov_b32_e32 v147, 0
    v_mov_b32_e32 v148, 0
    v_mov_b32_e32 v149, 0
    v_mov_b32_e32 v150, 0
    v_mov_b32_e32 v151, 0
    v_mov_b32_e32 v152, 0
    v_mov_b32_e32 v153, 0
    v_mov_b32_e32 v154, 0
    v_mov_b32_e32 v155, 0
    v_mov_b32_e32 v156, 0
    v_mov_b32_e32 v157, 0
    v_mov_b32_e32 v158, 0
    v_mov_b32_e32 v159, 0
    v_mov_b32_e32 v48, 0
    v_mov_b32_e32 v49, 0
    v_mov_b32_e32 v50, 0
    v_mov_b32_e32 v51, 0
    v_mov_b32_e32 v52, 0
    v_mov_b32_e32 v53, 0
    v_mov_b32_e32 v54, 0
    v_mov_b32_e32 v55, 0
    v_mov_b32_e32 v56, 0
    v_mov_b32_e32 v57, 0
    v_mov_b32_e32 v58, 0
    v_mov_b32_e32 v59, 0
    v_mov_b32_e32 v60, 0
    v_mov_b32_e32 v61, 0
    v_mov_b32_e32 v62, 0
    v_mov_b32_e32 v63, 0
    v_add_u32_e32 v3, 0x10000, v2
    s_mov_b32 s57, 4
    s_waitcnt vmcnt(23)
    v_lshlrev_b32_e32 v240, 16, v224
    v_lshlrev_b32_e32 v248, 16, v228
    v_and_b32_e32 v241, 0xffff0000, v224
    v_and_b32_e32 v249, 0xffff0000, v228
    v_lshlrev_b32_e32 v242, 16, v225
    v_lshlrev_b32_e32 v250, 16, v229
    v_and_b32_e32 v243, 0xffff0000, v225
    v_and_b32_e32 v251, 0xffff0000, v229
    v_lshlrev_b32_e32 v244, 16, v226
    v_lshlrev_b32_e32 v252, 16, v230
    v_and_b32_e32 v245, 0xffff0000, v226
    v_and_b32_e32 v253, 0xffff0000, v230
    v_lshlrev_b32_e32 v246, 16, v227
    v_lshlrev_b32_e32 v254, 16, v231
    v_and_b32_e32 v247, 0xffff0000, v227
    v_and_b32_e32 v255, 0xffff0000, v231
    v_mul_f32_e32 v240, s69, v240
    v_mul_f32_e32 v241, s69, v241
    v_mul_f32_e32 v242, s69, v242
    v_mul_f32_e32 v243, s69, v243
    v_mul_f32_e32 v244, s69, v244
    v_mul_f32_e32 v245, s69, v245
    v_mul_f32_e32 v246, s69, v246
    v_mul_f32_e32 v247, s69, v247
    v_mul_f32_e64 v248, -v240, v248
    v_mul_f32_e64 v249, -v241, v249
    v_mul_f32_e64 v250, -v242, v250
    v_mul_f32_e64 v251, -v243, v251
    v_mul_f32_e64 v252, -v244, v252
    v_mul_f32_e64 v253, -v245, v253
    v_mul_f32_e64 v254, -v246, v254
    v_mul_f32_e64 v255, -v247, v255
    s_waitcnt vmcnt(21)
    v_cvt_f32_i32_e32 v160, v160
    v_cvt_f32_i32_e32 v161, v161
    v_cvt_f32_i32_e32 v162, v162
    v_cvt_f32_i32_e32 v163, v163
    v_cvt_f32_i32_e32 v164, v164
    v_cvt_f32_i32_e32 v165, v165
    v_cvt_f32_i32_e32 v166, v166
    v_cvt_f32_i32_e32 v167, v167
    v_fma_f32 v160, v160, v240, v248
    v_fma_f32 v161, v161, v241, v249
    v_fma_f32 v162, v162, v242, v250
    v_fma_f32 v163, v163, v243, v251
    v_fma_f32 v164, v164, v244, v252
    v_fma_f32 v165, v165, v245, v253
    v_fma_f32 v166, v166, v246, v254
    v_fma_f32 v167, v167, v247, v255
    v_cvt_pk_bf16_f32 v160, v160, v161
    v_cvt_pk_bf16_f32 v161, v162, v163
    v_cvt_pk_bf16_f32 v162, v164, v165
    v_cvt_pk_bf16_f32 v163, v166, v167
    buffer_store_dwordx4 v[160:163], v6, s[20:23], s60 offen sc1
    ds_write_b128 v6, v[160:163]
    s_waitcnt vmcnt(20)
    v_cvt_f32_i32_e32 v168, v168
    v_cvt_f32_i32_e32 v169, v169
    v_cvt_f32_i32_e32 v170, v170
    v_cvt_f32_i32_e32 v171, v171
    v_cvt_f32_i32_e32 v172, v172
    v_cvt_f32_i32_e32 v173, v173
    v_cvt_f32_i32_e32 v174, v174
    v_cvt_f32_i32_e32 v175, v175
    v_fma_f32 v168, v168, v240, v248
    v_fma_f32 v169, v169, v241, v249
    v_fma_f32 v170, v170, v242, v250
    v_fma_f32 v171, v171, v243, v251
    v_fma_f32 v172, v172, v244, v252
    v_fma_f32 v173, v173, v245, v253
    v_fma_f32 v174, v174, v246, v254
    v_fma_f32 v175, v175, v247, v255
    v_cvt_pk_bf16_f32 v168, v168, v169
    v_cvt_pk_bf16_f32 v169, v170, v171
    v_cvt_pk_bf16_f32 v170, v172, v173
    v_cvt_pk_bf16_f32 v171, v174, v175
    buffer_store_dwordx4 v[168:171], v6, s[20:23], s60 offen offset:128 sc1
    ds_write_b128 v6, v[168:171] offset:128
    s_waitcnt vmcnt(19)
    v_cvt_f32_i32_e32 v176, v176
    v_cvt_f32_i32_e32 v177, v177
    v_cvt_f32_i32_e32 v178, v178
    v_cvt_f32_i32_e32 v179, v179
    v_cvt_f32_i32_e32 v180, v180
    v_cvt_f32_i32_e32 v181, v181
    v_cvt_f32_i32_e32 v182, v182
    v_cvt_f32_i32_e32 v183, v183
    v_fma_f32 v176, v176, v240, v248
    v_fma_f32 v177, v177, v241, v249
    v_fma_f32 v178, v178, v242, v250
    v_fma_f32 v179, v179, v243, v251
    v_fma_f32 v180, v180, v244, v252
    v_fma_f32 v181, v181, v245, v253
    v_fma_f32 v182, v182, v246, v254
    v_fma_f32 v183, v183, v247, v255
    v_cvt_pk_bf16_f32 v176, v176, v177
    v_cvt_pk_bf16_f32 v177, v178, v179
    v_cvt_pk_bf16_f32 v178, v180, v181
    v_cvt_pk_bf16_f32 v179, v182, v183
    s_add_u32 s68, s60, 0x1000
    buffer_store_dwordx4 v[176:179], v6, s[20:23], s68 offen sc1
    ds_write_b128 v6, v[176:179] offset:4096
    s_waitcnt vmcnt(18)
    v_cvt_f32_i32_e32 v184, v184
    v_cvt_f32_i32_e32 v185, v185
    v_cvt_f32_i32_e32 v186, v186
    v_cvt_f32_i32_e32 v187, v187
    v_cvt_f32_i32_e32 v188, v188
    v_cvt_f32_i32_e32 v189, v189
    v_cvt_f32_i32_e32 v190, v190
    v_cvt_f32_i32_e32 v191, v191
    v_fma_f32 v184, v184, v240, v248
    v_fma_f32 v185, v185, v241, v249
    v_fma_f32 v186, v186, v242, v250
    v_fma_f32 v187, v187, v243, v251
    v_fma_f32 v188, v188, v244, v252
    v_fma_f32 v189, v189, v245, v253
    v_fma_f32 v190, v190, v246, v254
    v_fma_f32 v191, v191, v247, v255
    v_cvt_pk_bf16_f32 v184, v184, v185
    v_cvt_pk_bf16_f32 v185, v186, v187
    v_cvt_pk_bf16_f32 v186, v188, v189
    v_cvt_pk_bf16_f32 v187, v190, v191
    buffer_store_dwordx4 v[184:187], v6, s[20:23], s68 offen offset:128 sc1
    ds_write_b128 v6, v[184:187] offset:4224
    s_getpc_b64 s[4:5]
at_pc:
    s_add_u32 s4, s4, at_first-at_pc
    s_addc_u32 s5, s5, 0
    s_lshr_b32 s67, s2, 3
    s_mul_i32 s68, s67, 26
    s_lshr_b32 s68, s68, 8
    s_mul_i32 s68, s68, 10
    s_sub_u32 s67, s67, s68
    s_lshl_b32 s67, s67, 12
    s_lshl_b32 s68, s54, 10
    s_add_u32 s67, s67, s68
    v_add_u32_e32 v30, s67, v2
    global_load_dwordx4 v[96:99], v30, s[4:5]
    s_waitcnt vmcnt(18)
    v_lshlrev_b32_e32 v240, 16, v232
    v_mov_b32_dpp v246, v236 quad_perm:[1,1,3,3] row_mask:0xf bank_mask:0xf
    v_log_f32_e32 v241, v240
    v_cmp_lt_f32_e32 vcc, 0x2b800000, v240
    v_rcp_f32_e32 v242, v240
    v_lshl_or_b32 v236, v246, 16, v236
    v_cndmask_b32_e32 v241, -1, v241, vcc
    v_cmp_gt_f32_e32 vcc, 0x53800000, v240
    v_cvt_pk_bf16_f32 v243, v242, v242
    v_mov_b32_dpp v245, v242 quad_perm:[1,1,3,3] row_mask:0xf bank_mask:0xf
    v_cndmask_b32_e32 v241, -1, v241, vcc
    v_and_b32_e32 v243, 0xffff0000, v243
    v_sub_f32_e32 v244, v242, v243
    buffer_store_dword v241, v11, s[80:83], s89 offen sc1
    ds_write_b32 v26, v241
    v_cvt_pk_bf16_f32 v242, v242, v245
    buffer_store_dword v236, v7, s[80:83], s89 offen offset:144 sc1
    ds_write_b32 v33, v236 offset:144
    v_mov_b32_dpp v246, v244 quad_perm:[1,1,3,3] row_mask:0xf bank_mask:0xf
    buffer_store_dword v242, v7, s[80:83], s89 offen sc1
    ds_write_b32 v33, v242
    v_cvt_pk_bf16_f32 v244, v244, v246
    buffer_store_dword v244, v7, s[80:83], s89 offen offset:72 sc1
    ds_write_b32 v33, v244 offset:72
    s_waitcnt vmcnt(14)
    s_cmp_lg_u32 s54, 0
    s_cbranch_scc1 at_q0skip
    s_add_u32 s67, s86, 0x1000
    buffer_load_dwordx4 a[160:163], v25, s[12:15], s67 offen nt
    buffer_load_dwordx4 a[164:167], v25, s[12:15], s67 offen offset:64 nt
    buffer_load_dwordx4 a[168:171], v25, s[12:15], s67 offen offset:128 nt
    buffer_load_dwordx4 a[172:175], v25, s[12:15], s67 offen offset:192 nt
    s_add_u32 s67, s86, 0x2000
    buffer_load_dwordx4 a[176:179], v25, s[12:15], s67 offen nt
    buffer_load_dwordx4 a[180:183], v25, s[12:15], s67 offen offset:64 nt
    buffer_load_dwordx4 a[184:187], v25, s[12:15], s67 offen offset:128 nt
    buffer_load_dwordx4 a[188:191], v25, s[12:15], s67 offen offset:192 nt
    s_add_u32 s67, s86, 0x3000
    buffer_load_dwordx4 a[192:195], v25, s[12:15], s67 offen nt
    buffer_load_dwordx4 a[196:199], v25, s[12:15], s67 offen offset:64 nt
    buffer_load_dwordx4 a[200:203], v25, s[12:15], s67 offen offset:128 nt
    buffer_load_dwordx4 a[204:207], v25, s[12:15], s67 offen offset:192 nt
at_q0skip:
    v_cvt_f32_i32_e32 v192, v192
    v_cvt_f32_i32_e32 v196, v196
    v_cvt_f32_i32_e32 v200, v200
    v_cvt_f32_i32_e32 v204, v204
    v_cvt_f32_i32_e32 v208, v208
    v_cvt_f32_i32_e32 v212, v212
    v_cvt_f32_i32_e32 v216, v216
    v_cvt_f32_i32_e32 v220, v220
    v_cvt_pk_bf16_f32 v160, v192, v196
    v_cvt_pk_bf16_f32 v161, v200, v204
    v_cvt_pk_bf16_f32 v162, v208, v212
    v_cvt_pk_bf16_f32 v163, v216, v220
    buffer_store_dwordx4 v[160:163], v9, s[20:23], s60 offen sc1
    ds_write_b128 v9, v[160:163]
    v_cvt_f32_i32_e32 v193, v193
    v_cvt_f32_i32_e32 v197, v197
    v_cvt_f32_i32_e32 v201, v201
    v_cvt_f32_i32_e32 v205, v205
    v_cvt_f32_i32_e32 v209, v209
    v_cvt_f32_i32_e32 v213, v213
    v_cvt_f32_i32_e32 v217, v217
    v_cvt_f32_i32_e32 v221, v221
    v_cvt_pk_bf16_f32 v164, v193, v197
    v_cvt_pk_bf16_f32 v165, v201, v205
    v_cvt_pk_bf16_f32 v166, v209, v213
    v_cvt_pk_bf16_f32 v167, v217, v221
    buffer_store_dwordx4 v[164:167], v9, s[20:23], s60 offen offset:1024 sc1
    ds_write_b128 v9, v[164:167] offset:1024
    v_cvt_f32_i32_e32 v194, v194
    v_cvt_f32_i32_e32 v198, v198
    v_cvt_f32_i32_e32 v202, v202
    v_cvt_f32_i32_e32 v206, v206
    v_cvt_f32_i32_e32 v210, v210
    v_cvt_f32_i32_e32 v214, v214
    v_cvt_f32_i32_e32 v218, v218
    v_cvt_f32_i32_e32 v222, v222
    v_cvt_pk_bf16_f32 v168, v194, v198
    v_cvt_pk_bf16_f32 v169, v202, v206
    v_cvt_pk_bf16_f32 v170, v210, v214
    v_cvt_pk_bf16_f32 v171, v218, v222
    buffer_store_dwordx4 v[168:171], v9, s[20:23], s60 offen offset:2048 sc1
    ds_write_b128 v9, v[168:171] offset:2048
    v_cvt_f32_i32_e32 v195, v195
    v_cvt_f32_i32_e32 v199, v199
    v_cvt_f32_i32_e32 v203, v203
    v_cvt_f32_i32_e32 v207, v207
    v_cvt_f32_i32_e32 v211, v211
    v_cvt_f32_i32_e32 v215, v215
    v_cvt_f32_i32_e32 v219, v219
    v_cvt_f32_i32_e32 v223, v223
    v_cvt_pk_bf16_f32 v172, v195, v199
    v_cvt_pk_bf16_f32 v173, v203, v207
    v_cvt_pk_bf16_f32 v174, v211, v215
    v_cvt_pk_bf16_f32 v175, v219, v223
    buffer_store_dwordx4 v[172:175], v9, s[20:23], s60 offen offset:3072 sc1
    ds_write_b128 v9, v[172:175] offset:3072
    s_waitcnt vmcnt(17)
    v_readfirstlane_b32 s90, v20
    v_readfirstlane_b32 s91, v21
    s_nop 3
    s_cmp_eq_u64 s[90:91], 0
    s_cselect_b64 s[92:93], s[92:93], s[90:91]
    s_cmp_eq_u32 s54, 0
    s_cselect_b64 s[92:93], s[92:93], 0
    v_mov_b32_e32 v12, s92
    v_mov_b32_e32 v13, s93
    s_add_u32 s60, s60, 0x40000
    s_add_u32 s61, s61, 0x400
    s_add_u32 s62, s62, 0x400
    s_lshr_b32 s89, s60, 5
    s_waitcnt vmcnt(0)
    s_waitcnt lgkmcnt(0)
    s_barrier
    buffer_store_dwordx2 v[12:13], v0, s[48:51], s87 offen sc1
    s_add_u32 s87, s87, 64
    s_cmp_eq_u32 s54, 0
    s_cbranch_scc1 at_q1skip
    s_add_u32 s67, s86, 0x1000
    buffer_load_dwordx4 a[160:163], v25, s[12:15], s67 offen nt
    buffer_load_dwordx4 a[164:167], v25, s[12:15], s67 offen offset:64 nt
    buffer_load_dwordx4 a[168:171], v25, s[12:15], s67 offen offset:128 nt
    buffer_load_dwordx4 a[172:175], v25, s[12:15], s67 offen offset:192 nt
    s_add_u32 s67, s86, 0x2000
    buffer_load_dwordx4 a[176:179], v25, s[12:15], s67 offen nt
    buffer_load_dwordx4 a[180:183], v25, s[12:15], s67 offen offset:64 nt
    buffer_load_dwordx4 a[184:187], v25, s[12:15], s67 offen offset:128 nt
    buffer_load_dwordx4 a[188:191], v25, s[12:15], s67 offen offset:192 nt
    s_add_u32 s67, s86, 0x3000
    buffer_load_dwordx4 a[192:195], v25, s[12:15], s67 offen nt
    buffer_load_dwordx4 a[196:199], v25, s[12:15], s67 offen offset:64 nt
    buffer_load_dwordx4 a[200:203], v25, s[12:15], s67 offen offset:128 nt
    buffer_load_dwordx4 a[204:207], v25, s[12:15], s67 offen offset:192 nt
at_q1skip:
    ds_read_b128 v[64:67], v2
    ds_read_b128 v[68:71], v2 offset:1024
    ds_read_b128 v[72:75], v2 offset:2048
    ds_read_b128 v[76:79], v2 offset:3072
    ds_read_b128 v[80:83], v2 offset:4096
    ds_read_b128 v[84:87], v2 offset:5120
    ds_read_b128 v[88:91], v2 offset:6144
    ds_read_b128 v[92:95], v2 offset:7168
    ds_read_b128 a[208:211], v2 offset:8192
    ds_read_b128 a[212:215], v2 offset:9216
    ds_read_b128 a[216:219], v2 offset:10240
    ds_read_b128 a[220:223], v2 offset:11264
    ds_read_b128 a[224:227], v2 offset:12288
    ds_read_b128 a[228:231], v2 offset:13312
    ds_read_b128 a[232:235], v2 offset:14336
    ds_read_b128 a[236:239], v2 offset:15360
    ds_read_b128 v[120:123], v1
    ds_read_b128 v[124:127], v1 offset:64
    ds_read2_b64 a[240:243], v14 offset0:0 offset1:4
    v_mov_b32_e32 v16, 0
    v_mov_b32_e32 v17, 0
    v_mov_b32_e32 v18, 0
    v_mov_b32_e32 v19, 0
    v_mov_b32_e32 v20, 0
    v_mov_b32_e32 v21, 0
    v_mov_b32_e32 v22, 0
    v_mov_b32_e32 v23, 0
    v_mov_b32_e32 v24, 0
    v_mov_b32_e32 v25, 0
    v_mov_b32_e32 v26, 0
    v_mov_b32_e32 v27, 0
    v_mov_b32_e32 v28, 0
    v_mov_b32_e32 v29, 0
    v_mov_b32_e32 v30, 0
    v_mov_b32_e32 v31, 0
    v_mov_b32_e32 v32, 0
    v_mov_b32_e32 v33, 0
    v_mov_b32_e32 v34, 0
    v_mov_b32_e32 v35, 0
    v_mov_b32_e32 v36, 0
    v_mov_b32_e32 v37, 0
    v_mov_b32_e32 v38, 0
    v_mov_b32_e32 v39, 0
    v_mov_b32_e32 v40, 0
    v_mov_b32_e32 v41, 0
    v_mov_b32_e32 v42, 0
    v_mov_b32_e32 v43, 0
    v_mov_b32_e32 v44, 0xff800000
    v_mov_b32_e32 v45, 0xff800000
    v_mov_b32_e32 v46, 0xff800000
    v_mov_b32_e32 v47, 0xff800000
    s_cmp_lg_u32 s54, 0
    s_cbranch_scc1 at_p_ready
at_pspin_in:
    s_mov_b32 s94, 0x100000
at_pspin:
    v_lshlrev_b32_e32 v12, 1, v15
    buffer_load_dwordx2 v[12:13], v12, s[48:51], 0 offen sc1
    s_sub_u32 s94, s94, 1
    s_cbranch_scc1 at_pspin_out
    s_waitcnt vmcnt(0)
    v_cmp_eq_u64_e64 s[90:91], s[92:93], v[12:13]
    s_nop 4
    s_lshr_b32 s64, s90, 0
    s_and_b32 s64, s64, 0xff
    s_cmp_eq_u32 s64, 0xff
    s_cbranch_scc0 at_pspin
at_pspin_out:
at_p_ready:
    s_barrier
    s_add_u32 m0, s88, 0x8000
    s_add_u32 s56, s71, 0
    buffer_load_dwordx4 v4, s[20:23], s56 offen sc1 lds
    buffer_load_dwordx4 v4, s[20:23], s56 offen offset:1024 sc1 lds
    buffer_load_dwordx4 v4, s[20:23], s56 offen offset:2048 sc1 lds
    buffer_load_dwordx4 v4, s[20:23], s56 offen offset:3072 sc1 lds
    s_add_u32 m0, s88, 0xc000
    s_add_u32 s56, s71, 0x4000
    buffer_load_dwordx4 v4, s[20:23], s56 offen sc1 lds
    buffer_load_dwordx4 v4, s[20:23], s56 offen offset:1024 sc1 lds
    buffer_load_dwordx4 v4, s[20:23], s56 offen offset:2048 sc1 lds
    buffer_load_dwordx4 v4, s[20:23], s56 offen offset:3072 sc1 lds
    s_add_u32 m0, s10, s84
    s_lshr_b32 s3, s71, 5
    buffer_load_dword v15, s[80:83], s3 offen sc1 lds
    s_add_u32 m0, s88, 0x10000
    s_add_u32 s56, s72, 0
    s_add_u32 s55, s72, 0x4000
    s_lshr_b32 s3, s72, 5
    s_waitcnt vmcnt(9)
    s_waitcnt lgkmcnt(0)
.p2align 6
at_first:
    v_mfma_f32_16x16x32_bf16 v[16:19], v[64:67], a[144:147], v[120:123]
    v_cvt_pk_bf16_f32 v61, v42, v43
    v_mfma_f32_16x16x32_bf16 v[16:19], v[68:71], a[148:151], v[16:19]
    v_exp_f32_e64 v44, v44
    v_mfma_f32_16x16x32_bf16 v[16:19], v[72:75], a[152:155], v[16:19]
    ds_read_b128 v[96:99], v2 offset:16384
    s_waitcnt lgkmcnt(4)
    v_mfma_f32_16x16x32_bf16 v[16:19], v[76:79], a[156:159], v[16:19]
    v_exp_f32_e32 v45, v45
    v_mfma_f32_16x16x32_bf16 v[20:23], v[80:83], a[144:147], v[124:127]
    buffer_load_dwordx4 v4, s[20:23], s56 offen sc1 lds
    v_cvt_pk_bf16_f32 v62, v44, v45
    v_mfma_f32_16x16x32_bf16 v[20:23], v[84:87], a[148:151], v[20:23]
    v_exp_f32_e64 v46, v46
    v_mfma_f32_16x16x32_bf16 v[20:23], v[88:91], a[152:155], v[20:23]
    ds_read_b128 v[100:103], v2 offset:17408
    v_mfma_f32_16x16x32_bf16 v[20:23], v[92:95], a[156:159], v[20:23]
    v_exp_f32_e64 v47, v47
    v_mfma_f32_16x16x32_bf16 a[64:67], v[56:59], v[128:131], a[64:67]
    buffer_load_dwordx4 v4, s[20:23], s56 offen offset:1024 sc1 lds
    v_cvt_pk_bf16_f32 v63, v46, v47
    v_mfma_f32_16x16x32_bf16 a[68:71], v[56:59], v[132:135], a[68:71]
    buffer_load_dwordx4 v4, s[20:23], s56 offen offset:2048 sc1 lds
    v_mfma_f32_16x16x32_bf16 a[72:75], v[56:59], v[136:139], a[72:75]
    v_exp_f32_e64 v16, v16
    v_mfma_f32_16x16x32_bf16 a[76:79], v[56:59], v[140:143], a[76:79]
    ds_read_b128 v[104:107], v2 offset:18432
    v_mfma_f32_16x16x32_bf16 a[80:83], v[56:59], v[144:147], a[80:83]
    v_exp_f32_e64 v17, v17
    v_mfma_f32_16x16x32_bf16 a[84:87], v[56:59], v[148:151], a[84:87]
    buffer_load_dwordx4 v4, s[20:23], s56 offen offset:3072 sc1 lds
    v_cvt_pk_bf16_f32 v48, v16, v17
    v_mfma_f32_16x16x32_bf16 a[88:91], v[56:59], v[152:155], a[88:91]
    v_exp_f32_e64 v18, v18
    v_mfma_f32_16x16x32_bf16 a[92:95], v[56:59], v[156:159], a[92:95]
    ds_read_b128 v[108:111], v2 offset:19456
    s_add_u32 m0, s88, 0x14000
    v_mfma_f32_16x16x32_bf16 a[136:139], v[56:59], a[244:247], a[136:139]
    v_exp_f32_e64 v19, v19
    v_mfma_f32_16x16x32_bf16 v[24:27], v[64:67], a[160:163], v[120:123]
    buffer_load_dwordx4 v4, s[20:23], s55 offen sc1 lds
    v_cvt_pk_bf16_f32 v49, v18, v19
    v_mfma_f32_16x16x32_bf16 v[24:27], v[68:71], a[164:167], v[24:27]
    v_exp_f32_e64 v20, v20
    v_mfma_f32_16x16x32_bf16 v[24:27], v[72:75], a[168:171], v[24:27]
    ds_read_b128 v[112:115], v2 offset:20480
    s_add_u32 s56, s73, s58
    v_mfma_f32_16x16x32_bf16 v[24:27], v[76:79], a[172:175], v[24:27]
    v_exp_f32_e32 v21, v21
    v_mfma_f32_16x16x32_bf16 v[28:31], v[80:83], a[160:163], v[124:127]
    buffer_load_dwordx4 v4, s[20:23], s55 offen offset:1024 sc1 lds
    v_cvt_pk_bf16_f32 v50, v20, v21
    v_mfma_f32_16x16x32_bf16 v[28:31], v[84:87], a[164:167], v[28:31]
    v_exp_f32_e64 v22, v22
    v_mfma_f32_16x16x32_bf16 v[28:31], v[88:91], a[168:171], v[28:31]
    ds_read_b128 v[116:119], v2 offset:21504
    s_lshr_b32 s11, s56, 5
    v_mfma_f32_16x16x32_bf16 v[28:31], v[92:95], a[172:175], v[28:31]
    v_exp_f32_e32 v23, v23
    v_mfma_f32_16x16x32_bf16 a[96:99], v[60:63], v[128:131], a[96:99]
    buffer_load_dwordx4 v4, s[20:23], s55 offen offset:2048 sc1 lds
    v_cvt_pk_bf16_f32 v51, v22, v23
    v_mfma_f32_16x16x32_bf16 a[100:103], v[60:63], v[132:135], a[100:103]
    buffer_load_dwordx4 v4, s[20:23], s55 offen offset:3072 sc1 lds
    v_mfma_f32_16x16x32_bf16 a[104:107], v[60:63], v[136:139], a[104:107]
    v_exp_f32_e64 v24, v24
    v_mfma_f32_16x16x32_bf16 a[108:111], v[60:63], v[140:143], a[108:111]
    ds_read_b128 a[248:251], v2 offset:22528
    s_lshl1_add_u32 m0, s84, s10
    v_mfma_f32_16x16x32_bf16 a[112:115], v[60:63], v[144:147], a[112:115]
    v_exp_f32_e32 v25, v25
    v_mfma_f32_16x16x32_bf16 a[116:119], v[60:63], v[148:151], a[116:119]
    buffer_load_dword v15, s[80:83], s3 offen sc1 lds
    v_cvt_pk_bf16_f32 v52, v24, v25
    s_add_u32 m0, s88, 0x18000
    v_mfma_f32_16x16x32_bf16 a[120:123], v[60:63], v[152:155], a[120:123]
    v_exp_f32_e64 v26, v26
    v_mfma_f32_16x16x32_bf16 a[124:127], v[60:63], v[156:159], a[124:127]
    ds_read_b128 a[252:255], v2 offset:23552
    s_waitcnt lgkmcnt(8)
    v_mfma_f32_16x16x32_bf16 a[140:143], v[60:63], a[244:247], a[140:143]
    v_exp_f32_e32 v27, v27
    v_mfma_f32_16x16x32_bf16 v[32:35], v[64:67], a[176:179], v[120:123]
    buffer_load_dwordx4 v4, s[20:23], s56 offen sc1 lds
    v_cvt_pk_bf16_f32 v53, v26, v27
    v_mfma_f32_16x16x32_bf16 v[32:35], v[68:71], a[180:183], v[32:35]
    v_exp_f32_e64 v28, v28
    v_mfma_f32_16x16x32_bf16 v[32:35], v[72:75], a[184:187], v[32:35]
    ds_read_b128 v[128:131], v2 offset:24576
    buffer_load_dwordx4 v4, s[20:23], s56 offen offset:1024 sc1 lds
    s_add_u32 s55, s56, 0x4000
    v_mfma_f32_16x16x32_bf16 v[32:35], v[76:79], a[188:191], v[32:35]
    v_exp_f32_e64 v29, v29
    v_mfma_f32_16x16x32_bf16 v[36:39], v[80:83], a[176:179], v[124:127]
    buffer_load_dwordx4 v4, s[20:23], s56 offen offset:2048 sc1 lds
    v_cvt_pk_bf16_f32 v54, v28, v29
    v_mfma_f32_16x16x32_bf16 v[36:39], v[84:87], a[180:183], v[36:39]
    v_exp_f32_e64 v30, v30
    v_mfma_f32_16x16x32_bf16 v[36:39], v[88:91], a[184:187], v[36:39]
    ds_read_b128 v[132:135], v2 offset:25600
    buffer_load_dwordx4 v4, s[20:23], s56 offen offset:3072 sc1 lds
    s_add_u32 m0, s88, 0x1c000
    v_mfma_f32_16x16x32_bf16 v[36:39], v[92:95], a[188:191], v[36:39]
    v_exp_f32_e64 v31, v31
    v_mfma_f32_16x16x32_bf16 a[0:3], v[48:51], a[208:211], a[0:3]
    buffer_load_dwordx4 v4, s[20:23], s55 offen sc1 lds
    v_cvt_pk_bf16_f32 v55, v30, v31
    v_mfma_f32_16x16x32_bf16 a[4:7], v[48:51], a[212:215], a[4:7]
    buffer_load_dwordx4 v4, s[20:23], s55 offen offset:1024 sc1 lds
    v_mfma_f32_16x16x32_bf16 a[8:11], v[48:51], a[216:219], a[8:11]
    v_exp_f32_e64 v32, v32
    v_mfma_f32_16x16x32_bf16 a[12:15], v[48:51], a[220:223], a[12:15]
    ds_read_b128 v[136:139], v2 offset:26624
    v_mfma_f32_16x16x32_bf16 a[16:19], v[48:51], a[224:227], a[16:19]
    v_exp_f32_e64 v33, v33
    v_mfma_f32_16x16x32_bf16 a[20:23], v[48:51], a[228:231], a[20:23]
    buffer_load_dwordx4 v4, s[20:23], s55 offen offset:2048 sc1 lds
    v_cvt_pk_bf16_f32 v56, v32, v33
    v_mfma_f32_16x16x32_bf16 a[24:27], v[48:51], a[232:235], a[24:27]
    v_exp_f32_e64 v34, v34
    v_mfma_f32_16x16x32_bf16 a[28:31], v[48:51], a[236:239], a[28:31]
    ds_read_b128 v[140:143], v2 offset:27648
    v_mfma_f32_16x16x32_bf16 a[128:131], v[48:51], a[240:243], a[128:131]
    v_exp_f32_e64 v35, v35
    v_mfma_f32_16x16x32_bf16 v[40:43], v[64:67], a[192:195], v[120:123]
    buffer_load_dwordx4 v4, s[20:23], s55 offen offset:3072 sc1 lds
    v_cvt_pk_bf16_f32 v57, v34, v35
    v_mfma_f32_16x16x32_bf16 v[40:43], v[68:71], a[196:199], v[40:43]
    v_exp_f32_e64 v36, v36
    v_mfma_f32_16x16x32_bf16 v[40:43], v[72:75], a[200:203], v[40:43]
    ds_read_b128 v[144:147], v2 offset:28672
    s_mov_b32 m0, s85
    v_mfma_f32_16x16x32_bf16 v[40:43], v[76:79], a[204:207], v[40:43]
    v_exp_f32_e32 v37, v37
    v_mfma_f32_16x16x32_bf16 v[44:47], v[80:83], a[192:195], v[124:127]
    ds_read_b128 v[120:123], v1 offset:128
    buffer_load_dword v15, s[80:83], s11 offen sc1 lds
    v_cvt_pk_bf16_f32 v58, v36, v37
    v_mfma_f32_16x16x32_bf16 v[44:47], v[84:87], a[196:199], v[44:47]
    v_exp_f32_e64 v38, v38
    v_mfma_f32_16x16x32_bf16 v[44:47], v[88:91], a[200:203], v[44:47]
    ds_read_b128 v[148:151], v2 offset:29696
    v_mfma_f32_16x16x32_bf16 v[44:47], v[92:95], a[204:207], v[44:47]
    v_exp_f32_e64 v39, v39
    v_mfma_f32_16x16x32_bf16 a[32:35], v[52:55], a[208:211], a[32:35]
    ds_read_b128 v[124:127], v1 offset:192
    v_cvt_pk_bf16_f32 v59, v38, v39
    v_mfma_f32_16x16x32_bf16 a[36:39], v[52:55], a[212:215], a[36:39]
    v_mfma_f32_16x16x32_bf16 a[40:43], v[52:55], a[216:219], a[40:43]
    v_exp_f32_e64 v40, v40
    v_mfma_f32_16x16x32_bf16 a[44:47], v[52:55], a[220:223], a[44:47]
    ds_read_b128 v[152:155], v2 offset:30720
    v_lshrrev_b32_e64 v228, 3, v2
    v_and_b32_e32 v228, 0x70, v228
    v_mfma_f32_16x16x32_bf16 a[48:51], v[52:55], a[224:227], a[48:51]
    v_exp_f32_e64 v41, v41
    v_mfma_f32_16x16x32_bf16 a[52:55], v[52:55], a[228:231], a[52:55]
    ds_read2_b64 a[244:247], v14 offset0:32 offset1:36
    v_cvt_pk_bf16_f32 v60, v40, v41
    v_add_u32_e64 v228, s95, v228
    v_mfma_f32_16x16x32_bf16 a[56:59], v[52:55], a[232:235], a[56:59]
    v_exp_f32_e64 v42, v42
    v_mfma_f32_16x16x32_bf16 a[60:63], v[52:55], a[236:239], a[60:63]
    ds_read_b128 v[156:159], v2 offset:31744
    s_waitcnt vmcnt(18) lgkmcnt(5)
    v_mfma_f32_16x16x32_bf16 a[132:135], v[52:55], a[240:243], a[132:135]
    v_exp_f32_e32 v43, v43
    v_mfma_f32_16x16x32_bf16 v[16:19], v[96:99], a[144:147], v[120:123]
    s_barrier
    v_cvt_pk_bf16_f32 v61, v42, v43
    v_mfma_f32_16x16x32_bf16 v[16:19], v[100:103], a[148:151], v[16:19]
    v_exp_f32_e32 v44, v44
    v_mfma_f32_16x16x32_bf16 v[16:19], v[104:107], a[152:155], v[16:19]
    ds_read_b128 v[64:67], v2 offset:32768
    buffer_load_dwordx4 v[224:227], v228, s[32:35], s61 offen
    s_waitcnt lgkmcnt(4)
    v_mfma_f32_16x16x32_bf16 v[16:19], v[108:111], a[156:159], v[16:19]
    v_exp_f32_e32 v45, v45
    v_mfma_f32_16x16x32_bf16 v[20:23], v[112:115], a[144:147], v[124:127]
    buffer_load_dwordx4 v[228:231], v228, s[36:39], s61 offen
    v_cvt_pk_bf16_f32 v62, v44, v45
    v_mfma_f32_16x16x32_bf16 v[20:23], v[116:119], a[148:151], v[20:23]
    v_exp_f32_e64 v46, v46
    v_mfma_f32_16x16x32_bf16 v[20:23], a[248:251], a[152:155], v[20:23]
    ds_read_b128 v[68:71], v2 offset:33792
    v_mfma_f32_16x16x32_bf16 v[20:23], a[252:255], a[156:159], v[20:23]
    v_exp_f32_e64 v47, v47
    v_mfma_f32_16x16x32_bf16 a[64:67], v[56:59], a[208:211], a[64:67]
    v_cvt_pk_bf16_f32 v63, v46, v47
    v_mfma_f32_16x16x32_bf16 a[68:71], v[56:59], a[212:215], a[68:71]
    buffer_load_dwordx4 v[160:163], v5, s[24:27], s60 offen nt
    v_mfma_f32_16x16x32_bf16 a[72:75], v[56:59], a[216:219], a[72:75]
    v_exp_f32_e64 v16, v16
    v_mfma_f32_16x16x32_bf16 a[76:79], v[56:59], a[220:223], a[76:79]
    ds_read_b128 v[72:75], v2 offset:34816
    v_mfma_f32_16x16x32_bf16 a[80:83], v[56:59], a[224:227], a[80:83]
    v_exp_f32_e64 v17, v17
    v_mfma_f32_16x16x32_bf16 a[84:87], v[56:59], a[228:231], a[84:87]
    v_cvt_pk_bf16_f32 v48, v16, v17
    v_mfma_f32_16x16x32_bf16 a[88:91], v[56:59], a[232:235], a[88:91]
    v_exp_f32_e64 v18, v18
    v_mfma_f32_16x16x32_bf16 a[92:95], v[56:59], a[236:239], a[92:95]
    ds_read_b128 v[76:79], v2 offset:35840
    v_mfma_f32_16x16x32_bf16 a[136:139], v[56:59], a[240:243], a[136:139]
    v_exp_f32_e64 v19, v19
    v_mfma_f32_16x16x32_bf16 v[24:27], v[96:99], a[160:163], v[120:123]
    buffer_load_dwordx4 v[164:167], v5, s[24:27], s60 offen offset:16 nt
    v_cvt_pk_bf16_f32 v49, v18, v19
    v_mfma_f32_16x16x32_bf16 v[24:27], v[100:103], a[164:167], v[24:27]
    v_exp_f32_e64 v20, v20
    v_mfma_f32_16x16x32_bf16 v[24:27], v[104:107], a[168:171], v[24:27]
    ds_read_b128 v[80:83], v2 offset:36864
    v_mfma_f32_16x16x32_bf16 v[24:27], v[108:111], a[172:175], v[24:27]
    v_exp_f32_e64 v21, v21
    v_mfma_f32_16x16x32_bf16 v[28:31], v[112:115], a[160:163], v[124:127]
    v_cvt_pk_bf16_f32 v50, v20, v21
    v_mfma_f32_16x16x32_bf16 v[28:31], v[116:119], a[164:167], v[28:31]
    v_exp_f32_e64 v22, v22
    v_mfma_f32_16x16x32_bf16 v[28:31], a[248:251], a[168:171], v[28:31]
    ds_read_b128 v[84:87], v2 offset:37888
    v_mfma_f32_16x16x32_bf16 v[28:31], a[252:255], a[172:175], v[28:31]
    v_exp_f32_e64 v23, v23
    v_mfma_f32_16x16x32_bf16 a[96:99], v[60:63], a[208:211], a[96:99]
    v_cvt_pk_bf16_f32 v51, v22, v23
    s_add_u32 s67, s60, 0x1000
    v_mfma_f32_16x16x32_bf16 a[100:103], v[60:63], a[212:215], a[100:103]
    buffer_load_dwordx4 v[168:171], v5, s[24:27], s67 offen nt
    v_mfma_f32_16x16x32_bf16 a[104:107], v[60:63], a[216:219], a[104:107]
    v_exp_f32_e64 v24, v24
    v_mfma_f32_16x16x32_bf16 a[108:111], v[60:63], a[220:223], a[108:111]
    ds_read_b128 v[88:91], v2 offset:38912
    v_mfma_f32_16x16x32_bf16 a[112:115], v[60:63], a[224:227], a[112:115]
    v_exp_f32_e64 v25, v25
    v_mfma_f32_16x16x32_bf16 a[116:119], v[60:63], a[228:231], a[116:119]
    v_cvt_pk_bf16_f32 v52, v24, v25
    v_mfma_f32_16x16x32_bf16 a[120:123], v[60:63], a[232:235], a[120:123]
    v_exp_f32_e64 v26, v26
    v_mfma_f32_16x16x32_bf16 a[124:127], v[60:63], a[236:239], a[124:127]
    ds_read_b128 v[92:95], v2 offset:39936
    s_waitcnt lgkmcnt(8)
    v_mfma_f32_16x16x32_bf16 a[140:143], v[60:63], a[240:243], a[140:143]
    v_exp_f32_e32 v27, v27
    v_mfma_f32_16x16x32_bf16 v[32:35], v[96:99], a[176:179], v[120:123]
    buffer_load_dwordx4 v[172:175], v5, s[24:27], s67 offen offset:16 nt
    v_cvt_pk_bf16_f32 v53, v26, v27
    v_mfma_f32_16x16x32_bf16 v[32:35], v[100:103], a[180:183], v[32:35]
    v_exp_f32_e64 v28, v28
    v_mfma_f32_16x16x32_bf16 v[32:35], v[104:107], a[184:187], v[32:35]
    ds_read_b128 a[208:211], v2 offset:40960
    v_mfma_f32_16x16x32_bf16 v[32:35], v[108:111], a[188:191], v[32:35]
    v_exp_f32_e64 v29, v29
    v_mfma_f32_16x16x32_bf16 v[36:39], v[112:115], a[176:179], v[124:127]
    v_cvt_pk_bf16_f32 v54, v28, v29
    v_mfma_f32_16x16x32_bf16 v[36:39], v[116:119], a[180:183], v[36:39]
    v_exp_f32_e64 v30, v30
    v_mfma_f32_16x16x32_bf16 v[36:39], a[248:251], a[184:187], v[36:39]
    ds_read_b128 a[212:215], v2 offset:41984
    v_mfma_f32_16x16x32_bf16 v[36:39], a[252:255], a[188:191], v[36:39]
    v_exp_f32_e64 v31, v31
    v_mfma_f32_16x16x32_bf16 a[0:3], v[48:51], v[128:131], a[0:3]
    v_cvt_pk_bf16_f32 v55, v30, v31
    s_add_u32 s67, s60, 0x2000
    v_mfma_f32_16x16x32_bf16 a[4:7], v[48:51], v[132:135], a[4:7]
    buffer_load_dwordx4 v[176:179], v5, s[24:27], s67 offen nt
    v_mfma_f32_16x16x32_bf16 a[8:11], v[48:51], v[136:139], a[8:11]
    v_exp_f32_e64 v32, v32
    v_mfma_f32_16x16x32_bf16 a[12:15], v[48:51], v[140:143], a[12:15]
    ds_read_b128 a[216:219], v2 offset:43008
    v_mfma_f32_16x16x32_bf16 a[16:19], v[48:51], v[144:147], a[16:19]
    v_exp_f32_e64 v33, v33
    v_mfma_f32_16x16x32_bf16 a[20:23], v[48:51], v[148:151], a[20:23]
    v_cvt_pk_bf16_f32 v56, v32, v33
    v_mfma_f32_16x16x32_bf16 a[24:27], v[48:51], v[152:155], a[24:27]
    v_exp_f32_e64 v34, v34
    v_mfma_f32_16x16x32_bf16 a[28:31], v[48:51], v[156:159], a[28:31]
    ds_read_b128 a[220:223], v2 offset:44032
    buffer_load_dwordx4 v[180:183], v5, s[24:27], s67 offen offset:16 nt
    v_mfma_f32_16x16x32_bf16 a[128:131], v[48:51], a[244:247], a[128:131]
    v_exp_f32_e64 v35, v35
    v_mfma_f32_16x16x32_bf16 v[40:43], v[96:99], a[192:195], v[120:123]
    v_cvt_pk_bf16_f32 v57, v34, v35
    v_mfma_f32_16x16x32_bf16 v[40:43], v[100:103], a[196:199], v[40:43]
    v_exp_f32_e64 v36, v36
    v_mfma_f32_16x16x32_bf16 v[40:43], v[104:107], a[200:203], v[40:43]
    ds_read_b128 a[224:227], v2 offset:45056
    v_mfma_f32_16x16x32_bf16 v[40:43], v[108:111], a[204:207], v[40:43]
    v_exp_f32_e64 v37, v37
    v_mfma_f32_16x16x32_bf16 v[44:47], v[112:115], a[192:195], v[124:127]
    ds_read_b128 v[120:123], v1 offset:256
    v_cvt_pk_bf16_f32 v58, v36, v37
    v_mfma_f32_16x16x32_bf16 v[44:47], v[116:119], a[196:199], v[44:47]
    v_exp_f32_e64 v38, v38
    v_mfma_f32_16x16x32_bf16 v[44:47], a[248:251], a[200:203], v[44:47]
    ds_read_b128 a[228:231], v2 offset:46080
    s_add_u32 s67, s60, 0x3000
    v_mfma_f32_16x16x32_bf16 v[44:47], a[252:255], a[204:207], v[44:47]
    v_exp_f32_e64 v39, v39
    v_mfma_f32_16x16x32_bf16 a[32:35], v[52:55], v[128:131], a[32:35]
    ds_read_b128 v[124:127], v1 offset:320
    buffer_load_dwordx4 v[184:187], v5, s[24:27], s67 offen nt
    v_cvt_pk_bf16_f32 v59, v38, v39
    v_mfma_f32_16x16x32_bf16 a[36:39], v[52:55], v[132:135], a[36:39]
    v_mfma_f32_16x16x32_bf16 a[40:43], v[52:55], v[136:139], a[40:43]
    v_exp_f32_e64 v40, v40
    v_mfma_f32_16x16x32_bf16 a[44:47], v[52:55], v[140:143], a[44:47]
    ds_read_b128 a[232:235], v2 offset:47104
    v_mfma_f32_16x16x32_bf16 a[48:51], v[52:55], v[144:147], a[48:51]
    v_exp_f32_e64 v41, v41
    v_mfma_f32_16x16x32_bf16 a[52:55], v[52:55], v[148:151], a[52:55]
    ds_read2_b64 a[240:243], v14 offset0:64 offset1:68
    v_cvt_pk_bf16_f32 v60, v40, v41
    v_mfma_f32_16x16x32_bf16 a[56:59], v[52:55], v[152:155], a[56:59]
    v_exp_f32_e64 v42, v42
    v_mfma_f32_16x16x32_bf16 a[60:63], v[52:55], v[156:159], a[60:63]
    ds_read_b128 a[236:239], v2 offset:48128
    s_waitcnt lgkmcnt(5)
    v_mfma_f32_16x16x32_bf16 a[132:135], v[52:55], a[244:247], a[132:135]
    v_exp_f32_e32 v43, v43
    v_mfma_f32_16x16x32_bf16 v[16:19], v[64:67], a[144:147], v[120:123]
    v_cvt_pk_bf16_f32 v61, v42, v43
    v_mfma_f32_16x16x32_bf16 v[16:19], v[68:71], a[148:151], v[16:19]
    v_exp_f32_e64 v44, v44
    v_mfma_f32_16x16x32_bf16 v[16:19], v[72:75], a[152:155], v[16:19]
    ds_read_b128 v[96:99], v2 offset:49152
    buffer_load_dwordx4 v[188:191], v5, s[24:27], s67 offen offset:16 nt
    s_waitcnt lgkmcnt(4)
    v_mfma_f32_16x16x32_bf16 v[16:19], v[76:79], a[156:159], v[16:19]
    v_exp_f32_e32 v45, v45
    v_mfma_f32_16x16x32_bf16 v[20:23], v[80:83], a[144:147], v[124:127]
    v_cvt_pk_bf16_f32 v62, v44, v45
    v_mfma_f32_16x16x32_bf16 v[20:23], v[84:87], a[148:151], v[20:23]
    v_exp_f32_e64 v46, v46
    v_mfma_f32_16x16x32_bf16 v[20:23], v[88:91], a[152:155], v[20:23]
    ds_read_b128 v[100:103], v2 offset:50176
    buffer_load_ushort v232, v10, s[40:43], s62 offen
    v_mfma_f32_16x16x32_bf16 v[20:23], v[92:95], a[156:159], v[20:23]
    v_exp_f32_e64 v47, v47
    v_mfma_f32_16x16x32_bf16 a[64:67], v[56:59], v[128:131], a[64:67]
    v_cvt_pk_bf16_f32 v63, v46, v47
    v_mfma_f32_16x16x32_bf16 a[68:71], v[56:59], v[132:135], a[68:71]
    v_mfma_f32_16x16x32_bf16 a[72:75], v[56:59], v[136:139], a[72:75]
    v_exp_f32_e64 v16, v16
    v_mfma_f32_16x16x32_bf16 a[76:79], v[56:59], v[140:143], a[76:79]
    ds_read_b128 v[104:107], v2 offset:51200
    v_mfma_f32_16x16x32_bf16 a[80:83], v[56:59], v[144:147], a[80:83]
    v_exp_f32_e64 v17, v17
    v_mfma_f32_16x16x32_bf16 a[84:87], v[56:59], v[148:151], a[84:87]
    buffer_load_ushort v236, v10, s[44:47], s62 offen
    v_cvt_pk_bf16_f32 v48, v16, v17
    v_mfma_f32_16x16x32_bf16 a[88:91], v[56:59], v[152:155], a[88:91]
    v_exp_f32_e64 v18, v18
    v_mfma_f32_16x16x32_bf16 a[92:95], v[56:59], v[156:159], a[92:95]
    ds_read_b128 v[108:111], v2 offset:52224
    v_mfma_f32_16x16x32_bf16 a[136:139], v[56:59], a[244:247], a[136:139]
    v_exp_f32_e64 v19, v19
    v_mfma_f32_16x16x32_bf16 v[24:27], v[64:67], a[160:163], v[120:123]
    v_cvt_pk_bf16_f32 v49, v18, v19
    v_mfma_f32_16x16x32_bf16 v[24:27], v[68:71], a[164:167], v[24:27]
    v_exp_f32_e64 v20, v20
    v_mfma_f32_16x16x32_bf16 v[24:27], v[72:75], a[168:171], v[24:27]
    ds_read_b128 v[112:115], v2 offset:53248
    v_mfma_f32_16x16x32_bf16 v[24:27], v[76:79], a[172:175], v[24:27]
    v_exp_f32_e64 v21, v21
    v_mfma_f32_16x16x32_bf16 v[28:31], v[80:83], a[160:163], v[124:127]
    buffer_load_dwordx4 v[192:195], v8, s[28:31], s60 offen nt
    v_cvt_pk_bf16_f32 v50, v20, v21
    v_mfma_f32_16x16x32_bf16 v[28:31], v[84:87], a[164:167], v[28:31]
    v_exp_f32_e64 v22, v22
    v_mfma_f32_16x16x32_bf16 v[28:31], v[88:91], a[168:171], v[28:31]
    ds_read_b128 v[116:119], v2 offset:54272
    v_mfma_f32_16x16x32_bf16 v[28:31], v[92:95], a[172:175], v[28:31]
    v_exp_f32_e64 v23, v23
    v_mfma_f32_16x16x32_bf16 a[96:99], v[60:63], v[128:131], a[96:99]
    v_cvt_pk_bf16_f32 v51, v22, v23
    v_mfma_f32_16x16x32_bf16 a[100:103], v[60:63], v[132:135], a[100:103]
    v_mfma_f32_16x16x32_bf16 a[104:107], v[60:63], v[136:139], a[104:107]
    v_exp_f32_e64 v24, v24
    v_mfma_f32_16x16x32_bf16 a[108:111], v[60:63], v[140:143], a[108:111]
    ds_read_b128 a[248:251], v2 offset:55296
    v_mfma_f32_16x16x32_bf16 a[112:115], v[60:63], v[144:147], a[112:115]
    v_exp_f32_e64 v25, v25
    v_mfma_f32_16x16x32_bf16 a[116:119], v[60:63], v[148:151], a[116:119]
    buffer_load_dwordx4 v[196:199], v8, s[28:31], s60 offen offset:512 nt
    v_cvt_pk_bf16_f32 v52, v24, v25
    v_mfma_f32_16x16x32_bf16 a[120:123], v[60:63], v[152:155], a[120:123]
    v_exp_f32_e64 v26, v26
    v_mfma_f32_16x16x32_bf16 a[124:127], v[60:63], v[156:159], a[124:127]
    ds_read_b128 a[252:255], v2 offset:56320
    s_waitcnt lgkmcnt(8)
    v_mfma_f32_16x16x32_bf16 a[140:143], v[60:63], a[244:247], a[140:143]
    v_exp_f32_e32 v27, v27
    v_mfma_f32_16x16x32_bf16 v[32:35], v[64:67], a[176:179], v[120:123]
    v_cvt_pk_bf16_f32 v53, v26, v27
    v_mfma_f32_16x16x32_bf16 v[32:35], v[68:71], a[180:183], v[32:35]
    v_exp_f32_e64 v28, v28
    v_mfma_f32_16x16x32_bf16 v[32:35], v[72:75], a[184:187], v[32:35]
    ds_read_b128 v[128:131], v2 offset:57344
    v_mfma_f32_16x16x32_bf16 v[32:35], v[76:79], a[188:191], v[32:35]
    v_exp_f32_e64 v29, v29
    v_mfma_f32_16x16x32_bf16 v[36:39], v[80:83], a[176:179], v[124:127]
    buffer_load_dwordx4 v[200:203], v8, s[28:31], s60 offen offset:1024 nt
    v_cvt_pk_bf16_f32 v54, v28, v29
    v_mfma_f32_16x16x32_bf16 v[36:39], v[84:87], a[180:183], v[36:39]
    v_exp_f32_e64 v30, v30
    v_mfma_f32_16x16x32_bf16 v[36:39], v[88:91], a[184:187], v[36:39]
    ds_read_b128 v[132:135], v2 offset:58368
    v_mfma_f32_16x16x32_bf16 v[36:39], v[92:95], a[188:191], v[36:39]
    v_exp_f32_e64 v31, v31
    v_mfma_f32_16x16x32_bf16 a[0:3], v[48:51], a[208:211], a[0:3]
    v_cvt_pk_bf16_f32 v55, v30, v31
    v_mfma_f32_16x16x32_bf16 a[4:7], v[48:51], a[212:215], a[4:7]
    v_mfma_f32_16x16x32_bf16 a[8:11], v[48:51], a[216:219], a[8:11]
    v_exp_f32_e64 v32, v32
    v_mfma_f32_16x16x32_bf16 a[12:15], v[48:51], a[220:223], a[12:15]
    ds_read_b128 v[136:139], v2 offset:59392
    buffer_load_dwordx4 v[204:207], v8, s[28:31], s60 offen offset:1536 nt
    v_mfma_f32_16x16x32_bf16 a[16:19], v[48:51], a[224:227], a[16:19]
    v_exp_f32_e64 v33, v33
    v_mfma_f32_16x16x32_bf16 a[20:23], v[48:51], a[228:231], a[20:23]
    v_cvt_pk_bf16_f32 v56, v32, v33
    v_mfma_f32_16x16x32_bf16 a[24:27], v[48:51], a[232:235], a[24:27]
    v_exp_f32_e64 v34, v34
    v_mfma_f32_16x16x32_bf16 a[28:31], v[48:51], a[236:239], a[28:31]
    ds_read_b128 v[140:143], v2 offset:60416
    v_mfma_f32_16x16x32_bf16 a[128:131], v[48:51], a[240:243], a[128:131]
    v_exp_f32_e64 v35, v35
    v_mfma_f32_16x16x32_bf16 v[40:43], v[64:67], a[192:195], v[120:123]
    v_cvt_pk_bf16_f32 v57, v34, v35
    v_mfma_f32_16x16x32_bf16 v[40:43], v[68:71], a[196:199], v[40:43]
    v_exp_f32_e64 v36, v36
    v_mfma_f32_16x16x32_bf16 v[40:43], v[72:75], a[200:203], v[40:43]
    ds_read_b128 v[144:147], v2 offset:61440
    s_add_u32 s67, s60, 0x2000
    v_mfma_f32_16x16x32_bf16 v[40:43], v[76:79], a[204:207], v[40:43]
    v_exp_f32_e64 v37, v37
    v_mfma_f32_16x16x32_bf16 v[44:47], v[80:83], a[192:195], v[124:127]
    ds_read_b128 v[120:123], v1 offset:384
    buffer_load_dwordx4 v[208:211], v8, s[28:31], s67 offen nt
    v_cvt_pk_bf16_f32 v58, v36, v37
    v_mfma_f32_16x16x32_bf16 v[44:47], v[84:87], a[196:199], v[44:47]
    v_exp_f32_e64 v38, v38
    v_mfma_f32_16x16x32_bf16 v[44:47], v[88:91], a[200:203], v[44:47]
    ds_read_b128 v[148:151], v2 offset:62464
    v_mfma_f32_16x16x32_bf16 v[44:47], v[92:95], a[204:207], v[44:47]
    v_exp_f32_e64 v39, v39
    v_mfma_f32_16x16x32_bf16 a[32:35], v[52:55], a[208:211], a[32:35]
    ds_read_b128 v[124:127], v1 offset:448
    v_cvt_pk_bf16_f32 v59, v38, v39
    v_mfma_f32_16x16x32_bf16 a[36:39], v[52:55], a[212:215], a[36:39]
    v_mfma_f32_16x16x32_bf16 a[40:43], v[52:55], a[216:219], a[40:43]
    v_exp_f32_e64 v40, v40
    v_mfma_f32_16x16x32_bf16 a[44:47], v[52:55], a[220:223], a[44:47]
    ds_read_b128 v[152:155], v2 offset:63488
    buffer_load_dwordx4 v[212:215], v8, s[28:31], s67 offen offset:512 nt
    v_mfma_f32_16x16x32_bf16 a[48:51], v[52:55], a[224:227], a[48:51]
    v_exp_f32_e64 v41, v41
    v_mfma_f32_16x16x32_bf16 a[52:55], v[52:55], a[228:231], a[52:55]
    ds_read2_b64 a[244:247], v14 offset0:96 offset1:100
    v_cvt_pk_bf16_f32 v60, v40, v41
    s_waitcnt vmcnt(16)
    v_mfma_f32_16x16x32_bf16 a[56:59], v[52:55], a[232:235], a[56:59]
    v_exp_f32_e32 v42, v42
    v_mfma_f32_16x16x32_bf16 a[60:63], v[52:55], a[236:239], a[60:63]
    ds_read_b128 v[156:159], v2 offset:64512
    s_waitcnt vmcnt(27) lgkmcnt(5)
    v_mfma_f32_16x16x32_bf16 a[132:135], v[52:55], a[240:243], a[132:135]
    v_exp_f32_e32 v43, v43
    v_mfma_f32_16x16x32_bf16 v[16:19], v[96:99], a[144:147], v[120:123]
    s_barrier
    v_cvt_pk_bf16_f32 v61, v42, v43
    v_mfma_f32_16x16x32_bf16 v[16:19], v[100:103], a[148:151], v[16:19]
    v_exp_f32_e32 v44, v44
    v_mfma_f32_16x16x32_bf16 v[16:19], v[104:107], a[152:155], v[16:19]
    ds_read_b128 v[64:67], v3
    buffer_load_dwordx4 v[216:219], v8, s[28:31], s67 offen offset:1024 nt
    s_waitcnt lgkmcnt(4)
    v_mfma_f32_16x16x32_bf16 v[16:19], v[108:111], a[156:159], v[16:19]
    v_exp_f32_e32 v45, v45
    v_mfma_f32_16x16x32_bf16 v[20:23], v[112:115], a[144:147], v[124:127]
    v_cvt_pk_bf16_f32 v62, v44, v45
    v_lshlrev_b32_e32 v240, 16, v224
    v_lshlrev_b32_e32 v248, 16, v228
    v_mfma_f32_16x16x32_bf16 v[20:23], v[116:119], a[148:151], v[20:23]
    v_exp_f32_e64 v46, v46
    v_mfma_f32_16x16x32_bf16 v[20:23], a[248:251], a[152:155], v[20:23]
    ds_read_b128 v[68:71], v3 offset:1024
    v_and_b32_e32 v241, 0xffff0000, v224
    v_and_b32_e32 v249, 0xffff0000, v228
    v_mfma_f32_16x16x32_bf16 v[20:23], a[252:255], a[156:159], v[20:23]
    v_exp_f32_e64 v47, v47
    v_mfma_f32_16x16x32_bf16 a[64:67], v[56:59], a[208:211], a[64:67]
    v_cvt_pk_bf16_f32 v63, v46, v47
    v_lshlrev_b32_e32 v242, 16, v225
    v_lshlrev_b32_e32 v250, 16, v229
    v_mfma_f32_16x16x32_bf16 a[68:71], v[56:59], a[212:215], a[68:71]
    buffer_load_dwordx4 v[220:223], v8, s[28:31], s67 offen offset:1536 nt
    v_and_b32_e32 v243, 0xffff0000, v225
    v_and_b32_e32 v251, 0xffff0000, v229
    v_mfma_f32_16x16x32_bf16 a[72:75], v[56:59], a[216:219], a[72:75]
    v_exp_f32_e64 v16, v16
    v_mfma_f32_16x16x32_bf16 a[76:79], v[56:59], a[220:223], a[76:79]
    ds_read_b128 v[72:75], v3 offset:2048
    v_lshlrev_b32_e32 v244, 16, v226
    v_lshlrev_b32_e32 v252, 16, v230
    v_mfma_f32_16x16x32_bf16 a[80:83], v[56:59], a[224:227], a[80:83]
    v_exp_f32_e64 v17, v17
    v_mfma_f32_16x16x32_bf16 a[84:87], v[56:59], a[228:231], a[84:87]
    v_cvt_pk_bf16_f32 v48, v16, v17
    v_and_b32_e32 v245, 0xffff0000, v226
    v_and_b32_e32 v253, 0xffff0000, v230
    v_mfma_f32_16x16x32_bf16 a[88:91], v[56:59], a[232:235], a[88:91]
    v_exp_f32_e64 v18, v18
    v_mfma_f32_16x16x32_bf16 a[92:95], v[56:59], a[236:239], a[92:95]
    ds_read_b128 v[76:79], v3 offset:3072
    v_lshlrev_b32_e32 v246, 16, v227
    v_lshlrev_b32_e32 v254, 16, v231
    v_mfma_f32_16x16x32_bf16 a[136:139], v[56:59], a[240:243], a[136:139]
    v_exp_f32_e64 v19, v19
    v_mfma_f32_16x16x32_bf16 v[24:27], v[96:99], a[160:163], v[120:123]
    v_cvt_pk_bf16_f32 v49, v18, v19
    v_and_b32_e32 v247, 0xffff0000, v227
    v_and_b32_e32 v255, 0xffff0000, v231
    v_mfma_f32_16x16x32_bf16 v[24:27], v[100:103], a[164:167], v[24:27]
    v_exp_f32_e64 v20, v20
    v_mfma_f32_16x16x32_bf16 v[24:27], v[104:107], a[168:171], v[24:27]
    ds_read_b128 v[80:83], v3 offset:4096
    v_mul_f32_e32 v240, s69, v240
    v_mul_f32_e32 v241, s69, v241
    v_mfma_f32_16x16x32_bf16 v[24:27], v[108:111], a[172:175], v[24:27]
    v_exp_f32_e64 v21, v21
    v_mfma_f32_16x16x32_bf16 v[28:31], v[112:115], a[160:163], v[124:127]
    v_cvt_pk_bf16_f32 v50, v20, v21
    v_mul_f32_e32 v242, s69, v242
    v_mul_f32_e32 v243, s69, v243
    v_mfma_f32_16x16x32_bf16 v[28:31], v[116:119], a[164:167], v[28:31]
    v_exp_f32_e64 v22, v22
    v_mfma_f32_16x16x32_bf16 v[28:31], a[248:251], a[168:171], v[28:31]
    ds_read_b128 v[84:87], v3 offset:5120
    v_mul_f32_e32 v244, s69, v244
    v_mul_f32_e32 v245, s69, v245
    v_mfma_f32_16x16x32_bf16 v[28:31], a[252:255], a[172:175], v[28:31]
    v_exp_f32_e64 v23, v23
    v_mfma_f32_16x16x32_bf16 a[96:99], v[60:63], a[208:211], a[96:99]
    v_cvt_pk_bf16_f32 v51, v22, v23
    v_mul_f32_e32 v246, s69, v246
    v_mul_f32_e32 v247, s69, v247
    v_mfma_f32_16x16x32_bf16 a[100:103], v[60:63], a[212:215], a[100:103]
    v_mul_f32_e64 v248, -v240, v248
    v_mul_f32_e64 v249, -v241, v249
    v_mul_f32_e64 v250, -v242, v250
    v_mfma_f32_16x16x32_bf16 a[104:107], v[60:63], a[216:219], a[104:107]
    v_exp_f32_e64 v24, v24
    v_mfma_f32_16x16x32_bf16 a[108:111], v[60:63], a[220:223], a[108:111]
    ds_read_b128 v[88:91], v3 offset:6144
    v_mul_f32_e64 v251, -v243, v251
    v_mul_f32_e64 v252, -v244, v252
    v_mfma_f32_16x16x32_bf16 a[112:115], v[60:63], a[224:227], a[112:115]
    v_exp_f32_e64 v25, v25
    v_mfma_f32_16x16x32_bf16 a[116:119], v[60:63], a[228:231], a[116:119]
    v_cvt_pk_bf16_f32 v52, v24, v25
    v_mul_f32_e64 v253, -v245, v253
    v_mul_f32_e64 v254, -v246, v254
    v_mfma_f32_16x16x32_bf16 a[120:123], v[60:63], a[232:235], a[120:123]
    v_exp_f32_e64 v26, v26
    v_mfma_f32_16x16x32_bf16 a[124:127], v[60:63], a[236:239], a[124:127]
    ds_read_b128 v[92:95], v3 offset:7168
    s_waitcnt lgkmcnt(8)
    v_mul_f32_e64 v255, -v247, v255
    v_mfma_f32_16x16x32_bf16 a[140:143], v[60:63], a[240:243], a[140:143]
    v_exp_f32_e32 v27, v27
    v_mfma_f32_16x16x32_bf16 v[32:35], v[96:99], a[176:179], v[120:123]
    v_cvt_pk_bf16_f32 v53, v26, v27
    s_waitcnt vmcnt(10)
    v_cvt_f32_i32_e32 v160, v160
    v_mfma_f32_16x16x32_bf16 v[32:35], v[100:103], a[180:183], v[32:35]
    v_exp_f32_e64 v28, v28
    v_mfma_f32_16x16x32_bf16 v[32:35], v[104:107], a[184:187], v[32:35]
    ds_read_b128 a[208:211], v3 offset:8192
    v_cvt_f32_i32_e32 v161, v161
    v_cvt_f32_i32_e32 v162, v162
    v_mfma_f32_16x16x32_bf16 v[32:35], v[108:111], a[188:191], v[32:35]
    v_exp_f32_e64 v29, v29
    v_mfma_f32_16x16x32_bf16 v[36:39], v[112:115], a[176:179], v[124:127]
    v_cvt_pk_bf16_f32 v54, v28, v29
    v_cvt_f32_i32_e32 v163, v163
    v_cvt_f32_i32_e32 v164, v164
    v_mfma_f32_16x16x32_bf16 v[36:39], v[116:119], a[180:183], v[36:39]
    v_exp_f32_e64 v30, v30
    v_mfma_f32_16x16x32_bf16 v[36:39], a[248:251], a[184:187], v[36:39]
    ds_read_b128 a[212:215], v3 offset:9216
    v_cvt_f32_i32_e32 v165, v165
    v_cvt_f32_i32_e32 v166, v166
    v_mfma_f32_16x16x32_bf16 v[36:39], a[252:255], a[188:191], v[36:39]
    v_exp_f32_e64 v31, v31
    v_mfma_f32_16x16x32_bf16 a[0:3], v[48:51], v[128:131], a[0:3]
    v_cvt_pk_bf16_f32 v55, v30, v31
    v_cvt_f32_i32_e64 v167, v167
    v_fma_f32 v160, v160, v240, v248
    v_mfma_f32_16x16x32_bf16 a[4:7], v[48:51], v[132:135], a[4:7]
    v_fma_f32 v161, v161, v241, v249
    v_fma_f32 v162, v162, v242, v250
    v_fma_f32 v163, v163, v243, v251
    v_mfma_f32_16x16x32_bf16 a[8:11], v[48:51], v[136:139], a[8:11]
    v_exp_f32_e64 v32, v32
    v_mfma_f32_16x16x32_bf16 a[12:15], v[48:51], v[140:143], a[12:15]
    ds_read_b128 a[216:219], v3 offset:10240
    v_fma_f32 v164, v164, v244, v252
    v_fma_f32 v165, v165, v245, v253
    v_mfma_f32_16x16x32_bf16 a[16:19], v[48:51], v[144:147], a[16:19]
    v_exp_f32_e64 v33, v33
    v_mfma_f32_16x16x32_bf16 a[20:23], v[48:51], v[148:151], a[20:23]
    v_cvt_pk_bf16_f32 v56, v32, v33
    v_fma_f32 v166, v166, v246, v254
    v_fma_f32 v167, v167, v247, v255
    v_mfma_f32_16x16x32_bf16 a[24:27], v[48:51], v[152:155], a[24:27]
    v_exp_f32_e64 v34, v34
    v_mfma_f32_16x16x32_bf16 a[28:31], v[48:51], v[156:159], a[28:31]
    ds_read_b128 a[220:223], v3 offset:11264
    v_cvt_pk_bf16_f32 v160, v160, v161
    v_cvt_pk_bf16_f32 v161, v162, v163
    v_mfma_f32_16x16x32_bf16 a[128:131], v[48:51], a[244:247], a[128:131]
    v_exp_f32_e64 v35, v35
    v_mfma_f32_16x16x32_bf16 v[40:43], v[96:99], a[192:195], v[120:123]
    v_cvt_pk_bf16_f32 v57, v34, v35
    v_cvt_pk_bf16_f32 v162, v164, v165
    v_cvt_pk_bf16_f32 v163, v166, v167
    v_mfma_f32_16x16x32_bf16 v[40:43], v[100:103], a[196:199], v[40:43]
    v_exp_f32_e64 v36, v36
    v_mfma_f32_16x16x32_bf16 v[40:43], v[104:107], a[200:203], v[40:43]
    ds_read_b128 a[224:227], v3 offset:12288
    buffer_store_dwordx4 v[160:163], v6, s[20:23], s60 offen sc1
    v_mfma_f32_16x16x32_bf16 v[40:43], v[108:111], a[204:207], v[40:43]
    v_exp_f32_e64 v37, v37
    v_mfma_f32_16x16x32_bf16 v[44:47], v[112:115], a[192:195], v[124:127]
    ds_read_b128 v[120:123], v1 offset:512
    v_cvt_pk_bf16_f32 v58, v36, v37
    v_cvt_f32_i32_e64 v168, v168
    v_mfma_f32_16x16x32_bf16 v[44:47], v[116:119], a[196:199], v[44:47]
    v_exp_f32_e64 v38, v38
    v_mfma_f32_16x16x32_bf16 v[44:47], a[248:251], a[200:203], v[44:47]
    ds_read_b128 a[228:231], v3 offset:13312
    v_cvt_f32_i32_e32 v169, v169
    v_cvt_f32_i32_e32 v170, v170
    v_mfma_f32_16x16x32_bf16 v[44:47], a[252:255], a[204:207], v[44:47]
    v_exp_f32_e64 v39, v39
    v_mfma_f32_16x16x32_bf16 a[32:35], v[52:55], v[128:131], a[32:35]
    ds_read_b128 v[124:127], v1 offset:576
    v_cvt_pk_bf16_f32 v59, v38, v39
    v_cvt_f32_i32_e64 v171, v171
    v_mfma_f32_16x16x32_bf16 a[36:39], v[52:55], v[132:135], a[36:39]
    v_cvt_f32_i32_e32 v172, v172
    v_cvt_f32_i32_e32 v173, v173
    v_cvt_f32_i32_e64 v174, v174
    v_mfma_f32_16x16x32_bf16 a[40:43], v[52:55], v[136:139], a[40:43]
    v_exp_f32_e64 v40, v40
    v_mfma_f32_16x16x32_bf16 a[44:47], v[52:55], v[140:143], a[44:47]
    ds_read_b128 a[232:235], v3 offset:14336
    v_cvt_f32_i32_e64 v175, v175
    v_fma_f32 v168, v168, v240, v248
    v_mfma_f32_16x16x32_bf16 a[48:51], v[52:55], v[144:147], a[48:51]
    v_exp_f32_e64 v41, v41
    v_mfma_f32_16x16x32_bf16 a[52:55], v[52:55], v[148:151], a[52:55]
    ds_read2_b64 a[240:243], v14 offset0:128 offset1:132
    v_cvt_pk_bf16_f32 v60, v40, v41
    v_fma_f32 v169, v169, v241, v249
    v_mfma_f32_16x16x32_bf16 a[56:59], v[52:55], v[152:155], a[56:59]
    v_exp_f32_e64 v42, v42
    v_mfma_f32_16x16x32_bf16 a[60:63], v[52:55], v[156:159], a[60:63]
    ds_read_b128 a[236:239], v3 offset:15360
    s_waitcnt lgkmcnt(5)
    v_mfma_f32_16x16x32_bf16 a[132:135], v[52:55], a[244:247], a[132:135]
    v_exp_f32_e32 v43, v43
    v_mfma_f32_16x16x32_bf16 v[16:19], v[64:67], a[144:147], v[120:123]
    v_cvt_pk_bf16_f32 v61, v42, v43
    v_mfma_f32_16x16x32_bf16 v[16:19], v[68:71], a[148:151], v[16:19]
    v_exp_f32_e64 v44, v44
    v_mfma_f32_16x16x32_bf16 v[16:19], v[72:75], a[152:155], v[16:19]
    ds_read_b128 v[96:99], v3 offset:16384
    s_waitcnt lgkmcnt(4)
    v_fma_f32 v170, v170, v242, v250
    v_mfma_f32_16x16x32_bf16 v[16:19], v[76:79], a[156:159], v[16:19]
    v_exp_f32_e32 v45, v45
    v_mfma_f32_16x16x32_bf16 v[20:23], v[80:83], a[144:147], v[124:127]
    v_cvt_pk_bf16_f32 v62, v44, v45
    v_fma_f32 v171, v171, v243, v251
    v_fma_f32 v172, v172, v244, v252
    v_mfma_f32_16x16x32_bf16 v[20:23], v[84:87], a[148:151], v[20:23]
    v_exp_f32_e64 v46, v46
    v_mfma_f32_16x16x32_bf16 v[20:23], v[88:91], a[152:155], v[20:23]
    ds_read_b128 v[100:103], v3 offset:17408
    v_fma_f32 v173, v173, v245, v253
    v_fma_f32 v174, v174, v246, v254
    v_mfma_f32_16x16x32_bf16 v[20:23], v[92:95], a[156:159], v[20:23]
    v_exp_f32_e64 v47, v47
    v_mfma_f32_16x16x32_bf16 a[64:67], v[56:59], v[128:131], a[64:67]
    v_cvt_pk_bf16_f32 v63, v46, v47
    v_fma_f32 v175, v175, v247, v255
    v_cvt_pk_bf16_f32 v168, v168, v169
    v_mfma_f32_16x16x32_bf16 a[68:71], v[56:59], v[132:135], a[68:71]
    v_cvt_pk_bf16_f32 v169, v170, v171
    v_cvt_pk_bf16_f32 v170, v172, v173
    v_cvt_pk_bf16_f32 v171, v174, v175
    v_mfma_f32_16x16x32_bf16 a[72:75], v[56:59], v[136:139], a[72:75]
    v_exp_f32_e64 v16, v16
    v_mfma_f32_16x16x32_bf16 a[76:79], v[56:59], v[140:143], a[76:79]
    ds_read_b128 v[104:107], v3 offset:18432
    buffer_store_dwordx4 v[168:171], v6, s[20:23], s60 offen offset:128 sc1
    v_mfma_f32_16x16x32_bf16 a[80:83], v[56:59], v[144:147], a[80:83]
    v_exp_f32_e64 v17, v17
    v_mfma_f32_16x16x32_bf16 a[84:87], v[56:59], v[148:151], a[84:87]
    v_cvt_pk_bf16_f32 v48, v16, v17
    v_cvt_f32_i32_e32 v176, v176
    v_cvt_f32_i32_e32 v177, v177
    v_mfma_f32_16x16x32_bf16 a[88:91], v[56:59], v[152:155], a[88:91]
    v_exp_f32_e64 v18, v18
    v_mfma_f32_16x16x32_bf16 a[92:95], v[56:59], v[156:159], a[92:95]
    ds_read_b128 v[108:111], v3 offset:19456
    v_cvt_f32_i32_e32 v178, v178
    v_cvt_f32_i32_e32 v179, v179
    v_mfma_f32_16x16x32_bf16 a[136:139], v[56:59], a[244:247], a[136:139]
    v_exp_f32_e64 v19, v19
    v_mfma_f32_16x16x32_bf16 v[24:27], v[64:67], a[160:163], v[120:123]
    v_cvt_pk_bf16_f32 v49, v18, v19
    v_cvt_f32_i32_e32 v180, v180
    v_cvt_f32_i32_e32 v181, v181
    v_mfma_f32_16x16x32_bf16 v[24:27], v[68:71], a[164:167], v[24:27]
    v_exp_f32_e64 v20, v20
    v_mfma_f32_16x16x32_bf16 v[24:27], v[72:75], a[168:171], v[24:27]
    ds_read_b128 v[112:115], v3 offset:20480
    v_cvt_f32_i32_e32 v182, v182
    v_cvt_f32_i32_e32 v183, v183
    v_mfma_f32_16x16x32_bf16 v[24:27], v[76:79], a[172:175], v[24:27]
    v_exp_f32_e64 v21, v21
    v_mfma_f32_16x16x32_bf16 v[28:31], v[80:83], a[160:163], v[124:127]
    v_cvt_pk_bf16_f32 v50, v20, v21
    v_fma_f32 v176, v176, v240, v248
    v_fma_f32 v177, v177, v241, v249
    v_mfma_f32_16x16x32_bf16 v[28:31], v[84:87], a[164:167], v[28:31]
    v_exp_f32_e64 v22, v22
    v_mfma_f32_16x16x32_bf16 v[28:31], v[88:91], a[168:171], v[28:31]
    ds_read_b128 v[116:119], v3 offset:21504
    v_fma_f32 v178, v178, v242, v250
    v_fma_f32 v179, v179, v243, v251
    v_mfma_f32_16x16x32_bf16 v[28:31], v[92:95], a[172:175], v[28:31]
    v_exp_f32_e64 v23, v23
    v_mfma_f32_16x16x32_bf16 a[96:99], v[60:63], v[128:131], a[96:99]
    v_cvt_pk_bf16_f32 v51, v22, v23
    v_fma_f32 v180, v180, v244, v252
    v_fma_f32 v181, v181, v245, v253
    v_mfma_f32_16x16x32_bf16 a[100:103], v[60:63], v[132:135], a[100:103]
    v_fma_f32 v182, v182, v246, v254
    v_fma_f32 v183, v183, v247, v255
    v_cvt_pk_bf16_f32 v176, v176, v177
    v_mfma_f32_16x16x32_bf16 a[104:107], v[60:63], v[136:139], a[104:107]
    v_exp_f32_e64 v24, v24
    v_mfma_f32_16x16x32_bf16 a[108:111], v[60:63], v[140:143], a[108:111]
    ds_read_b128 a[248:251], v3 offset:22528
    v_cvt_pk_bf16_f32 v177, v178, v179
    v_cvt_pk_bf16_f32 v178, v180, v181
    v_mfma_f32_16x16x32_bf16 a[112:115], v[60:63], v[144:147], a[112:115]
    v_exp_f32_e64 v25, v25
    v_mfma_f32_16x16x32_bf16 a[116:119], v[60:63], v[148:151], a[116:119]
    v_cvt_pk_bf16_f32 v52, v24, v25
    v_cvt_pk_bf16_f32 v179, v182, v183
    s_add_u32 s68, s60, 0x1000
    v_mfma_f32_16x16x32_bf16 a[120:123], v[60:63], v[152:155], a[120:123]
    v_exp_f32_e64 v26, v26
    v_mfma_f32_16x16x32_bf16 a[124:127], v[60:63], v[156:159], a[124:127]
    ds_read_b128 a[252:255], v3 offset:23552
    buffer_store_dwordx4 v[176:179], v6, s[20:23], s68 offen sc1
    s_waitcnt lgkmcnt(8)
    v_mfma_f32_16x16x32_bf16 a[140:143], v[60:63], a[244:247], a[140:143]
    v_exp_f32_e32 v27, v27
    v_mfma_f32_16x16x32_bf16 v[32:35], v[64:67], a[176:179], v[120:123]
    v_cvt_pk_bf16_f32 v53, v26, v27
    v_cvt_f32_i32_e32 v184, v184
    v_cvt_f32_i32_e32 v185, v185
    v_mfma_f32_16x16x32_bf16 v[32:35], v[68:71], a[180:183], v[32:35]
    v_exp_f32_e64 v28, v28
    v_mfma_f32_16x16x32_bf16 v[32:35], v[72:75], a[184:187], v[32:35]
    ds_read_b128 v[128:131], v3 offset:24576
    v_cvt_f32_i32_e32 v186, v186
    v_cvt_f32_i32_e32 v187, v187
    v_mfma_f32_16x16x32_bf16 v[32:35], v[76:79], a[188:191], v[32:35]
    v_exp_f32_e64 v29, v29
    v_mfma_f32_16x16x32_bf16 v[36:39], v[80:83], a[176:179], v[124:127]
    v_cvt_pk_bf16_f32 v54, v28, v29
    v_cvt_f32_i32_e32 v188, v188
    v_cvt_f32_i32_e32 v189, v189
    v_mfma_f32_16x16x32_bf16 v[36:39], v[84:87], a[180:183], v[36:39]
    v_exp_f32_e64 v30, v30
    v_mfma_f32_16x16x32_bf16 v[36:39], v[88:91], a[184:187], v[36:39]
    ds_read_b128 v[132:135], v3 offset:25600
    v_cvt_f32_i32_e32 v190, v190
    v_cvt_f32_i32_e32 v191, v191
    v_mfma_f32_16x16x32_bf16 v[36:39], v[92:95], a[188:191], v[36:39]
    v_exp_f32_e64 v31, v31
    v_mfma_f32_16x16x32_bf16 a[0:3], v[48:51], a[208:211], a[0:3]
    v_cvt_pk_bf16_f32 v55, v30, v31
    v_fma_f32 v184, v184, v240, v248
    v_fma_f32 v185, v185, v241, v249
    v_mfma_f32_16x16x32_bf16 a[4:7], v[48:51], a[212:215], a[4:7]
    s_add_u32 s56, s74, s58
    s_add_u32 s55, s56, 0x4000
    v_fma_f32 v186, v186, v242, v250
    v_mfma_f32_16x16x32_bf16 a[8:11], v[48:51], a[216:219], a[8:11]
    v_exp_f32_e32 v32, v32
    v_mfma_f32_16x16x32_bf16 a[12:15], v[48:51], a[220:223], a[12:15]
    ds_read_b128 v[136:139], v3 offset:26624
    v_fma_f32 v187, v187, v243, v251
    v_fma_f32 v188, v188, v244, v252
    v_mfma_f32_16x16x32_bf16 a[16:19], v[48:51], a[224:227], a[16:19]
    v_exp_f32_e64 v33, v33
    v_mfma_f32_16x16x32_bf16 a[20:23], v[48:51], a[228:231], a[20:23]
    v_cvt_pk_bf16_f32 v56, v32, v33
    v_fma_f32 v189, v189, v245, v253
    v_fma_f32 v190, v190, v246, v254
    v_mfma_f32_16x16x32_bf16 a[24:27], v[48:51], a[232:235], a[24:27]
    v_exp_f32_e64 v34, v34
    v_mfma_f32_16x16x32_bf16 a[28:31], v[48:51], a[236:239], a[28:31]
    ds_read_b128 v[140:143], v3 offset:27648
    v_fma_f32 v191, v191, v247, v255
    v_cvt_pk_bf16_f32 v184, v184, v185
    v_mfma_f32_16x16x32_bf16 a[128:131], v[48:51], a[240:243], a[128:131]
    v_exp_f32_e64 v35, v35
    v_mfma_f32_16x16x32_bf16 v[40:43], v[64:67], a[192:195], v[120:123]
    v_cvt_pk_bf16_f32 v57, v34, v35
    v_cvt_pk_bf16_f32 v185, v186, v187
    v_cvt_pk_bf16_f32 v186, v188, v189
    v_mfma_f32_16x16x32_bf16 v[40:43], v[68:71], a[196:199], v[40:43]
    v_exp_f32_e64 v36, v36
    v_mfma_f32_16x16x32_bf16 v[40:43], v[72:75], a[200:203], v[40:43]
    ds_read_b128 v[144:147], v3 offset:28672
    v_cvt_pk_bf16_f32 v187, v190, v191
    v_mfma_f32_16x16x32_bf16 v[40:43], v[76:79], a[204:207], v[40:43]
    v_exp_f32_e64 v37, v37
    v_mfma_f32_16x16x32_bf16 v[44:47], v[80:83], a[192:195], v[124:127]
    ds_read_b128 v[120:123], v1 offset:640
    buffer_store_dwordx4 v[184:187], v6, s[20:23], s68 offen offset:128 sc1
    v_cvt_pk_bf16_f32 v58, v36, v37
    v_mfma_f32_16x16x32_bf16 v[44:47], v[84:87], a[196:199], v[44:47]
    v_exp_f32_e64 v38, v38
    v_mfma_f32_16x16x32_bf16 v[44:47], v[88:91], a[200:203], v[44:47]
    ds_read_b128 v[148:151], v3 offset:29696
    s_waitcnt vmcnt(12)
    v_lshlrev_b32_e32 v240, 16, v232
    v_mfma_f32_16x16x32_bf16 v[44:47], v[92:95], a[204:207], v[44:47]
    v_exp_f32_e64 v39, v39
    v_mfma_f32_16x16x32_bf16 a[32:35], v[52:55], a[208:211], a[32:35]
    ds_read_b128 v[124:127], v1 offset:704
    v_cvt_pk_bf16_f32 v59, v38, v39
    v_mov_b32_dpp v246, v236 quad_perm:[1,1,3,3] row_mask:0xf bank_mask:0xf
    v_mfma_f32_16x16x32_bf16 a[36:39], v[52:55], a[212:215], a[36:39]
    s_mov_b32 m0, s88
    s_lshr_b32 s3, s56, 5
    v_mfma_f32_16x16x32_bf16 a[40:43], v[52:55], a[216:219], a[40:43]
    v_exp_f32_e64 v40, v40
    v_mfma_f32_16x16x32_bf16 a[44:47], v[52:55], a[220:223], a[44:47]
    ds_read_b128 v[152:155], v3 offset:30720
    v_log_f32_e64 v241, v240
    v_mfma_f32_16x16x32_bf16 a[48:51], v[52:55], a[224:227], a[48:51]
    v_exp_f32_e64 v41, v41
    v_mfma_f32_16x16x32_bf16 a[52:55], v[52:55], a[228:231], a[52:55]
    ds_read2_b64 a[244:247], v14 offset0:160 offset1:164
    v_cvt_pk_bf16_f32 v60, v40, v41
    v_cmp_lt_f32_e32 vcc, 0x2b800000, v240
    v_mfma_f32_16x16x32_bf16 a[56:59], v[52:55], a[232:235], a[56:59]
    v_exp_f32_e64 v42, v42
    v_mfma_f32_16x16x32_bf16 a[60:63], v[52:55], a[236:239], a[60:63]
    ds_read_b128 v[156:159], v3 offset:31744
    s_waitcnt vmcnt(24) lgkmcnt(5)
    v_mfma_f32_16x16x32_bf16 a[132:135], v[52:55], a[240:243], a[132:135]
    v_exp_f32_e32 v43, v43
    v_mfma_f32_16x16x32_bf16 v[16:19], v[96:99], a[144:147], v[120:123]
    s_barrier
    v_cvt_pk_bf16_f32 v61, v42, v43
    v_mfma_f32_16x16x32_bf16 v[16:19], v[100:103], a[148:151], v[16:19]
    v_exp_f32_e32 v44, v44
    v_mfma_f32_16x16x32_bf16 v[16:19], v[104:107], a[152:155], v[16:19]
    ds_read_b128 v[64:67], v3 offset:32768
    s_waitcnt lgkmcnt(4)
    v_mfma_f32_16x16x32_bf16 v[16:19], v[108:111], a[156:159], v[16:19]
    v_exp_f32_e32 v45, v45
    v_mfma_f32_16x16x32_bf16 v[20:23], v[112:115], a[144:147], v[124:127]
    buffer_load_dwordx4 v4, s[20:23], s56 offen sc1 lds
    v_cvt_pk_bf16_f32 v62, v44, v45
    v_mfma_f32_16x16x32_bf16 v[20:23], v[116:119], a[148:151], v[20:23]
    v_exp_f32_e64 v46, v46
    v_mfma_f32_16x16x32_bf16 v[20:23], a[248:251], a[152:155], v[20:23]
    ds_read_b128 v[68:71], v3 offset:33792
    v_rcp_f32_e64 v242, v240
    v_mfma_f32_16x16x32_bf16 v[20:23], a[252:255], a[156:159], v[20:23]
    v_exp_f32_e64 v47, v47
    v_mfma_f32_16x16x32_bf16 a[64:67], v[56:59], a[208:211], a[64:67]
    buffer_load_dwordx4 v4, s[20:23], s56 offen offset:1024 sc1 lds
    v_cvt_pk_bf16_f32 v63, v46, v47
    v_lshl_or_b32 v236, v246, 16, v236
    v_mfma_f32_16x16x32_bf16 a[68:71], v[56:59], a[212:215], a[68:71]
    buffer_load_dwordx4 v4, s[20:23], s56 offen offset:2048 sc1 lds
    v_cndmask_b32_e32 v241, -1, v241, vcc
    v_cmp_gt_f32_e32 vcc, 0x53800000, v240
    v_mfma_f32_16x16x32_bf16 a[72:75], v[56:59], a[216:219], a[72:75]
    v_exp_f32_e32 v16, v16
    v_mfma_f32_16x16x32_bf16 a[76:79], v[56:59], a[220:223], a[76:79]
    ds_read_b128 v[72:75], v3 offset:34816
    v_cvt_pk_bf16_f32 v243, v242, v242
    v_mov_b32_dpp v245, v242 quad_perm:[1,1,3,3] row_mask:0xf bank_mask:0xf
    v_mfma_f32_16x16x32_bf16 a[80:83], v[56:59], a[224:227], a[80:83]
    v_exp_f32_e64 v17, v17
    v_mfma_f32_16x16x32_bf16 a[84:87], v[56:59], a[228:231], a[84:87]
    buffer_load_dwordx4 v4, s[20:23], s56 offen offset:3072 sc1 lds
    v_cvt_pk_bf16_f32 v48, v16, v17
    v_cndmask_b32_e32 v241, -1, v241, vcc
    v_mfma_f32_16x16x32_bf16 a[88:91], v[56:59], a[232:235], a[88:91]
    v_exp_f32_e32 v18, v18
    v_mfma_f32_16x16x32_bf16 a[92:95], v[56:59], a[236:239], a[92:95]
    ds_read_b128 v[76:79], v3 offset:35840
    s_add_u32 m0, s88, 0x4000
    v_and_b32_e32 v243, 0xffff0000, v243
    v_mfma_f32_16x16x32_bf16 a[136:139], v[56:59], a[240:243], a[136:139]
    v_exp_f32_e64 v19, v19
    v_mfma_f32_16x16x32_bf16 v[24:27], v[96:99], a[160:163], v[120:123]
    buffer_load_dwordx4 v4, s[20:23], s55 offen sc1 lds
    v_cvt_pk_bf16_f32 v49, v18, v19
    v_sub_f32_e64 v244, v242, v243
    v_mfma_f32_16x16x32_bf16 v[24:27], v[100:103], a[164:167], v[24:27]
    v_exp_f32_e64 v20, v20
    v_mfma_f32_16x16x32_bf16 v[24:27], v[104:107], a[168:171], v[24:27]
    ds_read_b128 v[80:83], v3 offset:36864
    buffer_store_dword v241, v11, s[80:83], s89 offen sc1
    s_add_u32 s56, s75, s58
    v_mfma_f32_16x16x32_bf16 v[24:27], v[108:111], a[172:175], v[24:27]
    v_exp_f32_e32 v21, v21
    v_mfma_f32_16x16x32_bf16 v[28:31], v[112:115], a[160:163], v[124:127]
    buffer_load_dwordx4 v4, s[20:23], s55 offen offset:1024 sc1 lds
    v_cvt_pk_bf16_f32 v50, v20, v21
    v_cvt_pk_bf16_f32 v242, v242, v245
    v_mfma_f32_16x16x32_bf16 v[28:31], v[116:119], a[164:167], v[28:31]
    v_exp_f32_e64 v22, v22
    v_mfma_f32_16x16x32_bf16 v[28:31], a[248:251], a[168:171], v[28:31]
    ds_read_b128 v[84:87], v3 offset:37888
    buffer_store_dword v236, v7, s[80:83], s89 offen offset:144 sc1
    s_lshr_b32 s11, s56, 5
    v_mfma_f32_16x16x32_bf16 v[28:31], a[252:255], a[172:175], v[28:31]
    v_exp_f32_e32 v23, v23
    v_mfma_f32_16x16x32_bf16 a[96:99], v[60:63], a[208:211], a[96:99]
    buffer_load_dwordx4 v4, s[20:23], s55 offen offset:2048 sc1 lds
    v_cvt_pk_bf16_f32 v51, v22, v23
    v_mov_b32_dpp v246, v244 quad_perm:[1,1,3,3] row_mask:0xf bank_mask:0xf
    v_mfma_f32_16x16x32_bf16 a[100:103], v[60:63], a[212:215], a[100:103]
    buffer_load_dwordx4 v4, s[20:23], s55 offen offset:3072 sc1 lds
    buffer_store_dword v242, v7, s[80:83], s89 offen sc1
    v_mfma_f32_16x16x32_bf16 a[104:107], v[60:63], a[216:219], a[104:107]
    v_exp_f32_e64 v24, v24
    v_mfma_f32_16x16x32_bf16 a[108:111], v[60:63], a[220:223], a[108:111]
    ds_read_b128 v[88:91], v3 offset:38912
    s_mov_b32 m0, s10
    v_cvt_pk_bf16_f32 v244, v244, v246
    v_mfma_f32_16x16x32_bf16 a[112:115], v[60:63], a[224:227], a[112:115]
    v_exp_f32_e32 v25, v25
    v_mfma_f32_16x16x32_bf16 a[116:119], v[60:63], a[228:231], a[116:119]
    buffer_load_dword v15, s[80:83], s3 offen sc1 lds
    v_cvt_pk_bf16_f32 v52, v24, v25
    s_add_u32 m0, s88, 0x8000
    v_mfma_f32_16x16x32_bf16 a[120:123], v[60:63], a[232:235], a[120:123]
    v_exp_f32_e64 v26, v26
    v_mfma_f32_16x16x32_bf16 a[124:127], v[60:63], a[236:239], a[124:127]
    ds_read_b128 v[92:95], v3 offset:39936
    buffer_store_dword v244, v7, s[80:83], s89 offen offset:72 sc1
    s_waitcnt lgkmcnt(8)
    v_mfma_f32_16x16x32_bf16 a[140:143], v[60:63], a[240:243], a[140:143]
    v_exp_f32_e32 v27, v27
    v_mfma_f32_16x16x32_bf16 v[32:35], v[96:99], a[176:179], v[120:123]
    buffer_load_dwordx4 v4, s[20:23], s56 offen sc1 lds
    v_cvt_pk_bf16_f32 v53, v26, v27
    s_waitcnt vmcnt(18)
    v_mfma_f32_16x16x32_bf16 v[32:35], v[100:103], a[180:183], v[32:35]
    v_exp_f32_e32 v28, v28
    v_mfma_f32_16x16x32_bf16 v[32:35], v[104:107], a[184:187], v[32:35]
    ds_read_b128 a[208:211], v3 offset:40960
    buffer_load_dwordx4 v4, s[20:23], s56 offen offset:1024 sc1 lds
    s_add_u32 s55, s56, 0x4000
    v_mfma_f32_16x16x32_bf16 v[32:35], v[108:111], a[188:191], v[32:35]
    v_exp_f32_e64 v29, v29
    v_mfma_f32_16x16x32_bf16 v[36:39], v[112:115], a[176:179], v[124:127]
    buffer_load_dwordx4 v4, s[20:23], s56 offen offset:2048 sc1 lds
    v_cvt_pk_bf16_f32 v54, v28, v29
    v_cvt_f32_i32_e64 v192, v192
    v_mfma_f32_16x16x32_bf16 v[36:39], v[116:119], a[180:183], v[36:39]
    v_exp_f32_e64 v30, v30
    v_mfma_f32_16x16x32_bf16 v[36:39], a[248:251], a[184:187], v[36:39]
    ds_read_b128 a[212:215], v3 offset:41984
    buffer_load_dwordx4 v4, s[20:23], s56 offen offset:3072 sc1 lds
    s_add_u32 m0, s88, 0xc000
    v_mfma_f32_16x16x32_bf16 v[36:39], a[252:255], a[188:191], v[36:39]
    v_exp_f32_e64 v31, v31
    v_mfma_f32_16x16x32_bf16 a[0:3], v[48:51], v[128:131], a[0:3]
    buffer_load_dwordx4 v4, s[20:23], s55 offen sc1 lds
    v_cvt_pk_bf16_f32 v55, v30, v31
    v_cvt_f32_i32_e64 v196, v196
    v_mfma_f32_16x16x32_bf16 a[4:7], v[48:51], v[132:135], a[4:7]
    buffer_load_dwordx4 v4, s[20:23], s55 offen offset:1024 sc1 lds
    v_cvt_f32_i32_e32 v200, v200
    v_cvt_f32_i32_e32 v204, v204
    v_mfma_f32_16x16x32_bf16 a[8:11], v[48:51], v[136:139], a[8:11]
    v_exp_f32_e64 v32, v32
    v_mfma_f32_16x16x32_bf16 a[12:15], v[48:51], v[140:143], a[12:15]
    ds_read_b128 a[216:219], v3 offset:43008
    v_cvt_f32_i32_e32 v208, v208
    v_cvt_f32_i32_e32 v212, v212
    v_mfma_f32_16x16x32_bf16 a[16:19], v[48:51], v[144:147], a[16:19]
    v_exp_f32_e64 v33, v33
    v_mfma_f32_16x16x32_bf16 a[20:23], v[48:51], v[148:151], a[20:23]
    buffer_load_dwordx4 v4, s[20:23], s55 offen offset:2048 sc1 lds
    v_cvt_pk_bf16_f32 v56, v32, v33
    v_cvt_f32_i32_e64 v216, v216
    v_mfma_f32_16x16x32_bf16 a[24:27], v[48:51], v[152:155], a[24:27]
    v_exp_f32_e64 v34, v34
    v_mfma_f32_16x16x32_bf16 a[28:31], v[48:51], v[156:159], a[28:31]
    ds_read_b128 a[220:223], v3 offset:44032
    v_cvt_f32_i32_e64 v220, v220
    v_cvt_pk_bf16_f32 v160, v192, v196
    v_mfma_f32_16x16x32_bf16 a[128:131], v[48:51], a[244:247], a[128:131]
    v_exp_f32_e64 v35, v35
    v_mfma_f32_16x16x32_bf16 v[40:43], v[96:99], a[192:195], v[120:123]
    buffer_load_dwordx4 v4, s[20:23], s55 offen offset:3072 sc1 lds
    v_cvt_pk_bf16_f32 v57, v34, v35
    v_cvt_pk_bf16_f32 v161, v200, v204
    v_mfma_f32_16x16x32_bf16 v[40:43], v[100:103], a[196:199], v[40:43]
    v_exp_f32_e64 v36, v36
    v_mfma_f32_16x16x32_bf16 v[40:43], v[104:107], a[200:203], v[40:43]
    ds_read_b128 a[224:227], v3 offset:45056
    s_add_u32 m0, s10, s84
    v_cvt_pk_bf16_f32 v162, v208, v212
    v_mfma_f32_16x16x32_bf16 v[40:43], v[108:111], a[204:207], v[40:43]
    v_exp_f32_e32 v37, v37
    v_mfma_f32_16x16x32_bf16 v[44:47], v[112:115], a[192:195], v[124:127]
    ds_read_b128 v[120:123], v1 offset:768
    buffer_load_dword v15, s[80:83], s11 offen sc1 lds
    v_cvt_pk_bf16_f32 v58, v36, v37
    v_mfma_f32_16x16x32_bf16 v[44:47], v[116:119], a[196:199], v[44:47]
    v_exp_f32_e64 v38, v38
    v_mfma_f32_16x16x32_bf16 v[44:47], a[248:251], a[200:203], v[44:47]
    ds_read_b128 a[228:231], v3 offset:46080
    v_cvt_pk_bf16_f32 v163, v216, v220
    v_mfma_f32_16x16x32_bf16 v[44:47], a[252:255], a[204:207], v[44:47]
    v_exp_f32_e64 v39, v39
    v_mfma_f32_16x16x32_bf16 a[32:35], v[52:55], v[128:131], a[32:35]
    ds_read_b128 v[124:127], v1 offset:832
    buffer_store_dwordx4 v[160:163], v9, s[20:23], s60 offen sc1
    v_cvt_pk_bf16_f32 v59, v38, v39
    v_mfma_f32_16x16x32_bf16 a[36:39], v[52:55], v[132:135], a[36:39]
    v_cvt_f32_i32_e32 v193, v193
    v_cvt_f32_i32_e32 v197, v197
    v_cvt_f32_i32_e64 v201, v201
    v_mfma_f32_16x16x32_bf16 a[40:43], v[52:55], v[136:139], a[40:43]
    v_exp_f32_e64 v40, v40
    v_mfma_f32_16x16x32_bf16 a[44:47], v[52:55], v[140:143], a[44:47]
    ds_read_b128 a[232:235], v3 offset:47104
    v_cvt_f32_i32_e32 v205, v205
    v_cvt_f32_i32_e32 v209, v209
    v_mfma_f32_16x16x32_bf16 a[48:51], v[52:55], v[144:147], a[48:51]
    v_exp_f32_e64 v41, v41
    v_mfma_f32_16x16x32_bf16 a[52:55], v[52:55], v[148:151], a[52:55]
    ds_read2_b64 a[240:243], v14 offset0:192 offset1:196
    v_cvt_pk_bf16_f32 v60, v40, v41
    v_cvt_f32_i32_e64 v213, v213
    v_mfma_f32_16x16x32_bf16 a[56:59], v[52:55], v[152:155], a[56:59]
    v_exp_f32_e64 v42, v42
    v_mfma_f32_16x16x32_bf16 a[60:63], v[52:55], v[156:159], a[60:63]
    ds_read_b128 a[236:239], v3 offset:48128
    s_waitcnt lgkmcnt(5)
    v_mfma_f32_16x16x32_bf16 a[132:135], v[52:55], a[244:247], a[132:135]
    v_exp_f32_e32 v43, v43
    v_mfma_f32_16x16x32_bf16 v[16:19], v[64:67], a[144:147], v[120:123]
    v_cvt_pk_bf16_f32 v61, v42, v43
    v_mfma_f32_16x16x32_bf16 v[16:19], v[68:71], a[148:151], v[16:19]
    v_exp_f32_e64 v44, v44
    v_mfma_f32_16x16x32_bf16 v[16:19], v[72:75], a[152:155], v[16:19]
    ds_read_b128 v[96:99], v3 offset:49152
    s_waitcnt lgkmcnt(4)
    v_cvt_f32_i32_e32 v217, v217
    v_mfma_f32_16x16x32_bf16 v[16:19], v[76:79], a[156:159], v[16:19]
    v_exp_f32_e64 v45, v45
    v_mfma_f32_16x16x32_bf16 v[20:23], v[80:83], a[144:147], v[124:127]
    v_cvt_pk_bf16_f32 v62, v44, v45
    v_cvt_f32_i32_e64 v221, v221
    v_cvt_pk_bf16_f32 v164, v193, v197
    v_mfma_f32_16x16x32_bf16 v[20:23], v[84:87], a[148:151], v[20:23]
    v_exp_f32_e64 v46, v46
    v_mfma_f32_16x16x32_bf16 v[20:23], v[88:91], a[152:155], v[20:23]
    ds_read_b128 v[100:103], v3 offset:50176
    v_cvt_pk_bf16_f32 v165, v201, v205
    v_cvt_pk_bf16_f32 v166, v209, v213
    v_mfma_f32_16x16x32_bf16 v[20:23], v[92:95], a[156:159], v[20:23]
    v_exp_f32_e64 v47, v47
    v_mfma_f32_16x16x32_bf16 a[64:67], v[56:59], v[128:131], a[64:67]
    v_cvt_pk_bf16_f32 v63, v46, v47
    v_cvt_pk_bf16_f32 v167, v217, v221
    v_mfma_f32_16x16x32_bf16 a[68:71], v[56:59], v[132:135], a[68:71]
    buffer_store_dwordx4 v[164:167], v9, s[20:23], s60 offen offset:1024 sc1
    v_mfma_f32_16x16x32_bf16 a[72:75], v[56:59], v[136:139], a[72:75]
    v_exp_f32_e64 v16, v16
    v_mfma_f32_16x16x32_bf16 a[76:79], v[56:59], v[140:143], a[76:79]
    ds_read_b128 v[104:107], v3 offset:51200
    v_cvt_f32_i32_e32 v194, v194
    v_cvt_f32_i32_e32 v198, v198
    v_mfma_f32_16x16x32_bf16 a[80:83], v[56:59], v[144:147], a[80:83]
    v_exp_f32_e64 v17, v17
    v_mfma_f32_16x16x32_bf16 a[84:87], v[56:59], v[148:151], a[84:87]
    v_cvt_pk_bf16_f32 v48, v16, v17
    v_cvt_f32_i32_e32 v202, v202
    v_cvt_f32_i32_e32 v206, v206
    v_mfma_f32_16x16x32_bf16 a[88:91], v[56:59], v[152:155], a[88:91]
    v_exp_f32_e64 v18, v18
    v_mfma_f32_16x16x32_bf16 a[92:95], v[56:59], v[156:159], a[92:95]
    ds_read_b128 v[108:111], v3 offset:52224
    v_cvt_f32_i32_e32 v210, v210
    v_cvt_f32_i32_e32 v214, v214
    v_mfma_f32_16x16x32_bf16 a[136:139], v[56:59], a[244:247], a[136:139]
    v_exp_f32_e64 v19, v19
    v_mfma_f32_16x16x32_bf16 v[24:27], v[64:67], a[160:163], v[120:123]
    v_cvt_pk_bf16_f32 v49, v18, v19
    v_cvt_f32_i32_e32 v218, v218
    v_cvt_f32_i32_e32 v222, v222
    v_mfma_f32_16x16x32_bf16 v[24:27], v[68:71], a[164:167], v[24:27]
    v_exp_f32_e64 v20, v20
    v_mfma_f32_16x16x32_bf16 v[24:27], v[72:75], a[168:171], v[24:27]
    ds_read_b128 v[112:115], v3 offset:53248
    v_cvt_pk_bf16_f32 v168, v194, v198
    v_cvt_pk_bf16_f32 v169, v202, v206
    v_mfma_f32_16x16x32_bf16 v[24:27], v[76:79], a[172:175], v[24:27]
    v_exp_f32_e64 v21, v21
    v_mfma_f32_16x16x32_bf16 v[28:31], v[80:83], a[160:163], v[124:127]
    v_cvt_pk_bf16_f32 v50, v20, v21
    v_cvt_pk_bf16_f32 v170, v210, v214
    v_cvt_pk_bf16_f32 v171, v218, v222
    v_mfma_f32_16x16x32_bf16 v[28:31], v[84:87], a[164:167], v[28:31]
    v_exp_f32_e64 v22, v22
    v_mfma_f32_16x16x32_bf16 v[28:31], v[88:91], a[168:171], v[28:31]
    ds_read_b128 v[116:119], v3 offset:54272
    buffer_store_dwordx4 v[168:171], v9, s[20:23], s60 offen offset:2048 sc1
    v_mfma_f32_16x16x32_bf16 v[28:31], v[92:95], a[172:175], v[28:31]
    v_exp_f32_e64 v23, v23
    v_mfma_f32_16x16x32_bf16 a[96:99], v[60:63], v[128:131], a[96:99]
    v_cvt_pk_bf16_f32 v51, v22, v23
    v_cvt_f32_i32_e32 v195, v195
    v_cvt_f32_i32_e32 v199, v199
    v_mfma_f32_16x16x32_bf16 a[100:103], v[60:63], v[132:135], a[100:103]
    v_cvt_f32_i32_e32 v203, v203
    v_cvt_f32_i32_e32 v207, v207
    v_cvt_f32_i32_e64 v211, v211
    v_mfma_f32_16x16x32_bf16 a[104:107], v[60:63], v[136:139], a[104:107]
    v_exp_f32_e64 v24, v24
    v_mfma_f32_16x16x32_bf16 a[108:111], v[60:63], v[140:143], a[108:111]
    ds_read_b128 a[248:251], v3 offset:55296
    v_cvt_f32_i32_e32 v215, v215
    v_cvt_f32_i32_e32 v219, v219
    v_mfma_f32_16x16x32_bf16 a[112:115], v[60:63], v[144:147], a[112:115]
    v_exp_f32_e64 v25, v25
    v_mfma_f32_16x16x32_bf16 a[116:119], v[60:63], v[148:151], a[116:119]
    v_cvt_pk_bf16_f32 v52, v24, v25
    v_cvt_f32_i32_e64 v223, v223
    v_cvt_pk_bf16_f32 v172, v195, v199
    v_mfma_f32_16x16x32_bf16 a[120:123], v[60:63], v[152:155], a[120:123]
    v_exp_f32_e64 v26, v26
    v_mfma_f32_16x16x32_bf16 a[124:127], v[60:63], v[156:159], a[124:127]
    ds_read_b128 a[252:255], v3 offset:56320
    s_waitcnt lgkmcnt(8)
    v_cvt_pk_bf16_f32 v173, v203, v207
    v_mfma_f32_16x16x32_bf16 a[140:143], v[60:63], a[244:247], a[140:143]
    v_exp_f32_e32 v27, v27
    v_mfma_f32_16x16x32_bf16 v[32:35], v[64:67], a[176:179], v[120:123]
    v_cvt_pk_bf16_f32 v53, v26, v27
    v_cvt_pk_bf16_f32 v174, v211, v215
    v_cvt_pk_bf16_f32 v175, v219, v223
    v_mfma_f32_16x16x32_bf16 v[32:35], v[68:71], a[180:183], v[32:35]
    v_exp_f32_e64 v28, v28
    v_mfma_f32_16x16x32_bf16 v[32:35], v[72:75], a[184:187], v[32:35]
    ds_read_b128 v[128:131], v3 offset:57344
    buffer_store_dwordx4 v[172:175], v9, s[20:23], s60 offen offset:3072 sc1
    v_mfma_f32_16x16x32_bf16 v[32:35], v[76:79], a[188:191], v[32:35]
    v_exp_f32_e64 v29, v29
    v_mfma_f32_16x16x32_bf16 v[36:39], v[80:83], a[176:179], v[124:127]
    v_cvt_pk_bf16_f32 v54, v28, v29
    v_mfma_f32_16x16x32_bf16 v[36:39], v[84:87], a[180:183], v[36:39]
    v_exp_f32_e64 v30, v30
    v_mfma_f32_16x16x32_bf16 v[36:39], v[88:91], a[184:187], v[36:39]
    ds_read_b128 v[132:135], v3 offset:58368
    v_mfma_f32_16x16x32_bf16 v[36:39], v[92:95], a[188:191], v[36:39]
    v_exp_f32_e64 v31, v31
    v_mfma_f32_16x16x32_bf16 a[0:3], v[48:51], a[208:211], a[0:3]
    v_cvt_pk_bf16_f32 v55, v30, v31
    v_mfma_f32_16x16x32_bf16 a[4:7], v[48:51], a[212:215], a[4:7]
    s_add_u32 s56, s76, s58
    s_add_u32 s55, s56, 0x4000
    v_mfma_f32_16x16x32_bf16 a[8:11], v[48:51], a[216:219], a[8:11]
    v_exp_f32_e32 v32, v32
    v_mfma_f32_16x16x32_bf16 a[12:15], v[48:51], a[220:223], a[12:15]
    ds_read_b128 v[136:139], v3 offset:59392
    v_mfma_f32_16x16x32_bf16 a[16:19], v[48:51], a[224:227], a[16:19]
    v_exp_f32_e64 v33, v33
    v_mfma_f32_16x16x32_bf16 a[20:23], v[48:51], a[228:231], a[20:23]
    v_cvt_pk_bf16_f32 v56, v32, v33
    v_mfma_f32_16x16x32_bf16 a[24:27], v[48:51], a[232:235], a[24:27]
    v_exp_f32_e64 v34, v34
    v_mfma_f32_16x16x32_bf16 a[28:31], v[48:51], a[236:239], a[28:31]
    ds_read_b128 v[140:143], v3 offset:60416
    s_add_u32 s60, s60, 0x40000
    v_mfma_f32_16x16x32_bf16 a[128:131], v[48:51], a[240:243], a[128:131]
    v_exp_f32_e64 v35, v35
    v_mfma_f32_16x16x32_bf16 v[40:43], v[64:67], a[192:195], v[120:123]
    v_cvt_pk_bf16_f32 v57, v34, v35
    v_mfma_f32_16x16x32_bf16 v[40:43], v[68:71], a[196:199], v[40:43]
    v_exp_f32_e64 v36, v36
    v_mfma_f32_16x16x32_bf16 v[40:43], v[72:75], a[200:203], v[40:43]
    ds_read_b128 v[144:147], v3 offset:61440
    s_add_u32 s61, s61, 0x400
    v_mfma_f32_16x16x32_bf16 v[40:43], v[76:79], a[204:207], v[40:43]
    v_exp_f32_e64 v37, v37
    v_mfma_f32_16x16x32_bf16 v[44:47], v[80:83], a[192:195], v[124:127]
    ds_read_b128 v[120:123], v1 offset:896
    v_cvt_pk_bf16_f32 v58, v36, v37
    v_mfma_f32_16x16x32_bf16 v[44:47], v[84:87], a[196:199], v[44:47]
    v_exp_f32_e64 v38, v38
    v_mfma_f32_16x16x32_bf16 v[44:47], v[88:91], a[200:203], v[44:47]
    ds_read_b128 v[148:151], v3 offset:62464
    s_add_u32 s62, s62, 0x400
    v_mfma_f32_16x16x32_bf16 v[44:47], v[92:95], a[204:207], v[44:47]
    v_exp_f32_e64 v39, v39
    v_mfma_f32_16x16x32_bf16 a[32:35], v[52:55], a[208:211], a[32:35]
    ds_read_b128 v[124:127], v1 offset:960
    v_cvt_pk_bf16_f32 v59, v38, v39
    v_mfma_f32_16x16x32_bf16 a[36:39], v[52:55], a[212:215], a[36:39]
    s_add_u32 m0, s88, 0x10000
    s_lshr_b32 s3, s56, 5
    v_mfma_f32_16x16x32_bf16 a[40:43], v[52:55], a[216:219], a[40:43]
    v_exp_f32_e32 v40, v40
    v_mfma_f32_16x16x32_bf16 a[44:47], v[52:55], a[220:223], a[44:47]
    ds_read_b128 v[152:155], v3 offset:63488
    s_lshr_b32 s89, s60, 5
    v_mfma_f32_16x16x32_bf16 a[48:51], v[52:55], a[224:227], a[48:51]
    v_exp_f32_e32 v41, v41
    v_mfma_f32_16x16x32_bf16 a[52:55], v[52:55], a[228:231], a[52:55]
    ds_read2_b64 a[244:247], v14 offset0:224 offset1:228
    v_cvt_pk_bf16_f32 v60, v40, v41
    v_mfma_f32_16x16x32_bf16 a[56:59], v[52:55], a[232:235], a[56:59]
    v_exp_f32_e64 v42, v42
    v_mfma_f32_16x16x32_bf16 a[60:63], v[52:55], a[236:239], a[60:63]
    ds_read_b128 v[156:159], v3 offset:64512
    s_waitcnt vmcnt(14) lgkmcnt(5)
    v_mfma_f32_16x16x32_bf16 a[132:135], v[52:55], a[240:243], a[132:135]
    v_exp_f32_e32 v43, v43
    v_mfma_f32_16x16x32_bf16 v[16:19], v[96:99], a[144:147], v[120:123]
    s_barrier
    v_cvt_pk_bf16_f32 v61, v42, v43
    v_mfma_f32_16x16x32_bf16 v[16:19], v[100:103], a[148:151], v[16:19]
    v_exp_f32_e32 v44, v44
    v_mfma_f32_16x16x32_bf16 v[16:19], v[104:107], a[152:155], v[16:19]
    ds_read_b128 v[64:67], v2
    s_waitcnt lgkmcnt(4)
    v_mfma_f32_16x16x32_bf16 v[16:19], v[108:111], a[156:159], v[16:19]
    v_exp_f32_e32 v45, v45
    v_mfma_f32_16x16x32_bf16 v[20:23], v[112:115], a[144:147], v[124:127]
    buffer_load_dwordx4 v4, s[20:23], s56 offen sc1 lds
    v_cvt_pk_bf16_f32 v62, v44, v45
    v_mfma_f32_16x16x32_bf16 v[20:23], v[116:119], a[148:151], v[20:23]
    v_exp_f32_e64 v46, v46
    v_mfma_f32_16x16x32_bf16 v[20:23], a[248:251], a[152:155], v[20:23]
    ds_read_b128 v[68:71], v2 offset:1024
    v_mfma_f32_16x16x32_bf16 v[20:23], a[252:255], a[156:159], v[20:23]
    v_exp_f32_e64 v47, v47
    v_mfma_f32_16x16x32_bf16 a[64:67], v[56:59], a[208:211], a[64:67]
    buffer_load_dwordx4 v4, s[20:23], s56 offen offset:1024 sc1 lds
    v_cvt_pk_bf16_f32 v63, v46, v47
    v_mfma_f32_16x16x32_bf16 a[68:71], v[56:59], a[212:215], a[68:71]
    buffer_load_dwordx4 v4, s[20:23], s56 offen offset:2048 sc1 lds
    v_mfma_f32_16x16x32_bf16 a[72:75], v[56:59], a[216:219], a[72:75]
    v_exp_f32_e64 v16, v16
    v_mfma_f32_16x16x32_bf16 a[76:79], v[56:59], a[220:223], a[76:79]
    ds_read_b128 v[72:75], v2 offset:2048
    v_mfma_f32_16x16x32_bf16 a[80:83], v[56:59], a[224:227], a[80:83]
    v_exp_f32_e64 v17, v17
    v_mfma_f32_16x16x32_bf16 a[84:87], v[56:59], a[228:231], a[84:87]
    buffer_load_dwordx4 v4, s[20:23], s56 offen offset:3072 sc1 lds
    v_cvt_pk_bf16_f32 v48, v16, v17
    v_mfma_f32_16x16x32_bf16 a[88:91], v[56:59], a[232:235], a[88:91]
    v_exp_f32_e64 v18, v18
    v_mfma_f32_16x16x32_bf16 a[92:95], v[56:59], a[236:239], a[92:95]
    ds_read_b128 v[76:79], v2 offset:3072
    s_add_u32 m0, s88, 0x14000
    v_mfma_f32_16x16x32_bf16 a[136:139], v[56:59], a[240:243], a[136:139]
    v_exp_f32_e64 v19, v19
    v_mfma_f32_16x16x32_bf16 v[24:27], v[96:99], a[160:163], v[120:123]
    buffer_load_dwordx4 v4, s[20:23], s55 offen sc1 lds
    v_cvt_pk_bf16_f32 v49, v18, v19
    v_mfma_f32_16x16x32_bf16 v[24:27], v[100:103], a[164:167], v[24:27]
    v_exp_f32_e64 v20, v20
    v_mfma_f32_16x16x32_bf16 v[24:27], v[104:107], a[168:171], v[24:27]
    ds_read_b128 v[80:83], v2 offset:4096
    v_mfma_f32_16x16x32_bf16 v[24:27], v[108:111], a[172:175], v[24:27]
    v_exp_f32_e64 v21, v21
    v_mfma_f32_16x16x32_bf16 v[28:31], v[112:115], a[160:163], v[124:127]
    buffer_load_dwordx4 v4, s[20:23], s55 offen offset:1024 sc1 lds
    v_cvt_pk_bf16_f32 v50, v20, v21
    v_mfma_f32_16x16x32_bf16 v[28:31], v[116:119], a[164:167], v[28:31]
    v_exp_f32_e64 v22, v22
    v_mfma_f32_16x16x32_bf16 v[28:31], a[248:251], a[168:171], v[28:31]
    ds_read_b128 v[84:87], v2 offset:5120
    v_mfma_f32_16x16x32_bf16 v[28:31], a[252:255], a[172:175], v[28:31]
    v_exp_f32_e64 v23, v23
    v_mfma_f32_16x16x32_bf16 a[96:99], v[60:63], a[208:211], a[96:99]
    buffer_load_dwordx4 v4, s[20:23], s55 offen offset:2048 sc1 lds
    v_cvt_pk_bf16_f32 v51, v22, v23
    v_mfma_f32_16x16x32_bf16 a[100:103], v[60:63], a[212:215], a[100:103]
    buffer_load_dwordx4 v4, s[20:23], s55 offen offset:3072 sc1 lds
    v_mfma_f32_16x16x32_bf16 a[104:107], v[60:63], a[216:219], a[104:107]
    v_exp_f32_e64 v24, v24
    v_mfma_f32_16x16x32_bf16 a[108:111], v[60:63], a[220:223], a[108:111]
    ds_read_b128 v[88:91], v2 offset:6144
    s_lshl1_add_u32 m0, s84, s10
    v_mfma_f32_16x16x32_bf16 a[112:115], v[60:63], a[224:227], a[112:115]
    v_exp_f32_e32 v25, v25
    v_mfma_f32_16x16x32_bf16 a[116:119], v[60:63], a[228:231], a[116:119]
    buffer_load_dword v15, s[80:83], s3 offen sc1 lds
    v_cvt_pk_bf16_f32 v52, v24, v25
    v_mfma_f32_16x16x32_bf16 a[120:123], v[60:63], a[232:235], a[120:123]
    v_exp_f32_e64 v26, v26
    v_mfma_f32_16x16x32_bf16 a[124:127], v[60:63], a[236:239], a[124:127]
    ds_read_b128 v[92:95], v2 offset:7168
    s_waitcnt lgkmcnt(8)
    v_mfma_f32_16x16x32_bf16 a[140:143], v[60:63], a[240:243], a[140:143]
    v_exp_f32_e32 v27, v27
    v_mfma_f32_16x16x32_bf16 v[32:35], v[96:99], a[176:179], v[120:123]
    v_cvt_pk_bf16_f32 v53, v26, v27
    v_mfma_f32_16x16x32_bf16 v[32:35], v[100:103], a[180:183], v[32:35]
    v_exp_f32_e64 v28, v28
    v_mfma_f32_16x16x32_bf16 v[32:35], v[104:107], a[184:187], v[32:35]
    ds_read_b128 a[208:211], v2 offset:8192
    v_lshrrev_b32_e64 v228, 3, v2
    v_mfma_f32_16x16x32_bf16 v[32:35], v[108:111], a[188:191], v[32:35]
    v_exp_f32_e64 v29, v29
    v_mfma_f32_16x16x32_bf16 v[36:39], v[112:115], a[176:179], v[124:127]
    v_cvt_pk_bf16_f32 v54, v28, v29
    v_and_b32_e32 v228, 0x70, v228
    v_mfma_f32_16x16x32_bf16 v[36:39], v[116:119], a[180:183], v[36:39]
    v_exp_f32_e64 v30, v30
    v_mfma_f32_16x16x32_bf16 v[36:39], a[248:251], a[184:187], v[36:39]
    ds_read_b128 a[212:215], v2 offset:9216
    v_add_u32_e64 v228, s95, v228
    v_mfma_f32_16x16x32_bf16 v[36:39], a[252:255], a[188:191], v[36:39]
    v_exp_f32_e64 v31, v31
    v_mfma_f32_16x16x32_bf16 a[0:3], v[48:51], v[128:131], a[0:3]
    buffer_load_dwordx4 v[224:227], v228, s[32:35], s61 offen
    v_cvt_pk_bf16_f32 v55, v30, v31
    v_mfma_f32_16x16x32_bf16 a[4:7], v[48:51], v[132:135], a[4:7]
    buffer_load_dwordx4 v[228:231], v228, s[36:39], s61 offen
    v_mfma_f32_16x16x32_bf16 a[8:11], v[48:51], v[136:139], a[8:11]
    v_exp_f32_e64 v32, v32
    v_mfma_f32_16x16x32_bf16 a[12:15], v[48:51], v[140:143], a[12:15]
    ds_read_b128 a[216:219], v2 offset:10240
    buffer_load_dwordx4 v[160:163], v5, s[24:27], s60 offen nt
    v_mfma_f32_16x16x32_bf16 a[16:19], v[48:51], v[144:147], a[16:19]
    v_exp_f32_e64 v33, v33
    v_mfma_f32_16x16x32_bf16 a[20:23], v[48:51], v[148:151], a[20:23]
    buffer_load_dwordx4 v[164:167], v5, s[24:27], s60 offen offset:16 nt
    v_cvt_pk_bf16_f32 v56, v32, v33
    v_mfma_f32_16x16x32_bf16 a[24:27], v[48:51], v[152:155], a[24:27]
    v_exp_f32_e64 v34, v34
    v_mfma_f32_16x16x32_bf16 a[28:31], v[48:51], v[156:159], a[28:31]
    ds_read_b128 a[220:223], v2 offset:11264
    s_add_u32 s67, s60, 0x1000
    v_mfma_f32_16x16x32_bf16 a[128:131], v[48:51], a[244:247], a[128:131]
    v_exp_f32_e64 v35, v35
    v_mfma_f32_16x16x32_bf16 v[40:43], v[96:99], a[192:195], v[120:123]
    buffer_load_dwordx4 v[168:171], v5, s[24:27], s67 offen nt
    v_cvt_pk_bf16_f32 v57, v34, v35
    v_mfma_f32_16x16x32_bf16 v[40:43], v[100:103], a[196:199], v[40:43]
    v_exp_f32_e64 v36, v36
    v_mfma_f32_16x16x32_bf16 v[40:43], v[104:107], a[200:203], v[40:43]
    ds_read_b128 a[224:227], v2 offset:12288
    v_mfma_f32_16x16x32_bf16 v[40:43], v[108:111], a[204:207], v[40:43]
    v_exp_f32_e64 v37, v37
    v_mfma_f32_16x16x32_bf16 v[44:47], v[112:115], a[192:195], v[124:127]
    ds_read_b128 v[120:123], v1
    v_cvt_pk_bf16_f32 v58, v36, v37
    v_mfma_f32_16x16x32_bf16 v[44:47], v[116:119], a[196:199], v[44:47]
    v_exp_f32_e64 v38, v38
    v_mfma_f32_16x16x32_bf16 v[44:47], a[248:251], a[200:203], v[44:47]
    ds_read_b128 a[228:231], v2 offset:13312
    v_mfma_f32_16x16x32_bf16 v[44:47], a[252:255], a[204:207], v[44:47]
    v_exp_f32_e64 v39, v39
    v_mfma_f32_16x16x32_bf16 a[32:35], v[52:55], v[128:131], a[32:35]
    ds_read_b128 v[124:127], v1 offset:64
    v_cvt_pk_bf16_f32 v59, v38, v39
    v_mfma_f32_16x16x32_bf16 a[36:39], v[52:55], v[132:135], a[36:39]
    v_mfma_f32_16x16x32_bf16 a[40:43], v[52:55], v[136:139], a[40:43]
    v_exp_f32_e64 v40, v40
    v_mfma_f32_16x16x32_bf16 a[44:47], v[52:55], v[140:143], a[44:47]
    ds_read_b128 a[232:235], v2 offset:14336
    v_mfma_f32_16x16x32_bf16 a[48:51], v[52:55], v[144:147], a[48:51]
    v_exp_f32_e64 v41, v41
    v_mfma_f32_16x16x32_bf16 a[52:55], v[52:55], v[148:151], a[52:55]
    ds_read2_b64 a[240:243], v14 offset0:0 offset1:4
    v_cvt_pk_bf16_f32 v60, v40, v41
    v_mfma_f32_16x16x32_bf16 a[56:59], v[52:55], v[152:155], a[56:59]
    v_exp_f32_e64 v42, v42
    v_mfma_f32_16x16x32_bf16 a[60:63], v[52:55], v[156:159], a[60:63]
    ds_read_b128 a[236:239], v2 offset:15360
    s_waitcnt lgkmcnt(5)
    v_mfma_f32_16x16x32_bf16 a[132:135], v[52:55], a[244:247], a[132:135]
    v_exp_f32_e32 v43, v43
    s_branch at_mid
.p2align 6
at_loop:
    v_mfma_f32_16x16x32_bf16 v[16:19], v[64:67], a[144:147], v[120:123]
    v_cvt_pk_bf16_f32 v61, v42, v43
    v_mfma_f32_16x16x32_bf16 v[16:19], v[68:71], a[148:151], v[16:19]
    v_exp_f32_e64 v44, v44
    v_mfma_f32_16x16x32_bf16 v[16:19], v[72:75], a[152:155], v[16:19]
    ds_read_b128 v[96:99], v2 offset:16384
    s_waitcnt lgkmcnt(4)
    v_mfma_f32_16x16x32_bf16 v[16:19], v[76:79], a[156:159], v[16:19]
    v_exp_f32_e32 v45, v45
    v_mfma_f32_16x16x32_bf16 v[20:23], v[80:83], a[144:147], v[124:127]
    v_cvt_pk_bf16_f32 v62, v44, v45
    v_fma_f32 v179, v179, v243, v251
    v_mfma_f32_16x16x32_bf16 v[20:23], v[84:87], a[148:151], v[20:23]
    v_exp_f32_e64 v46, v46
    v_mfma_f32_16x16x32_bf16 v[20:23], v[88:91], a[152:155], v[20:23]
    ds_read_b128 v[100:103], v2 offset:17408
    v_fma_f32 v180, v180, v244, v252
    v_mfma_f32_16x16x32_bf16 v[20:23], v[92:95], a[156:159], v[20:23]
    v_exp_f32_e64 v47, v47
    v_mfma_f32_16x16x32_bf16 a[64:67], v[56:59], v[128:131], a[64:67]
    v_cvt_pk_bf16_f32 v63, v46, v47
    v_fma_f32 v181, v181, v245, v253
    v_mfma_f32_16x16x32_bf16 a[68:71], v[56:59], v[132:135], a[68:71]
    v_fma_f32 v182, v182, v246, v254
    v_fma_f32 v183, v183, v247, v255
    v_mfma_f32_16x16x32_bf16 a[72:75], v[56:59], v[136:139], a[72:75]
    v_exp_f32_e64 v16, v16
    v_mfma_f32_16x16x32_bf16 a[76:79], v[56:59], v[140:143], a[76:79]
    ds_read_b128 v[104:107], v2 offset:18432
    v_cvt_pk_bf16_f32 v176, v176, v177
    v_mfma_f32_16x16x32_bf16 a[80:83], v[56:59], v[144:147], a[80:83]
    v_exp_f32_e64 v17, v17
    v_mfma_f32_16x16x32_bf16 a[84:87], v[56:59], v[148:151], a[84:87]
    v_cvt_pk_bf16_f32 v48, v16, v17
    v_cvt_pk_bf16_f32 v177, v178, v179
    v_mfma_f32_16x16x32_bf16 a[88:91], v[56:59], v[152:155], a[88:91]
    v_exp_f32_e64 v18, v18
    v_mfma_f32_16x16x32_bf16 a[92:95], v[56:59], v[156:159], a[92:95]
    ds_read_b128 v[108:111], v2 offset:19456
    v_cvt_pk_bf16_f32 v178, v180, v181
    v_mfma_f32_16x16x32_bf16 a[136:139], v[56:59], a[244:247], a[136:139]
    v_exp_f32_e64 v19, v19
    v_mfma_f32_16x16x32_bf16 v[24:27], v[64:67], a[160:163], v[120:123]
    v_cvt_pk_bf16_f32 v49, v18, v19
    v_cvt_pk_bf16_f32 v179, v182, v183
    v_mfma_f32_16x16x32_bf16 v[24:27], v[68:71], a[164:167], v[24:27]
    v_exp_f32_e64 v20, v20
    v_mfma_f32_16x16x32_bf16 v[24:27], v[72:75], a[168:171], v[24:27]
    ds_read_b128 v[112:115], v2 offset:20480
    s_add_u32 s68, s60, 0x1000
    v_mfma_f32_16x16x32_bf16 v[24:27], v[76:79], a[172:175], v[24:27]
    v_exp_f32_e64 v21, v21
    v_mfma_f32_16x16x32_bf16 v[28:31], v[80:83], a[160:163], v[124:127]
    buffer_store_dwordx4 v[176:179], v6, s[20:23], s68 offen sc1
    v_cvt_pk_bf16_f32 v50, v20, v21
    v_mfma_f32_16x16x32_bf16 v[28:31], v[84:87], a[164:167], v[28:31]
    v_exp_f32_e64 v22, v22
    v_mfma_f32_16x16x32_bf16 v[28:31], v[88:91], a[168:171], v[28:31]
    ds_read_b128 v[116:119], v2 offset:21504
    v_cvt_f32_i32_e64 v184, v184
    v_mfma_f32_16x16x32_bf16 v[28:31], v[92:95], a[172:175], v[28:31]
    v_exp_f32_e64 v23, v23
    v_mfma_f32_16x16x32_bf16 a[96:99], v[60:63], v[128:131], a[96:99]
    v_cvt_pk_bf16_f32 v51, v22, v23
    v_cvt_f32_i32_e64 v185, v185
    v_mfma_f32_16x16x32_bf16 a[100:103], v[60:63], v[132:135], a[100:103]
    v_cvt_f32_i32_e32 v186, v186
    v_cvt_f32_i32_e32 v187, v187
    v_mfma_f32_16x16x32_bf16 a[104:107], v[60:63], v[136:139], a[104:107]
    v_exp_f32_e64 v24, v24
    v_mfma_f32_16x16x32_bf16 a[108:111], v[60:63], v[140:143], a[108:111]
    ds_read_b128 a[248:251], v2 offset:22528
    v_cvt_f32_i32_e64 v188, v188
    v_mfma_f32_16x16x32_bf16 a[112:115], v[60:63], v[144:147], a[112:115]
    v_exp_f32_e64 v25, v25
    v_mfma_f32_16x16x32_bf16 a[116:119], v[60:63], v[148:151], a[116:119]
    v_cvt_pk_bf16_f32 v52, v24, v25
    v_cvt_f32_i32_e64 v189, v189
    v_mfma_f32_16x16x32_bf16 a[120:123], v[60:63], v[152:155], a[120:123]
    v_exp_f32_e64 v26, v26
    v_mfma_f32_16x16x32_bf16 a[124:127], v[60:63], v[156:159], a[124:127]
    ds_read_b128 a[252:255], v2 offset:23552
    s_waitcnt lgkmcnt(8)
    v_mfma_f32_16x16x32_bf16 a[140:143], v[60:63], a[244:247], a[140:143]
    v_exp_f32_e32 v27, v27
    v_mfma_f32_16x16x32_bf16 v[32:35], v[64:67], a[176:179], v[120:123]
    v_cvt_pk_bf16_f32 v53, v26, v27
    v_cvt_f32_i32_e64 v190, v190
    v_mfma_f32_16x16x32_bf16 v[32:35], v[68:71], a[180:183], v[32:35]
    v_exp_f32_e64 v28, v28
    v_mfma_f32_16x16x32_bf16 v[32:35], v[72:75], a[184:187], v[32:35]
    ds_read_b128 v[128:131], v2 offset:24576
    v_cvt_f32_i32_e64 v191, v191
    v_mfma_f32_16x16x32_bf16 v[32:35], v[76:79], a[188:191], v[32:35]
    v_exp_f32_e64 v29, v29
    v_mfma_f32_16x16x32_bf16 v[36:39], v[80:83], a[176:179], v[124:127]
    v_cvt_pk_bf16_f32 v54, v28, v29
    v_fma_f32 v184, v184, v240, v248
    v_mfma_f32_16x16x32_bf16 v[36:39], v[84:87], a[180:183], v[36:39]
    v_exp_f32_e64 v30, v30
    v_mfma_f32_16x16x32_bf16 v[36:39], v[88:91], a[184:187], v[36:39]
    ds_read_b128 v[132:135], v2 offset:25600
    v_fma_f32 v185, v185, v241, v249
    v_mfma_f32_16x16x32_bf16 v[36:39], v[92:95], a[188:191], v[36:39]
    v_exp_f32_e64 v31, v31
    v_mfma_f32_16x16x32_bf16 a[0:3], v[48:51], a[208:211], a[0:3]
    v_cvt_pk_bf16_f32 v55, v30, v31
    v_fma_f32 v186, v186, v242, v250
    v_mfma_f32_16x16x32_bf16 a[4:7], v[48:51], a[212:215], a[4:7]
    s_add_u32 s56, s73, s58
    s_add_u32 s55, s56, 0x4000
    v_mfma_f32_16x16x32_bf16 a[8:11], v[48:51], a[216:219], a[8:11]
    v_exp_f32_e32 v32, v32
    v_mfma_f32_16x16x32_bf16 a[12:15], v[48:51], a[220:223], a[12:15]
    ds_read_b128 v[136:139], v2 offset:26624
    v_fma_f32 v187, v187, v243, v251
    v_mfma_f32_16x16x32_bf16 a[16:19], v[48:51], a[224:227], a[16:19]
    v_exp_f32_e64 v33, v33
    v_mfma_f32_16x16x32_bf16 a[20:23], v[48:51], a[228:231], a[20:23]
    v_cvt_pk_bf16_f32 v56, v32, v33
    v_fma_f32 v188, v188, v244, v252
    v_mfma_f32_16x16x32_bf16 a[24:27], v[48:51], a[232:235], a[24:27]
    v_exp_f32_e64 v34, v34
    v_mfma_f32_16x16x32_bf16 a[28:31], v[48:51], a[236:239], a[28:31]
    ds_read_b128 v[140:143], v2 offset:27648
    v_fma_f32 v189, v189, v245, v253
    v_mfma_f32_16x16x32_bf16 a[128:131], v[48:51], a[240:243], a[128:131]
    v_exp_f32_e64 v35, v35
    v_mfma_f32_16x16x32_bf16 v[40:43], v[64:67], a[192:195], v[120:123]
    v_cvt_pk_bf16_f32 v57, v34, v35
    v_fma_f32 v190, v190, v246, v254
    v_mfma_f32_16x16x32_bf16 v[40:43], v[68:71], a[196:199], v[40:43]
    v_exp_f32_e64 v36, v36
    v_mfma_f32_16x16x32_bf16 v[40:43], v[72:75], a[200:203], v[40:43]
    ds_read_b128 v[144:147], v2 offset:28672
    v_fma_f32 v191, v191, v247, v255
    v_mfma_f32_16x16x32_bf16 v[40:43], v[76:79], a[204:207], v[40:43]
    v_exp_f32_e64 v37, v37
    v_mfma_f32_16x16x32_bf16 v[44:47], v[80:83], a[192:195], v[124:127]
    ds_read_b128 v[120:123], v1 offset:128
    v_cvt_pk_bf16_f32 v58, v36, v37
    v_mfma_f32_16x16x32_bf16 v[44:47], v[84:87], a[196:199], v[44:47]
    v_exp_f32_e64 v38, v38
    v_mfma_f32_16x16x32_bf16 v[44:47], v[88:91], a[200:203], v[44:47]
    ds_read_b128 v[148:151], v2 offset:29696
    v_cvt_pk_bf16_f32 v184, v184, v185
    v_mfma_f32_16x16x32_bf16 v[44:47], v[92:95], a[204:207], v[44:47]
    v_exp_f32_e64 v39, v39
    v_mfma_f32_16x16x32_bf16 a[32:35], v[52:55], a[208:211], a[32:35]
    ds_read_b128 v[124:127], v1 offset:192
    v_cvt_pk_bf16_f32 v59, v38, v39
    v_mfma_f32_16x16x32_bf16 a[36:39], v[52:55], a[212:215], a[36:39]
    s_add_u32 m0, s88, 0x18000
    s_lshr_b32 s3, s56, 5
    v_mfma_f32_16x16x32_bf16 a[40:43], v[52:55], a[216:219], a[40:43]
    v_exp_f32_e32 v40, v40
    v_mfma_f32_16x16x32_bf16 a[44:47], v[52:55], a[220:223], a[44:47]
    ds_read_b128 v[152:155], v2 offset:30720
    v_cvt_pk_bf16_f32 v185, v186, v187
    v_mfma_f32_16x16x32_bf16 a[48:51], v[52:55], a[224:227], a[48:51]
    v_exp_f32_e64 v41, v41
    v_mfma_f32_16x16x32_bf16 a[52:55], v[52:55], a[228:231], a[52:55]
    ds_read2_b64 a[244:247], v14 offset0:32 offset1:36
    v_cvt_pk_bf16_f32 v60, v40, v41
    v_mfma_f32_16x16x32_bf16 a[56:59], v[52:55], a[232:235], a[56:59]
    v_exp_f32_e64 v42, v42
    v_mfma_f32_16x16x32_bf16 a[60:63], v[52:55], a[236:239], a[60:63]
    ds_read_b128 v[156:159], v2 offset:31744
    s_waitcnt vmcnt(18) lgkmcnt(5)
    v_mfma_f32_16x16x32_bf16 a[132:135], v[52:55], a[240:243], a[132:135]
    v_exp_f32_e32 v43, v43
    v_mfma_f32_16x16x32_bf16 v[16:19], v[96:99], a[144:147], v[120:123]
    s_barrier
    v_cvt_pk_bf16_f32 v61, v42, v43
    v_mfma_f32_16x16x32_bf16 v[16:19], v[100:103], a[148:151], v[16:19]
    v_exp_f32_e32 v44, v44
    v_mfma_f32_16x16x32_bf16 v[16:19], v[104:107], a[152:155], v[16:19]
    ds_read_b128 v[64:67], v2 offset:32768
    s_waitcnt lgkmcnt(4)
    v_mfma_f32_16x16x32_bf16 v[16:19], v[108:111], a[156:159], v[16:19]
    v_exp_f32_e32 v45, v45
    v_mfma_f32_16x16x32_bf16 v[20:23], v[112:115], a[144:147], v[124:127]
    buffer_load_dwordx4 v4, s[20:23], s56 offen sc1 lds
    v_cvt_pk_bf16_f32 v62, v44, v45
    v_mfma_f32_16x16x32_bf16 v[20:23], v[116:119], a[148:151], v[20:23]
    v_exp_f32_e64 v46, v46
    v_mfma_f32_16x16x32_bf16 v[20:23], a[248:251], a[152:155], v[20:23]
    ds_read_b128 v[68:71], v2 offset:33792
    v_cvt_pk_bf16_f32 v186, v188, v189
    v_mfma_f32_16x16x32_bf16 v[20:23], a[252:255], a[156:159], v[20:23]
    v_exp_f32_e64 v47, v47
    v_mfma_f32_16x16x32_bf16 a[64:67], v[56:59], a[208:211], a[64:67]
    buffer_load_dwordx4 v4, s[20:23], s56 offen offset:1024 sc1 lds
    v_cvt_pk_bf16_f32 v63, v46, v47
    v_mfma_f32_16x16x32_bf16 a[68:71], v[56:59], a[212:215], a[68:71]
    buffer_load_dwordx4 v4, s[20:23], s56 offen offset:2048 sc1 lds
    v_cvt_pk_bf16_f32 v187, v190, v191
    v_mfma_f32_16x16x32_bf16 a[72:75], v[56:59], a[216:219], a[72:75]
    v_exp_f32_e64 v16, v16
    v_mfma_f32_16x16x32_bf16 a[76:79], v[56:59], a[220:223], a[76:79]
    ds_read_b128 v[72:75], v2 offset:34816
    buffer_store_dwordx4 v[184:187], v6, s[20:23], s68 offen offset:128 sc1
    v_mfma_f32_16x16x32_bf16 a[80:83], v[56:59], a[224:227], a[80:83]
    v_exp_f32_e64 v17, v17
    v_mfma_f32_16x16x32_bf16 a[84:87], v[56:59], a[228:231], a[84:87]
    buffer_load_dwordx4 v4, s[20:23], s56 offen offset:3072 sc1 lds
    v_cvt_pk_bf16_f32 v48, v16, v17
    v_mfma_f32_16x16x32_bf16 a[88:91], v[56:59], a[232:235], a[88:91]
    v_exp_f32_e64 v18, v18
    v_mfma_f32_16x16x32_bf16 a[92:95], v[56:59], a[236:239], a[92:95]
    ds_read_b128 v[76:79], v2 offset:35840
    s_add_u32 m0, s88, 0x1c000
    v_mfma_f32_16x16x32_bf16 a[136:139], v[56:59], a[240:243], a[136:139]
    v_exp_f32_e64 v19, v19
    v_mfma_f32_16x16x32_bf16 v[24:27], v[96:99], a[160:163], v[120:123]
    buffer_load_dwordx4 v4, s[20:23], s55 offen sc1 lds
    v_cvt_pk_bf16_f32 v49, v18, v19
    v_mfma_f32_16x16x32_bf16 v[24:27], v[100:103], a[164:167], v[24:27]
    v_exp_f32_e64 v20, v20
    v_mfma_f32_16x16x32_bf16 v[24:27], v[104:107], a[168:171], v[24:27]
    ds_read_b128 v[80:83], v2 offset:36864
    s_waitcnt vmcnt(35)
    v_mfma_f32_16x16x32_bf16 v[24:27], v[108:111], a[172:175], v[24:27]
    v_exp_f32_e32 v21, v21
    v_mfma_f32_16x16x32_bf16 v[28:31], v[112:115], a[160:163], v[124:127]
    buffer_load_dwordx4 v4, s[20:23], s55 offen offset:1024 sc1 lds
    v_cvt_pk_bf16_f32 v50, v20, v21
    v_mfma_f32_16x16x32_bf16 v[28:31], v[116:119], a[164:167], v[28:31]
    v_exp_f32_e64 v22, v22
    v_mfma_f32_16x16x32_bf16 v[28:31], a[248:251], a[168:171], v[28:31]
    ds_read_b128 v[84:87], v2 offset:37888
    v_lshlrev_b32_e64 v240, 16, v232
    v_mfma_f32_16x16x32_bf16 v[28:31], a[252:255], a[172:175], v[28:31]
    v_exp_f32_e64 v23, v23
    v_mfma_f32_16x16x32_bf16 a[96:99], v[60:63], a[208:211], a[96:99]
    buffer_load_dwordx4 v4, s[20:23], s55 offen offset:2048 sc1 lds
    v_cvt_pk_bf16_f32 v51, v22, v23
    v_mfma_f32_16x16x32_bf16 a[100:103], v[60:63], a[212:215], a[100:103]
    buffer_load_dwordx4 v4, s[20:23], s55 offen offset:3072 sc1 lds
    v_mov_b32_dpp v246, v236 quad_perm:[1,1,3,3] row_mask:0xf bank_mask:0xf
    v_mfma_f32_16x16x32_bf16 a[104:107], v[60:63], a[216:219], a[104:107]
    v_exp_f32_e64 v24, v24
    v_mfma_f32_16x16x32_bf16 a[108:111], v[60:63], a[220:223], a[108:111]
    ds_read_b128 v[88:91], v2 offset:38912
    s_mov_b32 m0, s85
    v_mfma_f32_16x16x32_bf16 a[112:115], v[60:63], a[224:227], a[112:115]
    v_exp_f32_e32 v25, v25
    v_mfma_f32_16x16x32_bf16 a[116:119], v[60:63], a[228:231], a[116:119]
    buffer_load_dword v15, s[80:83], s3 offen sc1 lds
    v_cvt_pk_bf16_f32 v52, v24, v25
    v_mfma_f32_16x16x32_bf16 a[120:123], v[60:63], a[232:235], a[120:123]
    v_exp_f32_e64 v26, v26
    v_mfma_f32_16x16x32_bf16 a[124:127], v[60:63], a[236:239], a[124:127]
    ds_read_b128 v[92:95], v2 offset:39936
    s_waitcnt lgkmcnt(8)
    v_mfma_f32_16x16x32_bf16 a[140:143], v[60:63], a[240:243], a[140:143]
    v_exp_f32_e32 v27, v27
    v_mfma_f32_16x16x32_bf16 v[32:35], v[96:99], a[176:179], v[120:123]
    v_cvt_pk_bf16_f32 v53, v26, v27
    v_log_f32_e64 v241, v240
    v_mfma_f32_16x16x32_bf16 v[32:35], v[100:103], a[180:183], v[32:35]
    v_exp_f32_e64 v28, v28
    v_mfma_f32_16x16x32_bf16 v[32:35], v[104:107], a[184:187], v[32:35]
    ds_read_b128 a[208:211], v2 offset:40960
    v_cmp_lt_f32_e32 vcc, 0x2b800000, v240
    v_mfma_f32_16x16x32_bf16 v[32:35], v[108:111], a[188:191], v[32:35]
    v_exp_f32_e64 v29, v29
    v_mfma_f32_16x16x32_bf16 v[36:39], v[112:115], a[176:179], v[124:127]
    v_cvt_pk_bf16_f32 v54, v28, v29
    v_rcp_f32_e64 v242, v240
    v_mfma_f32_16x16x32_bf16 v[36:39], v[116:119], a[180:183], v[36:39]
    v_exp_f32_e64 v30, v30
    v_mfma_f32_16x16x32_bf16 v[36:39], a[248:251], a[184:187], v[36:39]
    ds_read_b128 a[212:215], v2 offset:41984
    v_lshl_or_b32 v236, v246, 16, v236
    v_mfma_f32_16x16x32_bf16 v[36:39], a[252:255], a[188:191], v[36:39]
    v_exp_f32_e64 v31, v31
    v_mfma_f32_16x16x32_bf16 a[0:3], v[48:51], v[128:131], a[0:3]
    v_cvt_pk_bf16_f32 v55, v30, v31
    v_cndmask_b32_e32 v241, -1, v241, vcc
    v_mfma_f32_16x16x32_bf16 a[4:7], v[48:51], v[132:135], a[4:7]
    v_cmp_gt_f32_e32 vcc, 0x53800000, v240
    v_cvt_pk_bf16_f32 v243, v242, v242
    v_mfma_f32_16x16x32_bf16 a[8:11], v[48:51], v[136:139], a[8:11]
    v_exp_f32_e32 v32, v32
    v_mfma_f32_16x16x32_bf16 a[12:15], v[48:51], v[140:143], a[12:15]
    ds_read_b128 a[216:219], v2 offset:43008
    v_mov_b32_dpp v245, v242 quad_perm:[1,1,3,3] row_mask:0xf bank_mask:0xf
    v_mfma_f32_16x16x32_bf16 a[16:19], v[48:51], v[144:147], a[16:19]
    v_exp_f32_e64 v33, v33
    v_mfma_f32_16x16x32_bf16 a[20:23], v[48:51], v[148:151], a[20:23]
    v_cvt_pk_bf16_f32 v56, v32, v33
    v_cndmask_b32_e32 v241, -1, v241, vcc
    v_mfma_f32_16x16x32_bf16 a[24:27], v[48:51], v[152:155], a[24:27]
    v_exp_f32_e32 v34, v34
    v_mfma_f32_16x16x32_bf16 a[28:31], v[48:51], v[156:159], a[28:31]
    ds_read_b128 a[220:223], v2 offset:44032
    v_and_b32_e32 v243, 0xffff0000, v243
    v_mfma_f32_16x16x32_bf16 a[128:131], v[48:51], a[244:247], a[128:131]
    v_exp_f32_e64 v35, v35
    v_mfma_f32_16x16x32_bf16 v[40:43], v[96:99], a[192:195], v[120:123]
    v_cvt_pk_bf16_f32 v57, v34, v35
    v_sub_f32_e64 v244, v242, v243
    v_mfma_f32_16x16x32_bf16 v[40:43], v[100:103], a[196:199], v[40:43]
    v_exp_f32_e64 v36, v36
    v_mfma_f32_16x16x32_bf16 v[40:43], v[104:107], a[200:203], v[40:43]
    ds_read_b128 a[224:227], v2 offset:45056
    buffer_store_dword v241, v11, s[80:83], s89 offen sc1
    v_mfma_f32_16x16x32_bf16 v[40:43], v[108:111], a[204:207], v[40:43]
    v_exp_f32_e64 v37, v37
    v_mfma_f32_16x16x32_bf16 v[44:47], v[112:115], a[192:195], v[124:127]
    ds_read_b128 v[120:123], v1 offset:256
    v_cvt_pk_bf16_f32 v58, v36, v37
    v_mfma_f32_16x16x32_bf16 v[44:47], v[116:119], a[196:199], v[44:47]
    v_exp_f32_e64 v38, v38
    v_mfma_f32_16x16x32_bf16 v[44:47], a[248:251], a[200:203], v[44:47]
    ds_read_b128 a[228:231], v2 offset:46080
    v_cvt_pk_bf16_f32 v242, v242, v245
    v_mfma_f32_16x16x32_bf16 v[44:47], a[252:255], a[204:207], v[44:47]
    v_exp_f32_e64 v39, v39
    v_mfma_f32_16x16x32_bf16 a[32:35], v[52:55], v[128:131], a[32:35]
    ds_read_b128 v[124:127], v1 offset:320
    v_cvt_pk_bf16_f32 v59, v38, v39
    v_mfma_f32_16x16x32_bf16 a[36:39], v[52:55], v[132:135], a[36:39]
    buffer_store_dword v236, v7, s[80:83], s89 offen offset:144 sc1
    v_mfma_f32_16x16x32_bf16 a[40:43], v[52:55], v[136:139], a[40:43]
    v_exp_f32_e64 v40, v40
    v_mfma_f32_16x16x32_bf16 a[44:47], v[52:55], v[140:143], a[44:47]
    ds_read_b128 a[232:235], v2 offset:47104
    v_mov_b32_dpp v246, v244 quad_perm:[1,1,3,3] row_mask:0xf bank_mask:0xf
    v_mfma_f32_16x16x32_bf16 a[48:51], v[52:55], v[144:147], a[48:51]
    v_exp_f32_e64 v41, v41
    v_mfma_f32_16x16x32_bf16 a[52:55], v[52:55], v[148:151], a[52:55]
    ds_read2_b64 a[240:243], v14 offset0:64 offset1:68
    v_cvt_pk_bf16_f32 v60, v40, v41
    v_mfma_f32_16x16x32_bf16 a[56:59], v[52:55], v[152:155], a[56:59]
    v_exp_f32_e64 v42, v42
    v_mfma_f32_16x16x32_bf16 a[60:63], v[52:55], v[156:159], a[60:63]
    ds_read_b128 a[236:239], v2 offset:48128
    s_waitcnt lgkmcnt(5)
    v_mfma_f32_16x16x32_bf16 a[132:135], v[52:55], a[244:247], a[132:135]
    v_exp_f32_e32 v43, v43
    v_mfma_f32_16x16x32_bf16 v[16:19], v[64:67], a[144:147], v[120:123]
    v_cvt_pk_bf16_f32 v61, v42, v43
    v_mfma_f32_16x16x32_bf16 v[16:19], v[68:71], a[148:151], v[16:19]
    v_exp_f32_e64 v44, v44
    v_mfma_f32_16x16x32_bf16 v[16:19], v[72:75], a[152:155], v[16:19]
    ds_read_b128 v[96:99], v2 offset:49152
    s_waitcnt lgkmcnt(4)
    v_mfma_f32_16x16x32_bf16 v[16:19], v[76:79], a[156:159], v[16:19]
    v_exp_f32_e32 v45, v45
    v_mfma_f32_16x16x32_bf16 v[20:23], v[80:83], a[144:147], v[124:127]
    buffer_store_dword v242, v7, s[80:83], s89 offen sc1
    v_cvt_pk_bf16_f32 v62, v44, v45
    v_mfma_f32_16x16x32_bf16 v[20:23], v[84:87], a[148:151], v[20:23]
    v_exp_f32_e64 v46, v46
    v_mfma_f32_16x16x32_bf16 v[20:23], v[88:91], a[152:155], v[20:23]
    ds_read_b128 v[100:103], v2 offset:50176
    v_cvt_pk_bf16_f32 v244, v244, v246
    v_mfma_f32_16x16x32_bf16 v[20:23], v[92:95], a[156:159], v[20:23]
    v_exp_f32_e64 v47, v47
    v_mfma_f32_16x16x32_bf16 a[64:67], v[56:59], v[128:131], a[64:67]
    buffer_store_dword v244, v7, s[80:83], s89 offen offset:72 sc1
    v_cvt_pk_bf16_f32 v63, v46, v47
    v_mfma_f32_16x16x32_bf16 a[68:71], v[56:59], v[132:135], a[68:71]
    s_waitcnt vmcnt(15)
    v_cvt_f32_i32_e32 v192, v192
    v_mfma_f32_16x16x32_bf16 a[72:75], v[56:59], v[136:139], a[72:75]
    v_exp_f32_e64 v16, v16
    v_mfma_f32_16x16x32_bf16 a[76:79], v[56:59], v[140:143], a[76:79]
    ds_read_b128 v[104:107], v2 offset:51200
    v_cvt_f32_i32_e64 v196, v196
    v_mfma_f32_16x16x32_bf16 a[80:83], v[56:59], v[144:147], a[80:83]
    v_exp_f32_e64 v17, v17
    v_mfma_f32_16x16x32_bf16 a[84:87], v[56:59], v[148:151], a[84:87]
    v_cvt_pk_bf16_f32 v48, v16, v17
    v_cvt_f32_i32_e64 v200, v200
    v_mfma_f32_16x16x32_bf16 a[88:91], v[56:59], v[152:155], a[88:91]
    v_exp_f32_e64 v18, v18
    v_mfma_f32_16x16x32_bf16 a[92:95], v[56:59], v[156:159], a[92:95]
    ds_read_b128 v[108:111], v2 offset:52224
    v_cvt_f32_i32_e64 v204, v204
    v_mfma_f32_16x16x32_bf16 a[136:139], v[56:59], a[244:247], a[136:139]
    v_exp_f32_e64 v19, v19
    v_mfma_f32_16x16x32_bf16 v[24:27], v[64:67], a[160:163], v[120:123]
    v_cvt_pk_bf16_f32 v49, v18, v19
    v_cvt_f32_i32_e64 v208, v208
    v_mfma_f32_16x16x32_bf16 v[24:27], v[68:71], a[164:167], v[24:27]
    v_exp_f32_e64 v20, v20
    v_mfma_f32_16x16x32_bf16 v[24:27], v[72:75], a[168:171], v[24:27]
    ds_read_b128 v[112:115], v2 offset:53248
    v_cvt_f32_i32_e64 v212, v212
    v_mfma_f32_16x16x32_bf16 v[24:27], v[76:79], a[172:175], v[24:27]
    v_exp_f32_e64 v21, v21
    v_mfma_f32_16x16x32_bf16 v[28:31], v[80:83], a[160:163], v[124:127]
    v_cvt_pk_bf16_f32 v50, v20, v21
    v_cvt_f32_i32_e64 v216, v216
    v_mfma_f32_16x16x32_bf16 v[28:31], v[84:87], a[164:167], v[28:31]
    v_exp_f32_e64 v22, v22
    v_mfma_f32_16x16x32_bf16 v[28:31], v[88:91], a[168:171], v[28:31]
    ds_read_b128 v[116:119], v2 offset:54272
    v_cvt_f32_i32_e64 v220, v220
    v_mfma_f32_16x16x32_bf16 v[28:31], v[92:95], a[172:175], v[28:31]
    v_exp_f32_e64 v23, v23
    v_mfma_f32_16x16x32_bf16 a[96:99], v[60:63], v[128:131], a[96:99]
    v_cvt_pk_bf16_f32 v51, v22, v23
    v_cvt_pk_bf16_f32 v160, v192, v196
    v_mfma_f32_16x16x32_bf16 a[100:103], v[60:63], v[132:135], a[100:103]
    v_cvt_pk_bf16_f32 v161, v200, v204
    v_cvt_pk_bf16_f32 v162, v208, v212
    v_mfma_f32_16x16x32_bf16 a[104:107], v[60:63], v[136:139], a[104:107]
    v_exp_f32_e64 v24, v24
    v_mfma_f32_16x16x32_bf16 a[108:111], v[60:63], v[140:143], a[108:111]
    ds_read_b128 a[248:251], v2 offset:55296
    v_cvt_pk_bf16_f32 v163, v216, v220
    v_mfma_f32_16x16x32_bf16 a[112:115], v[60:63], v[144:147], a[112:115]
    v_exp_f32_e64 v25, v25
    v_mfma_f32_16x16x32_bf16 a[116:119], v[60:63], v[148:151], a[116:119]
    buffer_store_dwordx4 v[160:163], v9, s[20:23], s60 offen sc1
    v_cvt_pk_bf16_f32 v52, v24, v25
    v_mfma_f32_16x16x32_bf16 a[120:123], v[60:63], v[152:155], a[120:123]
    v_exp_f32_e64 v26, v26
    v_mfma_f32_16x16x32_bf16 a[124:127], v[60:63], v[156:159], a[124:127]
    ds_read_b128 a[252:255], v2 offset:56320
    s_waitcnt lgkmcnt(8)
    v_mfma_f32_16x16x32_bf16 a[140:143], v[60:63], a[244:247], a[140:143]
    v_exp_f32_e32 v27, v27
    v_mfma_f32_16x16x32_bf16 v[32:35], v[64:67], a[176:179], v[120:123]
    v_cvt_pk_bf16_f32 v53, v26, v27
    v_cvt_f32_i32_e64 v193, v193
    v_mfma_f32_16x16x32_bf16 v[32:35], v[68:71], a[180:183], v[32:35]
    v_exp_f32_e64 v28, v28
    v_mfma_f32_16x16x32_bf16 v[32:35], v[72:75], a[184:187], v[32:35]
    ds_read_b128 v[128:131], v2 offset:57344
    v_cvt_f32_i32_e64 v197, v197
    v_mfma_f32_16x16x32_bf16 v[32:35], v[76:79], a[188:191], v[32:35]
    v_exp_f32_e64 v29, v29
    v_mfma_f32_16x16x32_bf16 v[36:39], v[80:83], a[176:179], v[124:127]
    v_cvt_pk_bf16_f32 v54, v28, v29
    v_cvt_f32_i32_e64 v201, v201
    v_mfma_f32_16x16x32_bf16 v[36:39], v[84:87], a[180:183], v[36:39]
    v_exp_f32_e64 v30, v30
    v_mfma_f32_16x16x32_bf16 v[36:39], v[88:91], a[184:187], v[36:39]
    ds_read_b128 v[132:135], v2 offset:58368
    v_cvt_f32_i32_e64 v205, v205
    v_mfma_f32_16x16x32_bf16 v[36:39], v[92:95], a[188:191], v[36:39]
    v_exp_f32_e64 v31, v31
    v_mfma_f32_16x16x32_bf16 a[0:3], v[48:51], a[208:211], a[0:3]
    v_cvt_pk_bf16_f32 v55, v30, v31
    v_cvt_f32_i32_e64 v209, v209
    v_mfma_f32_16x16x32_bf16 a[4:7], v[48:51], a[212:215], a[4:7]
    s_add_u32 s56, s74, s58
    s_add_u32 s55, s56, 0x4000
    v_mfma_f32_16x16x32_bf16 a[8:11], v[48:51], a[216:219], a[8:11]
    v_exp_f32_e32 v32, v32
    v_mfma_f32_16x16x32_bf16 a[12:15], v[48:51], a[220:223], a[12:15]
    ds_read_b128 v[136:139], v2 offset:59392
    v_cvt_f32_i32_e64 v213, v213
    v_mfma_f32_16x16x32_bf16 a[16:19], v[48:51], a[224:227], a[16:19]
    v_exp_f32_e64 v33, v33
    v_mfma_f32_16x16x32_bf16 a[20:23], v[48:51], a[228:231], a[20:23]
    v_cvt_pk_bf16_f32 v56, v32, v33
    v_cvt_f32_i32_e64 v217, v217
    v_mfma_f32_16x16x32_bf16 a[24:27], v[48:51], a[232:235], a[24:27]
    v_exp_f32_e64 v34, v34
    v_mfma_f32_16x16x32_bf16 a[28:31], v[48:51], a[236:239], a[28:31]
    ds_read_b128 v[140:143], v2 offset:60416
    v_cvt_f32_i32_e64 v221, v221
    v_mfma_f32_16x16x32_bf16 a[128:131], v[48:51], a[240:243], a[128:131]
    v_exp_f32_e64 v35, v35
    v_mfma_f32_16x16x32_bf16 v[40:43], v[64:67], a[192:195], v[120:123]
    v_cvt_pk_bf16_f32 v57, v34, v35
    v_cvt_pk_bf16_f32 v164, v193, v197
    v_mfma_f32_16x16x32_bf16 v[40:43], v[68:71], a[196:199], v[40:43]
    v_exp_f32_e64 v36, v36
    v_mfma_f32_16x16x32_bf16 v[40:43], v[72:75], a[200:203], v[40:43]
    ds_read_b128 v[144:147], v2 offset:61440
    v_cvt_pk_bf16_f32 v165, v201, v205
    v_mfma_f32_16x16x32_bf16 v[40:43], v[76:79], a[204:207], v[40:43]
    v_exp_f32_e64 v37, v37
    v_mfma_f32_16x16x32_bf16 v[44:47], v[80:83], a[192:195], v[124:127]
    ds_read_b128 v[120:123], v1 offset:384
    v_cvt_pk_bf16_f32 v58, v36, v37
    v_mfma_f32_16x16x32_bf16 v[44:47], v[84:87], a[196:199], v[44:47]
    v_exp_f32_e64 v38, v38
    v_mfma_f32_16x16x32_bf16 v[44:47], v[88:91], a[200:203], v[44:47]
    ds_read_b128 v[148:151], v2 offset:62464
    v_cvt_pk_bf16_f32 v166, v209, v213
    v_mfma_f32_16x16x32_bf16 v[44:47], v[92:95], a[204:207], v[44:47]
    v_exp_f32_e64 v39, v39
    v_mfma_f32_16x16x32_bf16 a[32:35], v[52:55], a[208:211], a[32:35]
    ds_read_b128 v[124:127], v1 offset:448
    v_cvt_pk_bf16_f32 v59, v38, v39
    v_mfma_f32_16x16x32_bf16 a[36:39], v[52:55], a[212:215], a[36:39]
    s_mov_b32 m0, s88
    s_lshr_b32 s3, s56, 5
    v_mfma_f32_16x16x32_bf16 a[40:43], v[52:55], a[216:219], a[40:43]
    v_exp_f32_e64 v40, v40
    v_mfma_f32_16x16x32_bf16 a[44:47], v[52:55], a[220:223], a[44:47]
    ds_read_b128 v[152:155], v2 offset:63488
    v_cvt_pk_bf16_f32 v167, v217, v221
    v_mfma_f32_16x16x32_bf16 a[48:51], v[52:55], a[224:227], a[48:51]
    v_exp_f32_e64 v41, v41
    v_mfma_f32_16x16x32_bf16 a[52:55], v[52:55], a[228:231], a[52:55]
    ds_read2_b64 a[244:247], v14 offset0:96 offset1:100
    v_cvt_pk_bf16_f32 v60, v40, v41
    v_mfma_f32_16x16x32_bf16 a[56:59], v[52:55], a[232:235], a[56:59]
    v_exp_f32_e64 v42, v42
    v_mfma_f32_16x16x32_bf16 a[60:63], v[52:55], a[236:239], a[60:63]
    ds_read_b128 v[156:159], v2 offset:64512
    s_waitcnt vmcnt(19) lgkmcnt(5)
    v_mfma_f32_16x16x32_bf16 a[132:135], v[52:55], a[240:243], a[132:135]
    v_exp_f32_e32 v43, v43
    v_mfma_f32_16x16x32_bf16 v[16:19], v[96:99], a[144:147], v[120:123]
    s_barrier
    v_cvt_pk_bf16_f32 v61, v42, v43
    v_mfma_f32_16x16x32_bf16 v[16:19], v[100:103], a[148:151], v[16:19]
    v_exp_f32_e32 v44, v44
    v_mfma_f32_16x16x32_bf16 v[16:19], v[104:107], a[152:155], v[16:19]
    ds_read_b128 v[64:67], v3
    s_waitcnt lgkmcnt(4)
    v_mfma_f32_16x16x32_bf16 v[16:19], v[108:111], a[156:159], v[16:19]
    v_exp_f32_e32 v45, v45
    v_mfma_f32_16x16x32_bf16 v[20:23], v[112:115], a[144:147], v[124:127]
    buffer_load_dwordx4 v4, s[20:23], s56 offen sc1 lds
    v_cvt_pk_bf16_f32 v62, v44, v45
    v_mfma_f32_16x16x32_bf16 v[20:23], v[116:119], a[148:151], v[20:23]
    v_exp_f32_e64 v46, v46
    v_mfma_f32_16x16x32_bf16 v[20:23], a[248:251], a[152:155], v[20:23]
    ds_read_b128 v[68:71], v3 offset:1024
    buffer_store_dwordx4 v[164:167], v9, s[20:23], s60 offen offset:1024 sc1
    v_mfma_f32_16x16x32_bf16 v[20:23], a[252:255], a[156:159], v[20:23]
    v_exp_f32_e64 v47, v47
    v_mfma_f32_16x16x32_bf16 a[64:67], v[56:59], a[208:211], a[64:67]
    buffer_load_dwordx4 v4, s[20:23], s56 offen offset:1024 sc1 lds
    v_cvt_pk_bf16_f32 v63, v46, v47
    v_mfma_f32_16x16x32_bf16 a[68:71], v[56:59], a[212:215], a[68:71]
    buffer_load_dwordx4 v4, s[20:23], s56 offen offset:2048 sc1 lds
    v_cvt_f32_i32_e64 v194, v194
    v_mfma_f32_16x16x32_bf16 a[72:75], v[56:59], a[216:219], a[72:75]
    v_exp_f32_e64 v16, v16
    v_mfma_f32_16x16x32_bf16 a[76:79], v[56:59], a[220:223], a[76:79]
    ds_read_b128 v[72:75], v3 offset:2048
    v_cvt_f32_i32_e64 v198, v198
    v_mfma_f32_16x16x32_bf16 a[80:83], v[56:59], a[224:227], a[80:83]
    v_exp_f32_e64 v17, v17
    v_mfma_f32_16x16x32_bf16 a[84:87], v[56:59], a[228:231], a[84:87]
    buffer_load_dwordx4 v4, s[20:23], s56 offen offset:3072 sc1 lds
    v_cvt_pk_bf16_f32 v48, v16, v17
    v_mfma_f32_16x16x32_bf16 a[88:91], v[56:59], a[232:235], a[88:91]
    v_exp_f32_e64 v18, v18
    v_mfma_f32_16x16x32_bf16 a[92:95], v[56:59], a[236:239], a[92:95]
    ds_read_b128 v[76:79], v3 offset:3072
    s_add_u32 m0, s88, 0x4000
    v_mfma_f32_16x16x32_bf16 a[136:139], v[56:59], a[240:243], a[136:139]
    v_exp_f32_e64 v19, v19
    v_mfma_f32_16x16x32_bf16 v[24:27], v[96:99], a[160:163], v[120:123]
    buffer_load_dwordx4 v4, s[20:23], s55 offen sc1 lds
    v_cvt_pk_bf16_f32 v49, v18, v19
    v_mfma_f32_16x16x32_bf16 v[24:27], v[100:103], a[164:167], v[24:27]
    v_exp_f32_e64 v20, v20
    v_mfma_f32_16x16x32_bf16 v[24:27], v[104:107], a[168:171], v[24:27]
    ds_read_b128 v[80:83], v3 offset:4096
    v_cvt_f32_i32_e64 v202, v202
    v_mfma_f32_16x16x32_bf16 v[24:27], v[108:111], a[172:175], v[24:27]
    v_exp_f32_e64 v21, v21
    v_mfma_f32_16x16x32_bf16 v[28:31], v[112:115], a[160:163], v[124:127]
    buffer_load_dwordx4 v4, s[20:23], s55 offen offset:1024 sc1 lds
    v_cvt_pk_bf16_f32 v50, v20, v21
    v_mfma_f32_16x16x32_bf16 v[28:31], v[116:119], a[164:167], v[28:31]
    v_exp_f32_e64 v22, v22
    v_mfma_f32_16x16x32_bf16 v[28:31], a[248:251], a[168:171], v[28:31]
    ds_read_b128 v[84:87], v3 offset:5120
    v_cvt_f32_i32_e64 v206, v206
    v_mfma_f32_16x16x32_bf16 v[28:31], a[252:255], a[172:175], v[28:31]
    v_exp_f32_e64 v23, v23
    v_mfma_f32_16x16x32_bf16 a[96:99], v[60:63], a[208:211], a[96:99]
    buffer_load_dwordx4 v4, s[20:23], s55 offen offset:2048 sc1 lds
    v_cvt_pk_bf16_f32 v51, v22, v23
    v_mfma_f32_16x16x32_bf16 a[100:103], v[60:63], a[212:215], a[100:103]
    buffer_load_dwordx4 v4, s[20:23], s55 offen offset:3072 sc1 lds
    v_cvt_f32_i32_e64 v210, v210
    v_mfma_f32_16x16x32_bf16 a[104:107], v[60:63], a[216:219], a[104:107]
    v_exp_f32_e64 v24, v24
    v_mfma_f32_16x16x32_bf16 a[108:111], v[60:63], a[220:223], a[108:111]
    ds_read_b128 v[88:91], v3 offset:6144
    s_mov_b32 m0, s10
    v_mfma_f32_16x16x32_bf16 a[112:115], v[60:63], a[224:227], a[112:115]
    v_exp_f32_e32 v25, v25
    v_mfma_f32_16x16x32_bf16 a[116:119], v[60:63], a[228:231], a[116:119]
    buffer_load_dword v15, s[80:83], s3 offen sc1 lds
    v_cvt_pk_bf16_f32 v52, v24, v25
    v_mfma_f32_16x16x32_bf16 a[120:123], v[60:63], a[232:235], a[120:123]
    v_exp_f32_e64 v26, v26
    v_mfma_f32_16x16x32_bf16 a[124:127], v[60:63], a[236:239], a[124:127]
    ds_read_b128 v[92:95], v3 offset:7168
    s_waitcnt lgkmcnt(8)
    v_mfma_f32_16x16x32_bf16 a[140:143], v[60:63], a[240:243], a[140:143]
    v_exp_f32_e32 v27, v27
    v_mfma_f32_16x16x32_bf16 v[32:35], v[96:99], a[176:179], v[120:123]
    v_cvt_pk_bf16_f32 v53, v26, v27
    v_cvt_f32_i32_e64 v214, v214
    v_mfma_f32_16x16x32_bf16 v[32:35], v[100:103], a[180:183], v[32:35]
    v_exp_f32_e64 v28, v28
    v_mfma_f32_16x16x32_bf16 v[32:35], v[104:107], a[184:187], v[32:35]
    ds_read_b128 a[208:211], v3 offset:8192
    v_cvt_f32_i32_e64 v218, v218
    v_mfma_f32_16x16x32_bf16 v[32:35], v[108:111], a[188:191], v[32:35]
    v_exp_f32_e64 v29, v29
    v_mfma_f32_16x16x32_bf16 v[36:39], v[112:115], a[176:179], v[124:127]
    v_cvt_pk_bf16_f32 v54, v28, v29
    v_cvt_f32_i32_e64 v222, v222
    v_mfma_f32_16x16x32_bf16 v[36:39], v[116:119], a[180:183], v[36:39]
    v_exp_f32_e64 v30, v30
    v_mfma_f32_16x16x32_bf16 v[36:39], a[248:251], a[184:187], v[36:39]
    ds_read_b128 a[212:215], v3 offset:9216
    v_cvt_pk_bf16_f32 v168, v194, v198
    v_mfma_f32_16x16x32_bf16 v[36:39], a[252:255], a[188:191], v[36:39]
    v_exp_f32_e64 v31, v31
    v_mfma_f32_16x16x32_bf16 a[0:3], v[48:51], v[128:131], a[0:3]
    v_cvt_pk_bf16_f32 v55, v30, v31
    v_cvt_pk_bf16_f32 v169, v202, v206
    v_mfma_f32_16x16x32_bf16 a[4:7], v[48:51], v[132:135], a[4:7]
    v_cvt_pk_bf16_f32 v170, v210, v214
    v_cvt_pk_bf16_f32 v171, v218, v222
    v_mfma_f32_16x16x32_bf16 a[8:11], v[48:51], v[136:139], a[8:11]
    v_exp_f32_e64 v32, v32
    v_mfma_f32_16x16x32_bf16 a[12:15], v[48:51], v[140:143], a[12:15]
    ds_read_b128 a[216:219], v3 offset:10240
    buffer_store_dwordx4 v[168:171], v9, s[20:23], s60 offen offset:2048 sc1
    v_mfma_f32_16x16x32_bf16 a[16:19], v[48:51], v[144:147], a[16:19]
    v_exp_f32_e64 v33, v33
    v_mfma_f32_16x16x32_bf16 a[20:23], v[48:51], v[148:151], a[20:23]
    v_cvt_pk_bf16_f32 v56, v32, v33
    v_cvt_f32_i32_e64 v195, v195
    v_mfma_f32_16x16x32_bf16 a[24:27], v[48:51], v[152:155], a[24:27]
    v_exp_f32_e64 v34, v34
    v_mfma_f32_16x16x32_bf16 a[28:31], v[48:51], v[156:159], a[28:31]
    ds_read_b128 a[220:223], v3 offset:11264
    v_cvt_f32_i32_e64 v199, v199
    v_mfma_f32_16x16x32_bf16 a[128:131], v[48:51], a[244:247], a[128:131]
    v_exp_f32_e64 v35, v35
    v_mfma_f32_16x16x32_bf16 v[40:43], v[96:99], a[192:195], v[120:123]
    v_cvt_pk_bf16_f32 v57, v34, v35
    v_cvt_f32_i32_e64 v203, v203
    v_mfma_f32_16x16x32_bf16 v[40:43], v[100:103], a[196:199], v[40:43]
    v_exp_f32_e64 v36, v36
    v_mfma_f32_16x16x32_bf16 v[40:43], v[104:107], a[200:203], v[40:43]
    ds_read_b128 a[224:227], v3 offset:12288
    v_cvt_f32_i32_e64 v207, v207
    v_mfma_f32_16x16x32_bf16 v[40:43], v[108:111], a[204:207], v[40:43]
    v_exp_f32_e64 v37, v37
    v_mfma_f32_16x16x32_bf16 v[44:47], v[112:115], a[192:195], v[124:127]
    ds_read_b128 v[120:123], v1 offset:512
    v_cvt_pk_bf16_f32 v58, v36, v37
    v_mfma_f32_16x16x32_bf16 v[44:47], v[116:119], a[196:199], v[44:47]
    v_exp_f32_e64 v38, v38
    v_mfma_f32_16x16x32_bf16 v[44:47], a[248:251], a[200:203], v[44:47]
    ds_read_b128 a[228:231], v3 offset:13312
    v_cvt_f32_i32_e64 v211, v211
    v_mfma_f32_16x16x32_bf16 v[44:47], a[252:255], a[204:207], v[44:47]
    v_exp_f32_e64 v39, v39
    v_mfma_f32_16x16x32_bf16 a[32:35], v[52:55], v[128:131], a[32:35]
    ds_read_b128 v[124:127], v1 offset:576
    v_cvt_pk_bf16_f32 v59, v38, v39
    v_mfma_f32_16x16x32_bf16 a[36:39], v[52:55], v[132:135], a[36:39]
    v_cvt_f32_i32_e32 v215, v215
    v_cvt_f32_i32_e32 v219, v219
    v_mfma_f32_16x16x32_bf16 a[40:43], v[52:55], v[136:139], a[40:43]
    v_exp_f32_e64 v40, v40
    v_mfma_f32_16x16x32_bf16 a[44:47], v[52:55], v[140:143], a[44:47]
    ds_read_b128 a[232:235], v3 offset:14336
    v_cvt_f32_i32_e64 v223, v223
    v_mfma_f32_16x16x32_bf16 a[48:51], v[52:55], v[144:147], a[48:51]
    v_exp_f32_e64 v41, v41
    v_mfma_f32_16x16x32_bf16 a[52:55], v[52:55], v[148:151], a[52:55]
    ds_read2_b64 a[240:243], v14 offset0:128 offset1:132
    v_cvt_pk_bf16_f32 v60, v40, v41
    v_mfma_f32_16x16x32_bf16 a[56:59], v[52:55], v[152:155], a[56:59]
    v_exp_f32_e64 v42, v42
    v_mfma_f32_16x16x32_bf16 a[60:63], v[52:55], v[156:159], a[60:63]
    ds_read_b128 a[236:239], v3 offset:15360
    s_waitcnt lgkmcnt(5)
    v_mfma_f32_16x16x32_bf16 a[132:135], v[52:55], a[244:247], a[132:135]
    v_exp_f32_e32 v43, v43
    v_mfma_f32_16x16x32_bf16 v[16:19], v[64:67], a[144:147], v[120:123]
    v_cvt_pk_bf16_f32 v61, v42, v43
    v_mfma_f32_16x16x32_bf16 v[16:19], v[68:71], a[148:151], v[16:19]
    v_exp_f32_e64 v44, v44
    v_mfma_f32_16x16x32_bf16 v[16:19], v[72:75], a[152:155], v[16:19]
    ds_read_b128 v[96:99], v3 offset:16384
    s_waitcnt lgkmcnt(4)
    v_mfma_f32_16x16x32_bf16 v[16:19], v[76:79], a[156:159], v[16:19]
    v_exp_f32_e32 v45, v45
    v_mfma_f32_16x16x32_bf16 v[20:23], v[80:83], a[144:147], v[124:127]
    v_cvt_pk_bf16_f32 v62, v44, v45
    v_cvt_pk_bf16_f32 v172, v195, v199
    v_mfma_f32_16x16x32_bf16 v[20:23], v[84:87], a[148:151], v[20:23]
    v_exp_f32_e64 v46, v46
    v_mfma_f32_16x16x32_bf16 v[20:23], v[88:91], a[152:155], v[20:23]
    ds_read_b128 v[100:103], v3 offset:17408
    v_cvt_pk_bf16_f32 v173, v203, v207
    v_mfma_f32_16x16x32_bf16 v[20:23], v[92:95], a[156:159], v[20:23]
    v_exp_f32_e64 v47, v47
    v_mfma_f32_16x16x32_bf16 a[64:67], v[56:59], v[128:131], a[64:67]
    v_cvt_pk_bf16_f32 v63, v46, v47
    v_cvt_pk_bf16_f32 v174, v211, v215
    v_mfma_f32_16x16x32_bf16 a[68:71], v[56:59], v[132:135], a[68:71]
    v_cvt_pk_bf16_f32 v175, v219, v223
    v_mfma_f32_16x16x32_bf16 a[72:75], v[56:59], v[136:139], a[72:75]
    v_exp_f32_e64 v16, v16
    v_mfma_f32_16x16x32_bf16 a[76:79], v[56:59], v[140:143], a[76:79]
    ds_read_b128 v[104:107], v3 offset:18432
    buffer_store_dwordx4 v[172:175], v9, s[20:23], s60 offen offset:3072 sc1
    v_mfma_f32_16x16x32_bf16 a[80:83], v[56:59], v[144:147], a[80:83]
    v_exp_f32_e64 v17, v17
    v_mfma_f32_16x16x32_bf16 a[84:87], v[56:59], v[148:151], a[84:87]
    v_cvt_pk_bf16_f32 v48, v16, v17
    v_mfma_f32_16x16x32_bf16 a[88:91], v[56:59], v[152:155], a[88:91]
    v_exp_f32_e64 v18, v18
    v_mfma_f32_16x16x32_bf16 a[92:95], v[56:59], v[156:159], a[92:95]
    ds_read_b128 v[108:111], v3 offset:19456
    v_mfma_f32_16x16x32_bf16 a[136:139], v[56:59], a[244:247], a[136:139]
    v_exp_f32_e64 v19, v19
    v_mfma_f32_16x16x32_bf16 v[24:27], v[64:67], a[160:163], v[120:123]
    v_cvt_pk_bf16_f32 v49, v18, v19
    v_mfma_f32_16x16x32_bf16 v[24:27], v[68:71], a[164:167], v[24:27]
    v_exp_f32_e64 v20, v20
    v_mfma_f32_16x16x32_bf16 v[24:27], v[72:75], a[168:171], v[24:27]
    ds_read_b128 v[112:115], v3 offset:20480
    v_mfma_f32_16x16x32_bf16 v[24:27], v[76:79], a[172:175], v[24:27]
    v_exp_f32_e64 v21, v21
    v_mfma_f32_16x16x32_bf16 v[28:31], v[80:83], a[160:163], v[124:127]
    v_cvt_pk_bf16_f32 v50, v20, v21
    v_mfma_f32_16x16x32_bf16 v[28:31], v[84:87], a[164:167], v[28:31]
    v_exp_f32_e64 v22, v22
    v_mfma_f32_16x16x32_bf16 v[28:31], v[88:91], a[168:171], v[28:31]
    ds_read_b128 v[116:119], v3 offset:21504
    v_mfma_f32_16x16x32_bf16 v[28:31], v[92:95], a[172:175], v[28:31]
    v_exp_f32_e64 v23, v23
    v_mfma_f32_16x16x32_bf16 a[96:99], v[60:63], v[128:131], a[96:99]
    v_cvt_pk_bf16_f32 v51, v22, v23
    v_mfma_f32_16x16x32_bf16 a[100:103], v[60:63], v[132:135], a[100:103]
    v_mfma_f32_16x16x32_bf16 a[104:107], v[60:63], v[136:139], a[104:107]
    v_exp_f32_e64 v24, v24
    v_mfma_f32_16x16x32_bf16 a[108:111], v[60:63], v[140:143], a[108:111]
    ds_read_b128 a[248:251], v3 offset:22528
    v_mfma_f32_16x16x32_bf16 a[112:115], v[60:63], v[144:147], a[112:115]
    v_exp_f32_e64 v25, v25
    v_mfma_f32_16x16x32_bf16 a[116:119], v[60:63], v[148:151], a[116:119]
    v_cvt_pk_bf16_f32 v52, v24, v25
    v_mfma_f32_16x16x32_bf16 a[120:123], v[60:63], v[152:155], a[120:123]
    v_exp_f32_e64 v26, v26
    v_mfma_f32_16x16x32_bf16 a[124:127], v[60:63], v[156:159], a[124:127]
    ds_read_b128 a[252:255], v3 offset:23552
    s_waitcnt lgkmcnt(8)
    v_mfma_f32_16x16x32_bf16 a[140:143], v[60:63], a[244:247], a[140:143]
    v_exp_f32_e32 v27, v27
    v_mfma_f32_16x16x32_bf16 v[32:35], v[64:67], a[176:179], v[120:123]
    v_cvt_pk_bf16_f32 v53, v26, v27
    v_mfma_f32_16x16x32_bf16 v[32:35], v[68:71], a[180:183], v[32:35]
    v_exp_f32_e64 v28, v28
    v_mfma_f32_16x16x32_bf16 v[32:35], v[72:75], a[184:187], v[32:35]
    ds_read_b128 v[128:131], v3 offset:24576
    v_mfma_f32_16x16x32_bf16 v[32:35], v[76:79], a[188:191], v[32:35]
    v_exp_f32_e64 v29, v29
    v_mfma_f32_16x16x32_bf16 v[36:39], v[80:83], a[176:179], v[124:127]
    v_cvt_pk_bf16_f32 v54, v28, v29
    v_mfma_f32_16x16x32_bf16 v[36:39], v[84:87], a[180:183], v[36:39]
    v_exp_f32_e64 v30, v30
    v_mfma_f32_16x16x32_bf16 v[36:39], v[88:91], a[184:187], v[36:39]
    ds_read_b128 v[132:135], v3 offset:25600
    v_mfma_f32_16x16x32_bf16 v[36:39], v[92:95], a[188:191], v[36:39]
    v_exp_f32_e64 v31, v31
    v_mfma_f32_16x16x32_bf16 a[0:3], v[48:51], a[208:211], a[0:3]
    v_cvt_pk_bf16_f32 v55, v30, v31
    v_mfma_f32_16x16x32_bf16 a[4:7], v[48:51], a[212:215], a[4:7]
    s_add_u32 s56, s75, s58
    s_add_u32 s55, s56, 0x4000
    v_mfma_f32_16x16x32_bf16 a[8:11], v[48:51], a[216:219], a[8:11]
    v_exp_f32_e32 v32, v32
    v_mfma_f32_16x16x32_bf16 a[12:15], v[48:51], a[220:223], a[12:15]
    ds_read_b128 v[136:139], v3 offset:26624
    v_mfma_f32_16x16x32_bf16 a[16:19], v[48:51], a[224:227], a[16:19]
    v_exp_f32_e64 v33, v33
    v_mfma_f32_16x16x32_bf16 a[20:23], v[48:51], a[228:231], a[20:23]
    v_cvt_pk_bf16_f32 v56, v32, v33
    v_mfma_f32_16x16x32_bf16 a[24:27], v[48:51], a[232:235], a[24:27]
    v_exp_f32_e64 v34, v34
    v_mfma_f32_16x16x32_bf16 a[28:31], v[48:51], a[236:239], a[28:31]
    ds_read_b128 v[140:143], v3 offset:27648
    v_mfma_f32_16x16x32_bf16 a[128:131], v[48:51], a[240:243], a[128:131]
    v_exp_f32_e64 v35, v35
    v_mfma_f32_16x16x32_bf16 v[40:43], v[64:67], a[192:195], v[120:123]
    v_cvt_pk_bf16_f32 v57, v34, v35
    v_mfma_f32_16x16x32_bf16 v[40:43], v[68:71], a[196:199], v[40:43]
    v_exp_f32_e64 v36, v36
    v_mfma_f32_16x16x32_bf16 v[40:43], v[72:75], a[200:203], v[40:43]
    ds_read_b128 v[144:147], v3 offset:28672
    v_mfma_f32_16x16x32_bf16 v[40:43], v[76:79], a[204:207], v[40:43]
    v_exp_f32_e64 v37, v37
    v_mfma_f32_16x16x32_bf16 v[44:47], v[80:83], a[192:195], v[124:127]
    ds_read_b128 v[120:123], v1 offset:640
    v_cvt_pk_bf16_f32 v58, v36, v37
    v_mfma_f32_16x16x32_bf16 v[44:47], v[84:87], a[196:199], v[44:47]
    v_exp_f32_e64 v38, v38
    v_mfma_f32_16x16x32_bf16 v[44:47], v[88:91], a[200:203], v[44:47]
    ds_read_b128 v[148:151], v3 offset:29696
    v_mfma_f32_16x16x32_bf16 v[44:47], v[92:95], a[204:207], v[44:47]
    v_exp_f32_e64 v39, v39
    v_mfma_f32_16x16x32_bf16 a[32:35], v[52:55], a[208:211], a[32:35]
    ds_read_b128 v[124:127], v1 offset:704
    v_cvt_pk_bf16_f32 v59, v38, v39
    v_mfma_f32_16x16x32_bf16 a[36:39], v[52:55], a[212:215], a[36:39]
    s_add_u32 m0, s88, 0x8000
    s_lshr_b32 s3, s56, 5
    v_mfma_f32_16x16x32_bf16 a[40:43], v[52:55], a[216:219], a[40:43]
    v_exp_f32_e32 v40, v40
    v_mfma_f32_16x16x32_bf16 a[44:47], v[52:55], a[220:223], a[44:47]
    ds_read_b128 v[152:155], v3 offset:30720
    v_mfma_f32_16x16x32_bf16 a[48:51], v[52:55], a[224:227], a[48:51]
    v_exp_f32_e64 v41, v41
    v_mfma_f32_16x16x32_bf16 a[52:55], v[52:55], a[228:231], a[52:55]
    ds_read2_b64 a[244:247], v14 offset0:160 offset1:164
    v_cvt_pk_bf16_f32 v60, v40, v41
    v_mfma_f32_16x16x32_bf16 a[56:59], v[52:55], a[232:235], a[56:59]
    v_exp_f32_e64 v42, v42
    v_mfma_f32_16x16x32_bf16 a[60:63], v[52:55], a[236:239], a[60:63]
    ds_read_b128 v[156:159], v3 offset:31744
    s_waitcnt vmcnt(17) lgkmcnt(5)
    v_mfma_f32_16x16x32_bf16 a[132:135], v[52:55], a[240:243], a[132:135]
    v_exp_f32_e32 v43, v43
    v_mfma_f32_16x16x32_bf16 v[16:19], v[96:99], a[144:147], v[120:123]
    s_barrier
    v_cvt_pk_bf16_f32 v61, v42, v43
    v_mfma_f32_16x16x32_bf16 v[16:19], v[100:103], a[148:151], v[16:19]
    v_exp_f32_e32 v44, v44
    v_mfma_f32_16x16x32_bf16 v[16:19], v[104:107], a[152:155], v[16:19]
    ds_read_b128 v[64:67], v3 offset:32768
    s_waitcnt lgkmcnt(4)
    v_mfma_f32_16x16x32_bf16 v[16:19], v[108:111], a[156:159], v[16:19]
    v_exp_f32_e32 v45, v45
    v_mfma_f32_16x16x32_bf16 v[20:23], v[112:115], a[144:147], v[124:127]
    buffer_load_dwordx4 v4, s[20:23], s56 offen sc1 lds
    v_cvt_pk_bf16_f32 v62, v44, v45
    v_mfma_f32_16x16x32_bf16 v[20:23], v[116:119], a[148:151], v[20:23]
    v_exp_f32_e64 v46, v46
    v_mfma_f32_16x16x32_bf16 v[20:23], a[248:251], a[152:155], v[20:23]
    ds_read_b128 v[68:71], v3 offset:33792
    v_mfma_f32_16x16x32_bf16 v[20:23], a[252:255], a[156:159], v[20:23]
    v_exp_f32_e64 v47, v47
    v_mfma_f32_16x16x32_bf16 a[64:67], v[56:59], a[208:211], a[64:67]
    buffer_load_dwordx4 v4, s[20:23], s56 offen offset:1024 sc1 lds
    v_cvt_pk_bf16_f32 v63, v46, v47
    v_mfma_f32_16x16x32_bf16 a[68:71], v[56:59], a[212:215], a[68:71]
    buffer_load_dwordx4 v4, s[20:23], s56 offen offset:2048 sc1 lds
    v_mfma_f32_16x16x32_bf16 a[72:75], v[56:59], a[216:219], a[72:75]
    v_exp_f32_e64 v16, v16
    v_mfma_f32_16x16x32_bf16 a[76:79], v[56:59], a[220:223], a[76:79]
    ds_read_b128 v[72:75], v3 offset:34816
    v_mfma_f32_16x16x32_bf16 a[80:83], v[56:59], a[224:227], a[80:83]
    v_exp_f32_e64 v17, v17
    v_mfma_f32_16x16x32_bf16 a[84:87], v[56:59], a[228:231], a[84:87]
    buffer_load_dwordx4 v4, s[20:23], s56 offen offset:3072 sc1 lds
    v_cvt_pk_bf16_f32 v48, v16, v17
    v_mfma_f32_16x16x32_bf16 a[88:91], v[56:59], a[232:235], a[88:91]
    v_exp_f32_e64 v18, v18
    v_mfma_f32_16x16x32_bf16 a[92:95], v[56:59], a[236:239], a[92:95]
    ds_read_b128 v[76:79], v3 offset:35840
    s_add_u32 m0, s88, 0xc000
    v_mfma_f32_16x16x32_bf16 a[136:139], v[56:59], a[240:243], a[136:139]
    v_exp_f32_e64 v19, v19
    v_mfma_f32_16x16x32_bf16 v[24:27], v[96:99], a[160:163], v[120:123]
    buffer_load_dwordx4 v4, s[20:23], s55 offen sc1 lds
    v_cvt_pk_bf16_f32 v49, v18, v19
    v_mfma_f32_16x16x32_bf16 v[24:27], v[100:103], a[164:167], v[24:27]
    v_exp_f32_e64 v20, v20
    v_mfma_f32_16x16x32_bf16 v[24:27], v[104:107], a[168:171], v[24:27]
    ds_read_b128 v[80:83], v3 offset:36864
    v_mfma_f32_16x16x32_bf16 v[24:27], v[108:111], a[172:175], v[24:27]
    v_exp_f32_e64 v21, v21
    v_mfma_f32_16x16x32_bf16 v[28:31], v[112:115], a[160:163], v[124:127]
    buffer_load_dwordx4 v4, s[20:23], s55 offen offset:1024 sc1 lds
    v_cvt_pk_bf16_f32 v50, v20, v21
    v_mfma_f32_16x16x32_bf16 v[28:31], v[116:119], a[164:167], v[28:31]
    v_exp_f32_e64 v22, v22
    v_mfma_f32_16x16x32_bf16 v[28:31], a[248:251], a[168:171], v[28:31]
    ds_read_b128 v[84:87], v3 offset:37888
    v_mfma_f32_16x16x32_bf16 v[28:31], a[252:255], a[172:175], v[28:31]
    v_exp_f32_e64 v23, v23
    v_mfma_f32_16x16x32_bf16 a[96:99], v[60:63], a[208:211], a[96:99]
    buffer_load_dwordx4 v4, s[20:23], s55 offen offset:2048 sc1 lds
    v_cvt_pk_bf16_f32 v51, v22, v23
    v_mfma_f32_16x16x32_bf16 a[100:103], v[60:63], a[212:215], a[100:103]
    buffer_load_dwordx4 v4, s[20:23], s55 offen offset:3072 sc1 lds
    v_mfma_f32_16x16x32_bf16 a[104:107], v[60:63], a[216:219], a[104:107]
    v_exp_f32_e64 v24, v24
    v_mfma_f32_16x16x32_bf16 a[108:111], v[60:63], a[220:223], a[108:111]
    ds_read_b128 v[88:91], v3 offset:38912
    s_add_u32 m0, s10, s84
    v_mfma_f32_16x16x32_bf16 a[112:115], v[60:63], a[224:227], a[112:115]
    v_exp_f32_e32 v25, v25
    v_mfma_f32_16x16x32_bf16 a[116:119], v[60:63], a[228:231], a[116:119]
    buffer_load_dword v15, s[80:83], s3 offen sc1 lds
    v_cvt_pk_bf16_f32 v52, v24, v25
    v_mfma_f32_16x16x32_bf16 a[120:123], v[60:63], a[232:235], a[120:123]
    v_exp_f32_e64 v26, v26
    v_mfma_f32_16x16x32_bf16 a[124:127], v[60:63], a[236:239], a[124:127]
    ds_read_b128 v[92:95], v3 offset:39936
    s_waitcnt lgkmcnt(8)
    v_mfma_f32_16x16x32_bf16 a[140:143], v[60:63], a[240:243], a[140:143]
    v_exp_f32_e32 v27, v27
    v_mfma_f32_16x16x32_bf16 v[32:35], v[96:99], a[176:179], v[120:123]
    v_cvt_pk_bf16_f32 v53, v26, v27
    v_mfma_f32_16x16x32_bf16 v[32:35], v[100:103], a[180:183], v[32:35]
    v_exp_f32_e64 v28, v28
    v_mfma_f32_16x16x32_bf16 v[32:35], v[104:107], a[184:187], v[32:35]
    ds_read_b128 a[208:211], v3 offset:40960
    v_mfma_f32_16x16x32_bf16 v[32:35], v[108:111], a[188:191], v[32:35]
    v_exp_f32_e64 v29, v29
    v_mfma_f32_16x16x32_bf16 v[36:39], v[112:115], a[176:179], v[124:127]
    v_cvt_pk_bf16_f32 v54, v28, v29
    v_mfma_f32_16x16x32_bf16 v[36:39], v[116:119], a[180:183], v[36:39]
    v_exp_f32_e64 v30, v30
    v_mfma_f32_16x16x32_bf16 v[36:39], a[248:251], a[184:187], v[36:39]
    ds_read_b128 a[212:215], v3 offset:41984
    v_mfma_f32_16x16x32_bf16 v[36:39], a[252:255], a[188:191], v[36:39]
    v_exp_f32_e64 v31, v31
    v_mfma_f32_16x16x32_bf16 a[0:3], v[48:51], v[128:131], a[0:3]
    v_cvt_pk_bf16_f32 v55, v30, v31
    v_mfma_f32_16x16x32_bf16 a[4:7], v[48:51], v[132:135], a[4:7]
    v_mfma_f32_16x16x32_bf16 a[8:11], v[48:51], v[136:139], a[8:11]
    v_exp_f32_e64 v32, v32
    v_mfma_f32_16x16x32_bf16 a[12:15], v[48:51], v[140:143], a[12:15]
    ds_read_b128 a[216:219], v3 offset:43008
    v_mfma_f32_16x16x32_bf16 a[16:19], v[48:51], v[144:147], a[16:19]
    v_exp_f32_e64 v33, v33
    v_mfma_f32_16x16x32_bf16 a[20:23], v[48:51], v[148:151], a[20:23]
    v_cvt_pk_bf16_f32 v56, v32, v33
    v_mfma_f32_16x16x32_bf16 a[24:27], v[48:51], v[152:155], a[24:27]
    v_exp_f32_e64 v34, v34
    v_mfma_f32_16x16x32_bf16 a[28:31], v[48:51], v[156:159], a[28:31]
    ds_read_b128 a[220:223], v3 offset:44032
    v_mfma_f32_16x16x32_bf16 a[128:131], v[48:51], a[244:247], a[128:131]
    v_exp_f32_e64 v35, v35
    v_mfma_f32_16x16x32_bf16 v[40:43], v[96:99], a[192:195], v[120:123]
    v_cvt_pk_bf16_f32 v57, v34, v35
    v_mfma_f32_16x16x32_bf16 v[40:43], v[100:103], a[196:199], v[40:43]
    v_exp_f32_e64 v36, v36
    v_mfma_f32_16x16x32_bf16 v[40:43], v[104:107], a[200:203], v[40:43]
    ds_read_b128 a[224:227], v3 offset:45056
    v_mfma_f32_16x16x32_bf16 v[40:43], v[108:111], a[204:207], v[40:43]
    v_exp_f32_e64 v37, v37
    v_mfma_f32_16x16x32_bf16 v[44:47], v[112:115], a[192:195], v[124:127]
    ds_read_b128 v[120:123], v1 offset:768
    v_cvt_pk_bf16_f32 v58, v36, v37
    v_mfma_f32_16x16x32_bf16 v[44:47], v[116:119], a[196:199], v[44:47]
    v_exp_f32_e64 v38, v38
    v_mfma_f32_16x16x32_bf16 v[44:47], a[248:251], a[200:203], v[44:47]
    ds_read_b128 a[228:231], v3 offset:46080
    v_mfma_f32_16x16x32_bf16 v[44:47], a[252:255], a[204:207], v[44:47]
    v_exp_f32_e64 v39, v39
    v_mfma_f32_16x16x32_bf16 a[32:35], v[52:55], v[128:131], a[32:35]
    ds_read_b128 v[124:127], v1 offset:832
    v_cvt_pk_bf16_f32 v59, v38, v39
    v_mfma_f32_16x16x32_bf16 a[36:39], v[52:55], v[132:135], a[36:39]
    v_mfma_f32_16x16x32_bf16 a[40:43], v[52:55], v[136:139], a[40:43]
    v_exp_f32_e64 v40, v40
    v_mfma_f32_16x16x32_bf16 a[44:47], v[52:55], v[140:143], a[44:47]
    ds_read_b128 a[232:235], v3 offset:47104
    v_mfma_f32_16x16x32_bf16 a[48:51], v[52:55], v[144:147], a[48:51]
    v_exp_f32_e64 v41, v41
    v_mfma_f32_16x16x32_bf16 a[52:55], v[52:55], v[148:151], a[52:55]
    ds_read2_b64 a[240:243], v14 offset0:192 offset1:196
    v_cvt_pk_bf16_f32 v60, v40, v41
    v_mfma_f32_16x16x32_bf16 a[56:59], v[52:55], v[152:155], a[56:59]
    v_exp_f32_e64 v42, v42
    v_mfma_f32_16x16x32_bf16 a[60:63], v[52:55], v[156:159], a[60:63]
    ds_read_b128 a[236:239], v3 offset:48128
    s_waitcnt lgkmcnt(5)
    v_mfma_f32_16x16x32_bf16 a[132:135], v[52:55], a[244:247], a[132:135]
    v_exp_f32_e32 v43, v43
    v_mfma_f32_16x16x32_bf16 v[16:19], v[64:67], a[144:147], v[120:123]
    v_cvt_pk_bf16_f32 v61, v42, v43
    v_mfma_f32_16x16x32_bf16 v[16:19], v[68:71], a[148:151], v[16:19]
    v_exp_f32_e64 v44, v44
    v_mfma_f32_16x16x32_bf16 v[16:19], v[72:75], a[152:155], v[16:19]
    ds_read_b128 v[96:99], v3 offset:49152
    s_waitcnt lgkmcnt(4)
    v_mfma_f32_16x16x32_bf16 v[16:19], v[76:79], a[156:159], v[16:19]
    v_exp_f32_e32 v45, v45
    v_mfma_f32_16x16x32_bf16 v[20:23], v[80:83], a[144:147], v[124:127]
    v_cvt_pk_bf16_f32 v62, v44, v45
    v_mfma_f32_16x16x32_bf16 v[20:23], v[84:87], a[148:151], v[20:23]
    v_exp_f32_e64 v46, v46
    v_mfma_f32_16x16x32_bf16 v[20:23], v[88:91], a[152:155], v[20:23]
    ds_read_b128 v[100:103], v3 offset:50176
    v_mfma_f32_16x16x32_bf16 v[20:23], v[92:95], a[156:159], v[20:23]
    v_exp_f32_e64 v47, v47
    v_mfma_f32_16x16x32_bf16 a[64:67], v[56:59], v[128:131], a[64:67]
    v_cvt_pk_bf16_f32 v63, v46, v47
    v_mfma_f32_16x16x32_bf16 a[68:71], v[56:59], v[132:135], a[68:71]
    v_mfma_f32_16x16x32_bf16 a[72:75], v[56:59], v[136:139], a[72:75]
    v_exp_f32_e64 v16, v16
    v_mfma_f32_16x16x32_bf16 a[76:79], v[56:59], v[140:143], a[76:79]
    ds_read_b128 v[104:107], v3 offset:51200
    v_mfma_f32_16x16x32_bf16 a[80:83], v[56:59], v[144:147], a[80:83]
    v_exp_f32_e64 v17, v17
    v_mfma_f32_16x16x32_bf16 a[84:87], v[56:59], v[148:151], a[84:87]
    v_cvt_pk_bf16_f32 v48, v16, v17
    v_mfma_f32_16x16x32_bf16 a[88:91], v[56:59], v[152:155], a[88:91]
    v_exp_f32_e64 v18, v18
    v_mfma_f32_16x16x32_bf16 a[92:95], v[56:59], v[156:159], a[92:95]
    ds_read_b128 v[108:111], v3 offset:52224
    v_mfma_f32_16x16x32_bf16 a[136:139], v[56:59], a[244:247], a[136:139]
    v_exp_f32_e64 v19, v19
    v_mfma_f32_16x16x32_bf16 v[24:27], v[64:67], a[160:163], v[120:123]
    v_cvt_pk_bf16_f32 v49, v18, v19
    v_mfma_f32_16x16x32_bf16 v[24:27], v[68:71], a[164:167], v[24:27]
    v_exp_f32_e64 v20, v20
    v_mfma_f32_16x16x32_bf16 v[24:27], v[72:75], a[168:171], v[24:27]
    ds_read_b128 v[112:115], v3 offset:53248
    v_mfma_f32_16x16x32_bf16 v[24:27], v[76:79], a[172:175], v[24:27]
    v_exp_f32_e64 v21, v21
    v_mfma_f32_16x16x32_bf16 v[28:31], v[80:83], a[160:163], v[124:127]
    v_cvt_pk_bf16_f32 v50, v20, v21
    v_mfma_f32_16x16x32_bf16 v[28:31], v[84:87], a[164:167], v[28:31]
    v_exp_f32_e64 v22, v22
    v_mfma_f32_16x16x32_bf16 v[28:31], v[88:91], a[168:171], v[28:31]
    ds_read_b128 v[116:119], v3 offset:54272
    v_mfma_f32_16x16x32_bf16 v[28:31], v[92:95], a[172:175], v[28:31]
    v_exp_f32_e64 v23, v23
    v_mfma_f32_16x16x32_bf16 a[96:99], v[60:63], v[128:131], a[96:99]
    v_cvt_pk_bf16_f32 v51, v22, v23
    v_mfma_f32_16x16x32_bf16 a[100:103], v[60:63], v[132:135], a[100:103]
    v_mfma_f32_16x16x32_bf16 a[104:107], v[60:63], v[136:139], a[104:107]
    v_exp_f32_e64 v24, v24
    v_mfma_f32_16x16x32_bf16 a[108:111], v[60:63], v[140:143], a[108:111]
    ds_read_b128 a[248:251], v3 offset:55296
    v_mfma_f32_16x16x32_bf16 a[112:115], v[60:63], v[144:147], a[112:115]
    v_exp_f32_e64 v25, v25
    v_mfma_f32_16x16x32_bf16 a[116:119], v[60:63], v[148:151], a[116:119]
    v_cvt_pk_bf16_f32 v52, v24, v25
    v_mfma_f32_16x16x32_bf16 a[120:123], v[60:63], v[152:155], a[120:123]
    v_exp_f32_e64 v26, v26
    v_mfma_f32_16x16x32_bf16 a[124:127], v[60:63], v[156:159], a[124:127]
    ds_read_b128 a[252:255], v3 offset:56320
    s_waitcnt lgkmcnt(8)
    v_mfma_f32_16x16x32_bf16 a[140:143], v[60:63], a[244:247], a[140:143]
    v_exp_f32_e32 v27, v27
    v_mfma_f32_16x16x32_bf16 v[32:35], v[64:67], a[176:179], v[120:123]
    v_cvt_pk_bf16_f32 v53, v26, v27
    v_mfma_f32_16x16x32_bf16 v[32:35], v[68:71], a[180:183], v[32:35]
    v_exp_f32_e64 v28, v28
    v_mfma_f32_16x16x32_bf16 v[32:35], v[72:75], a[184:187], v[32:35]
    ds_read_b128 v[128:131], v3 offset:57344
    v_mfma_f32_16x16x32_bf16 v[32:35], v[76:79], a[188:191], v[32:35]
    v_exp_f32_e64 v29, v29
    v_mfma_f32_16x16x32_bf16 v[36:39], v[80:83], a[176:179], v[124:127]
    v_cvt_pk_bf16_f32 v54, v28, v29
    v_mfma_f32_16x16x32_bf16 v[36:39], v[84:87], a[180:183], v[36:39]
    v_exp_f32_e64 v30, v30
    v_mfma_f32_16x16x32_bf16 v[36:39], v[88:91], a[184:187], v[36:39]
    ds_read_b128 v[132:135], v3 offset:58368
    v_mfma_f32_16x16x32_bf16 v[36:39], v[92:95], a[188:191], v[36:39]
    v_exp_f32_e64 v31, v31
    v_mfma_f32_16x16x32_bf16 a[0:3], v[48:51], a[208:211], a[0:3]
    v_cvt_pk_bf16_f32 v55, v30, v31
    v_mfma_f32_16x16x32_bf16 a[4:7], v[48:51], a[212:215], a[4:7]
    s_add_u32 s56, s76, s58
    s_add_u32 s55, s56, 0x4000
    v_mfma_f32_16x16x32_bf16 a[8:11], v[48:51], a[216:219], a[8:11]
    v_exp_f32_e32 v32, v32
    v_mfma_f32_16x16x32_bf16 a[12:15], v[48:51], a[220:223], a[12:15]
    ds_read_b128 v[136:139], v3 offset:59392
    v_mfma_f32_16x16x32_bf16 a[16:19], v[48:51], a[224:227], a[16:19]
    v_exp_f32_e64 v33, v33
    v_mfma_f32_16x16x32_bf16 a[20:23], v[48:51], a[228:231], a[20:23]
    v_cvt_pk_bf16_f32 v56, v32, v33
    v_mfma_f32_16x16x32_bf16 a[24:27], v[48:51], a[232:235], a[24:27]
    v_exp_f32_e64 v34, v34
    v_mfma_f32_16x16x32_bf16 a[28:31], v[48:51], a[236:239], a[28:31]
    ds_read_b128 v[140:143], v3 offset:60416
    s_add_u32 s60, s60, 0x40000
    v_mfma_f32_16x16x32_bf16 a[128:131], v[48:51], a[240:243], a[128:131]
    v_exp_f32_e64 v35, v35
    v_mfma_f32_16x16x32_bf16 v[40:43], v[64:67], a[192:195], v[120:123]
    v_cvt_pk_bf16_f32 v57, v34, v35
    v_mfma_f32_16x16x32_bf16 v[40:43], v[68:71], a[196:199], v[40:43]
    v_exp_f32_e64 v36, v36
    v_mfma_f32_16x16x32_bf16 v[40:43], v[72:75], a[200:203], v[40:43]
    ds_read_b128 v[144:147], v3 offset:61440
    s_add_u32 s61, s61, 0x400
    v_mfma_f32_16x16x32_bf16 v[40:43], v[76:79], a[204:207], v[40:43]
    v_exp_f32_e64 v37, v37
    v_mfma_f32_16x16x32_bf16 v[44:47], v[80:83], a[192:195], v[124:127]
    ds_read_b128 v[120:123], v1 offset:896
    v_cvt_pk_bf16_f32 v58, v36, v37
    v_mfma_f32_16x16x32_bf16 v[44:47], v[84:87], a[196:199], v[44:47]
    v_exp_f32_e64 v38, v38
    v_mfma_f32_16x16x32_bf16 v[44:47], v[88:91], a[200:203], v[44:47]
    ds_read_b128 v[148:151], v3 offset:62464
    s_add_u32 s62, s62, 0x400
    v_mfma_f32_16x16x32_bf16 v[44:47], v[92:95], a[204:207], v[44:47]
    v_exp_f32_e64 v39, v39
    v_mfma_f32_16x16x32_bf16 a[32:35], v[52:55], a[208:211], a[32:35]
    ds_read_b128 v[124:127], v1 offset:960
    v_cvt_pk_bf16_f32 v59, v38, v39
    v_mfma_f32_16x16x32_bf16 a[36:39], v[52:55], a[212:215], a[36:39]
    s_add_u32 m0, s88, 0x10000
    s_lshr_b32 s3, s56, 5
    v_mfma_f32_16x16x32_bf16 a[40:43], v[52:55], a[216:219], a[40:43]
    v_exp_f32_e32 v40, v40
    v_mfma_f32_16x16x32_bf16 a[44:47], v[52:55], a[220:223], a[44:47]
    ds_read_b128 v[152:155], v3 offset:63488
    s_lshr_b32 s89, s60, 5
    v_mfma_f32_16x16x32_bf16 a[48:51], v[52:55], a[224:227], a[48:51]
    v_exp_f32_e32 v41, v41
    v_mfma_f32_16x16x32_bf16 a[52:55], v[52:55], a[228:231], a[52:55]
    ds_read2_b64 a[244:247], v14 offset0:224 offset1:228
    v_cvt_pk_bf16_f32 v60, v40, v41
    v_mfma_f32_16x16x32_bf16 a[56:59], v[52:55], a[232:235], a[56:59]
    v_exp_f32_e64 v42, v42
    v_mfma_f32_16x16x32_bf16 a[60:63], v[52:55], a[236:239], a[60:63]
    ds_read_b128 v[156:159], v3 offset:64512
    s_waitcnt vmcnt(11) lgkmcnt(5)
    v_mfma_f32_16x16x32_bf16 a[132:135], v[52:55], a[240:243], a[132:135]
    v_exp_f32_e32 v43, v43
    v_mfma_f32_16x16x32_bf16 v[16:19], v[96:99], a[144:147], v[120:123]
    s_barrier
    v_cvt_pk_bf16_f32 v61, v42, v43
    v_mfma_f32_16x16x32_bf16 v[16:19], v[100:103], a[148:151], v[16:19]
    v_exp_f32_e32 v44, v44
    v_mfma_f32_16x16x32_bf16 v[16:19], v[104:107], a[152:155], v[16:19]
    ds_read_b128 v[64:67], v2
    s_waitcnt lgkmcnt(4)
    v_mfma_f32_16x16x32_bf16 v[16:19], v[108:111], a[156:159], v[16:19]
    v_exp_f32_e32 v45, v45
    v_mfma_f32_16x16x32_bf16 v[20:23], v[112:115], a[144:147], v[124:127]
    buffer_load_dwordx4 v4, s[20:23], s56 offen sc1 lds
    v_cvt_pk_bf16_f32 v62, v44, v45
    v_mfma_f32_16x16x32_bf16 v[20:23], v[116:119], a[148:151], v[20:23]
    v_exp_f32_e64 v46, v46
    v_mfma_f32_16x16x32_bf16 v[20:23], a[248:251], a[152:155], v[20:23]
    ds_read_b128 v[68:71], v2 offset:1024
    v_mfma_f32_16x16x32_bf16 v[20:23], a[252:255], a[156:159], v[20:23]
    v_exp_f32_e64 v47, v47
    v_mfma_f32_16x16x32_bf16 a[64:67], v[56:59], a[208:211], a[64:67]
    buffer_load_dwordx4 v4, s[20:23], s56 offen offset:1024 sc1 lds
    v_cvt_pk_bf16_f32 v63, v46, v47
    v_mfma_f32_16x16x32_bf16 a[68:71], v[56:59], a[212:215], a[68:71]
    buffer_load_dwordx4 v4, s[20:23], s56 offen offset:2048 sc1 lds
    v_mfma_f32_16x16x32_bf16 a[72:75], v[56:59], a[216:219], a[72:75]
    v_exp_f32_e64 v16, v16
    v_mfma_f32_16x16x32_bf16 a[76:79], v[56:59], a[220:223], a[76:79]
    ds_read_b128 v[72:75], v2 offset:2048
    v_mfma_f32_16x16x32_bf16 a[80:83], v[56:59], a[224:227], a[80:83]
    v_exp_f32_e64 v17, v17
    v_mfma_f32_16x16x32_bf16 a[84:87], v[56:59], a[228:231], a[84:87]
    buffer_load_dwordx4 v4, s[20:23], s56 offen offset:3072 sc1 lds
    v_cvt_pk_bf16_f32 v48, v16, v17
    v_mfma_f32_16x16x32_bf16 a[88:91], v[56:59], a[232:235], a[88:91]
    v_exp_f32_e64 v18, v18
    v_mfma_f32_16x16x32_bf16 a[92:95], v[56:59], a[236:239], a[92:95]
    ds_read_b128 v[76:79], v2 offset:3072
    s_add_u32 m0, s88, 0x14000
    v_mfma_f32_16x16x32_bf16 a[136:139], v[56:59], a[240:243], a[136:139]
    v_exp_f32_e64 v19, v19
    v_mfma_f32_16x16x32_bf16 v[24:27], v[96:99], a[160:163], v[120:123]
    buffer_load_dwordx4 v4, s[20:23], s55 offen sc1 lds
    v_cvt_pk_bf16_f32 v49, v18, v19
    v_mfma_f32_16x16x32_bf16 v[24:27], v[100:103], a[164:167], v[24:27]
    v_exp_f32_e64 v20, v20
    v_mfma_f32_16x16x32_bf16 v[24:27], v[104:107], a[168:171], v[24:27]
    ds_read_b128 v[80:83], v2 offset:4096
    v_mfma_f32_16x16x32_bf16 v[24:27], v[108:111], a[172:175], v[24:27]
    v_exp_f32_e64 v21, v21
    v_mfma_f32_16x16x32_bf16 v[28:31], v[112:115], a[160:163], v[124:127]
    buffer_load_dwordx4 v4, s[20:23], s55 offen offset:1024 sc1 lds
    v_cvt_pk_bf16_f32 v50, v20, v21
    v_mfma_f32_16x16x32_bf16 v[28:31], v[116:119], a[164:167], v[28:31]
    v_exp_f32_e64 v22, v22
    v_mfma_f32_16x16x32_bf16 v[28:31], a[248:251], a[168:171], v[28:31]
    ds_read_b128 v[84:87], v2 offset:5120
    v_mfma_f32_16x16x32_bf16 v[28:31], a[252:255], a[172:175], v[28:31]
    v_exp_f32_e64 v23, v23
    v_mfma_f32_16x16x32_bf16 a[96:99], v[60:63], a[208:211], a[96:99]
    buffer_load_dwordx4 v4, s[20:23], s55 offen offset:2048 sc1 lds
    v_cvt_pk_bf16_f32 v51, v22, v23
    v_mfma_f32_16x16x32_bf16 a[100:103], v[60:63], a[212:215], a[100:103]
    buffer_load_dwordx4 v4, s[20:23], s55 offen offset:3072 sc1 lds
    v_mfma_f32_16x16x32_bf16 a[104:107], v[60:63], a[216:219], a[104:107]
    v_exp_f32_e64 v24, v24
    v_mfma_f32_16x16x32_bf16 a[108:111], v[60:63], a[220:223], a[108:111]
    ds_read_b128 v[88:91], v2 offset:6144
    s_lshl1_add_u32 m0, s84, s10
    v_mfma_f32_16x16x32_bf16 a[112:115], v[60:63], a[224:227], a[112:115]
    v_exp_f32_e32 v25, v25
    v_mfma_f32_16x16x32_bf16 a[116:119], v[60:63], a[228:231], a[116:119]
    buffer_load_dword v15, s[80:83], s3 offen sc1 lds
    v_cvt_pk_bf16_f32 v52, v24, v25
    v_mfma_f32_16x16x32_bf16 a[120:123], v[60:63], a[232:235], a[120:123]
    v_exp_f32_e64 v26, v26
    v_mfma_f32_16x16x32_bf16 a[124:127], v[60:63], a[236:239], a[124:127]
    ds_read_b128 v[92:95], v2 offset:7168
    s_waitcnt lgkmcnt(8)
    v_mfma_f32_16x16x32_bf16 a[140:143], v[60:63], a[240:243], a[140:143]
    v_exp_f32_e32 v27, v27
    v_mfma_f32_16x16x32_bf16 v[32:35], v[96:99], a[176:179], v[120:123]
    v_cvt_pk_bf16_f32 v53, v26, v27
    v_mfma_f32_16x16x32_bf16 v[32:35], v[100:103], a[180:183], v[32:35]
    v_exp_f32_e64 v28, v28
    v_mfma_f32_16x16x32_bf16 v[32:35], v[104:107], a[184:187], v[32:35]
    ds_read_b128 a[208:211], v2 offset:8192
    v_lshrrev_b32_e64 v228, 3, v2
    v_mfma_f32_16x16x32_bf16 v[32:35], v[108:111], a[188:191], v[32:35]
    v_exp_f32_e64 v29, v29
    v_mfma_f32_16x16x32_bf16 v[36:39], v[112:115], a[176:179], v[124:127]
    v_cvt_pk_bf16_f32 v54, v28, v29
    v_and_b32_e32 v228, 0x70, v228
    v_mfma_f32_16x16x32_bf16 v[36:39], v[116:119], a[180:183], v[36:39]
    v_exp_f32_e64 v30, v30
    v_mfma_f32_16x16x32_bf16 v[36:39], a[248:251], a[184:187], v[36:39]
    ds_read_b128 a[212:215], v2 offset:9216
    v_add_u32_e64 v228, s95, v228
    v_mfma_f32_16x16x32_bf16 v[36:39], a[252:255], a[188:191], v[36:39]
    v_exp_f32_e64 v31, v31
    v_mfma_f32_16x16x32_bf16 a[0:3], v[48:51], v[128:131], a[0:3]
    buffer_load_dwordx4 v[224:227], v228, s[32:35], s61 offen
    v_cvt_pk_bf16_f32 v55, v30, v31
    v_mfma_f32_16x16x32_bf16 a[4:7], v[48:51], v[132:135], a[4:7]
    buffer_load_dwordx4 v[228:231], v228, s[36:39], s61 offen
    v_mfma_f32_16x16x32_bf16 a[8:11], v[48:51], v[136:139], a[8:11]
    v_exp_f32_e64 v32, v32
    v_mfma_f32_16x16x32_bf16 a[12:15], v[48:51], v[140:143], a[12:15]
    ds_read_b128 a[216:219], v2 offset:10240
    buffer_load_dwordx4 v[160:163], v5, s[24:27], s60 offen nt
    v_mfma_f32_16x16x32_bf16 a[16:19], v[48:51], v[144:147], a[16:19]
    v_exp_f32_e64 v33, v33
    v_mfma_f32_16x16x32_bf16 a[20:23], v[48:51], v[148:151], a[20:23]
    buffer_load_dwordx4 v[164:167], v5, s[24:27], s60 offen offset:16 nt
    v_cvt_pk_bf16_f32 v56, v32, v33
    v_mfma_f32_16x16x32_bf16 a[24:27], v[48:51], v[152:155], a[24:27]
    v_exp_f32_e64 v34, v34
    v_mfma_f32_16x16x32_bf16 a[28:31], v[48:51], v[156:159], a[28:31]
    ds_read_b128 a[220:223], v2 offset:11264
    s_add_u32 s67, s60, 0x1000
    v_mfma_f32_16x16x32_bf16 a[128:131], v[48:51], a[244:247], a[128:131]
    v_exp_f32_e64 v35, v35
    v_mfma_f32_16x16x32_bf16 v[40:43], v[96:99], a[192:195], v[120:123]
    buffer_load_dwordx4 v[168:171], v5, s[24:27], s67 offen nt
    v_cvt_pk_bf16_f32 v57, v34, v35
    v_mfma_f32_16x16x32_bf16 v[40:43], v[100:103], a[196:199], v[40:43]
    v_exp_f32_e64 v36, v36
    v_mfma_f32_16x16x32_bf16 v[40:43], v[104:107], a[200:203], v[40:43]
    ds_read_b128 a[224:227], v2 offset:12288
    v_mfma_f32_16x16x32_bf16 v[40:43], v[108:111], a[204:207], v[40:43]
    v_exp_f32_e64 v37, v37
    v_mfma_f32_16x16x32_bf16 v[44:47], v[112:115], a[192:195], v[124:127]
    ds_read_b128 v[120:123], v1
    v_cvt_pk_bf16_f32 v58, v36, v37
    v_mfma_f32_16x16x32_bf16 v[44:47], v[116:119], a[196:199], v[44:47]
    v_exp_f32_e64 v38, v38
    v_mfma_f32_16x16x32_bf16 v[44:47], a[248:251], a[200:203], v[44:47]
    ds_read_b128 a[228:231], v2 offset:13312
    v_mfma_f32_16x16x32_bf16 v[44:47], a[252:255], a[204:207], v[44:47]
    v_exp_f32_e64 v39, v39
    v_mfma_f32_16x16x32_bf16 a[32:35], v[52:55], v[128:131], a[32:35]
    ds_read_b128 v[124:127], v1 offset:64
    v_cvt_pk_bf16_f32 v59, v38, v39
    v_mfma_f32_16x16x32_bf16 a[36:39], v[52:55], v[132:135], a[36:39]
    v_mfma_f32_16x16x32_bf16 a[40:43], v[52:55], v[136:139], a[40:43]
    v_exp_f32_e64 v40, v40
    v_mfma_f32_16x16x32_bf16 a[44:47], v[52:55], v[140:143], a[44:47]
    ds_read_b128 a[232:235], v2 offset:14336
    v_mfma_f32_16x16x32_bf16 a[48:51], v[52:55], v[144:147], a[48:51]
    v_exp_f32_e64 v41, v41
    v_mfma_f32_16x16x32_bf16 a[52:55], v[52:55], v[148:151], a[52:55]
    ds_read2_b64 a[240:243], v14 offset0:0 offset1:4
    v_cvt_pk_bf16_f32 v60, v40, v41
    v_mfma_f32_16x16x32_bf16 a[56:59], v[52:55], v[152:155], a[56:59]
    v_exp_f32_e64 v42, v42
    v_mfma_f32_16x16x32_bf16 a[60:63], v[52:55], v[156:159], a[60:63]
    ds_read_b128 a[236:239], v2 offset:15360
    s_waitcnt lgkmcnt(5)
    v_mfma_f32_16x16x32_bf16 a[132:135], v[52:55], a[244:247], a[132:135]
    v_exp_f32_e32 v43, v43
.p2align 3
at_mid:
    v_mfma_f32_16x16x32_bf16 v[16:19], v[64:67], a[144:147], v[120:123]
    v_cvt_pk_bf16_f32 v61, v42, v43
    v_mfma_f32_16x16x32_bf16 v[16:19], v[68:71], a[148:151], v[16:19]
    v_exp_f32_e64 v44, v44
    v_mfma_f32_16x16x32_bf16 v[16:19], v[72:75], a[152:155], v[16:19]
    ds_read_b128 v[96:99], v2 offset:16384
    s_waitcnt lgkmcnt(4)
    v_mfma_f32_16x16x32_bf16 v[16:19], v[76:79], a[156:159], v[16:19]
    v_exp_f32_e32 v45, v45
    v_mfma_f32_16x16x32_bf16 v[20:23], v[80:83], a[144:147], v[124:127]
    v_cvt_pk_bf16_f32 v62, v44, v45
    v_mfma_f32_16x16x32_bf16 v[20:23], v[84:87], a[148:151], v[20:23]
    v_exp_f32_e64 v46, v46
    v_mfma_f32_16x16x32_bf16 v[20:23], v[88:91], a[152:155], v[20:23]
    ds_read_b128 v[100:103], v2 offset:17408
    v_mfma_f32_16x16x32_bf16 v[20:23], v[92:95], a[156:159], v[20:23]
    v_exp_f32_e64 v47, v47
    v_mfma_f32_16x16x32_bf16 a[64:67], v[56:59], v[128:131], a[64:67]
    v_cvt_pk_bf16_f32 v63, v46, v47
    v_mfma_f32_16x16x32_bf16 a[68:71], v[56:59], v[132:135], a[68:71]
    v_mfma_f32_16x16x32_bf16 a[72:75], v[56:59], v[136:139], a[72:75]
    v_exp_f32_e64 v16, v16
    v_mfma_f32_16x16x32_bf16 a[76:79], v[56:59], v[140:143], a[76:79]
    ds_read_b128 v[104:107], v2 offset:18432
    v_mfma_f32_16x16x32_bf16 a[80:83], v[56:59], v[144:147], a[80:83]
    v_exp_f32_e64 v17, v17
    v_mfma_f32_16x16x32_bf16 a[84:87], v[56:59], v[148:151], a[84:87]
    v_cvt_pk_bf16_f32 v48, v16, v17
    v_mfma_f32_16x16x32_bf16 a[88:91], v[56:59], v[152:155], a[88:91]
    v_exp_f32_e64 v18, v18
    v_mfma_f32_16x16x32_bf16 a[92:95], v[56:59], v[156:159], a[92:95]
    ds_read_b128 v[108:111], v2 offset:19456
    v_mfma_f32_16x16x32_bf16 a[136:139], v[56:59], a[244:247], a[136:139]
    v_exp_f32_e64 v19, v19
    v_mfma_f32_16x16x32_bf16 v[24:27], v[64:67], a[160:163], v[120:123]
    v_cvt_pk_bf16_f32 v49, v18, v19
    v_mfma_f32_16x16x32_bf16 v[24:27], v[68:71], a[164:167], v[24:27]
    v_exp_f32_e64 v20, v20
    v_mfma_f32_16x16x32_bf16 v[24:27], v[72:75], a[168:171], v[24:27]
    ds_read_b128 v[112:115], v2 offset:20480
    v_mfma_f32_16x16x32_bf16 v[24:27], v[76:79], a[172:175], v[24:27]
    v_exp_f32_e64 v21, v21
    v_mfma_f32_16x16x32_bf16 v[28:31], v[80:83], a[160:163], v[124:127]
    v_cvt_pk_bf16_f32 v50, v20, v21
    v_mfma_f32_16x16x32_bf16 v[28:31], v[84:87], a[164:167], v[28:31]
    v_exp_f32_e64 v22, v22
    v_mfma_f32_16x16x32_bf16 v[28:31], v[88:91], a[168:171], v[28:31]
    ds_read_b128 v[116:119], v2 offset:21504
    v_mfma_f32_16x16x32_bf16 v[28:31], v[92:95], a[172:175], v[28:31]
    v_exp_f32_e64 v23, v23
    v_mfma_f32_16x16x32_bf16 a[96:99], v[60:63], v[128:131], a[96:99]
    v_cvt_pk_bf16_f32 v51, v22, v23
    v_mfma_f32_16x16x32_bf16 a[100:103], v[60:63], v[132:135], a[100:103]
    v_mfma_f32_16x16x32_bf16 a[104:107], v[60:63], v[136:139], a[104:107]
    v_exp_f32_e64 v24, v24
    v_mfma_f32_16x16x32_bf16 a[108:111], v[60:63], v[140:143], a[108:111]
    ds_read_b128 a[248:251], v2 offset:22528
    v_mfma_f32_16x16x32_bf16 a[112:115], v[60:63], v[144:147], a[112:115]
    v_exp_f32_e64 v25, v25
    v_mfma_f32_16x16x32_bf16 a[116:119], v[60:63], v[148:151], a[116:119]
    v_cvt_pk_bf16_f32 v52, v24, v25
    v_mfma_f32_16x16x32_bf16 a[120:123], v[60:63], v[152:155], a[120:123]
    v_exp_f32_e64 v26, v26
    v_mfma_f32_16x16x32_bf16 a[124:127], v[60:63], v[156:159], a[124:127]
    ds_read_b128 a[252:255], v2 offset:23552
    s_waitcnt lgkmcnt(8)
    v_mfma_f32_16x16x32_bf16 a[140:143], v[60:63], a[244:247], a[140:143]
    v_exp_f32_e32 v27, v27
    v_mfma_f32_16x16x32_bf16 v[32:35], v[64:67], a[176:179], v[120:123]
    v_cvt_pk_bf16_f32 v53, v26, v27
    v_mfma_f32_16x16x32_bf16 v[32:35], v[68:71], a[180:183], v[32:35]
    v_exp_f32_e64 v28, v28
    v_mfma_f32_16x16x32_bf16 v[32:35], v[72:75], a[184:187], v[32:35]
    ds_read_b128 v[128:131], v2 offset:24576
    v_mfma_f32_16x16x32_bf16 v[32:35], v[76:79], a[188:191], v[32:35]
    v_exp_f32_e64 v29, v29
    v_mfma_f32_16x16x32_bf16 v[36:39], v[80:83], a[176:179], v[124:127]
    v_cvt_pk_bf16_f32 v54, v28, v29
    v_mfma_f32_16x16x32_bf16 v[36:39], v[84:87], a[180:183], v[36:39]
    v_exp_f32_e64 v30, v30
    v_mfma_f32_16x16x32_bf16 v[36:39], v[88:91], a[184:187], v[36:39]
    ds_read_b128 v[132:135], v2 offset:25600
    v_mfma_f32_16x16x32_bf16 v[36:39], v[92:95], a[188:191], v[36:39]
    v_exp_f32_e64 v31, v31
    v_mfma_f32_16x16x32_bf16 a[0:3], v[48:51], a[208:211], a[0:3]
    v_cvt_pk_bf16_f32 v55, v30, v31
    v_mfma_f32_16x16x32_bf16 a[4:7], v[48:51], a[212:215], a[4:7]
    s_add_u32 s56, s77, s58
    s_add_u32 s55, s56, 0x4000
    v_mfma_f32_16x16x32_bf16 a[8:11], v[48:51], a[216:219], a[8:11]
    v_exp_f32_e32 v32, v32
    v_mfma_f32_16x16x32_bf16 a[12:15], v[48:51], a[220:223], a[12:15]
    ds_read_b128 v[136:139], v2 offset:26624
    v_mfma_f32_16x16x32_bf16 a[16:19], v[48:51], a[224:227], a[16:19]
    v_exp_f32_e64 v33, v33
    v_mfma_f32_16x16x32_bf16 a[20:23], v[48:51], a[228:231], a[20:23]
    v_cvt_pk_bf16_f32 v56, v32, v33
    v_mfma_f32_16x16x32_bf16 a[24:27], v[48:51], a[232:235], a[24:27]
    v_exp_f32_e64 v34, v34
    v_mfma_f32_16x16x32_bf16 a[28:31], v[48:51], a[236:239], a[28:31]
    ds_read_b128 v[140:143], v2 offset:27648
    v_mfma_f32_16x16x32_bf16 a[128:131], v[48:51], a[240:243], a[128:131]
    v_exp_f32_e64 v35, v35
    v_mfma_f32_16x16x32_bf16 v[40:43], v[64:67], a[192:195], v[120:123]
    v_cvt_pk_bf16_f32 v57, v34, v35
    v_mfma_f32_16x16x32_bf16 v[40:43], v[68:71], a[196:199], v[40:43]
    v_exp_f32_e64 v36, v36
    v_mfma_f32_16x16x32_bf16 v[40:43], v[72:75], a[200:203], v[40:43]
    ds_read_b128 v[144:147], v2 offset:28672
    v_mfma_f32_16x16x32_bf16 v[40:43], v[76:79], a[204:207], v[40:43]
    v_exp_f32_e64 v37, v37
    v_mfma_f32_16x16x32_bf16 v[44:47], v[80:83], a[192:195], v[124:127]
    ds_read_b128 v[120:123], v1 offset:128
    v_cvt_pk_bf16_f32 v58, v36, v37
    v_mfma_f32_16x16x32_bf16 v[44:47], v[84:87], a[196:199], v[44:47]
    v_exp_f32_e64 v38, v38
    v_mfma_f32_16x16x32_bf16 v[44:47], v[88:91], a[200:203], v[44:47]
    ds_read_b128 v[148:151], v2 offset:29696
    v_mfma_f32_16x16x32_bf16 v[44:47], v[92:95], a[204:207], v[44:47]
    v_exp_f32_e64 v39, v39
    v_mfma_f32_16x16x32_bf16 a[32:35], v[52:55], a[208:211], a[32:35]
    ds_read_b128 v[124:127], v1 offset:192
    v_cvt_pk_bf16_f32 v59, v38, v39
    v_mfma_f32_16x16x32_bf16 a[36:39], v[52:55], a[212:215], a[36:39]
    s_add_u32 m0, s88, 0x18000
    s_lshr_b32 s3, s56, 5
    v_mfma_f32_16x16x32_bf16 a[40:43], v[52:55], a[216:219], a[40:43]
    v_exp_f32_e32 v40, v40
    v_mfma_f32_16x16x32_bf16 a[44:47], v[52:55], a[220:223], a[44:47]
    ds_read_b128 v[152:155], v2 offset:30720
    v_mfma_f32_16x16x32_bf16 a[48:51], v[52:55], a[224:227], a[48:51]
    v_exp_f32_e64 v41, v41
    v_mfma_f32_16x16x32_bf16 a[52:55], v[52:55], a[228:231], a[52:55]
    ds_read2_b64 a[244:247], v14 offset0:32 offset1:36
    v_cvt_pk_bf16_f32 v60, v40, v41
    v_mfma_f32_16x16x32_bf16 a[56:59], v[52:55], a[232:235], a[56:59]
    v_exp_f32_e64 v42, v42
    v_mfma_f32_16x16x32_bf16 a[60:63], v[52:55], a[236:239], a[60:63]
    ds_read_b128 v[156:159], v2 offset:31744
    s_waitcnt vmcnt(14) lgkmcnt(5)
    v_mfma_f32_16x16x32_bf16 a[132:135], v[52:55], a[240:243], a[132:135]
    v_exp_f32_e32 v43, v43
    v_mfma_f32_16x16x32_bf16 v[16:19], v[96:99], a[144:147], v[120:123]
    s_barrier
    v_cvt_pk_bf16_f32 v61, v42, v43
    v_mfma_f32_16x16x32_bf16 v[16:19], v[100:103], a[148:151], v[16:19]
    v_exp_f32_e32 v44, v44
    v_mfma_f32_16x16x32_bf16 v[16:19], v[104:107], a[152:155], v[16:19]
    ds_read_b128 v[64:67], v2 offset:32768
    s_waitcnt lgkmcnt(4)
    v_mfma_f32_16x16x32_bf16 v[16:19], v[108:111], a[156:159], v[16:19]
    v_exp_f32_e32 v45, v45
    v_mfma_f32_16x16x32_bf16 v[20:23], v[112:115], a[144:147], v[124:127]
    buffer_load_dwordx4 v4, s[20:23], s56 offen sc1 lds
    v_cvt_pk_bf16_f32 v62, v44, v45
    v_mfma_f32_16x16x32_bf16 v[20:23], v[116:119], a[148:151], v[20:23]
    v_exp_f32_e64 v46, v46
    v_mfma_f32_16x16x32_bf16 v[20:23], a[248:251], a[152:155], v[20:23]
    ds_read_b128 v[68:71], v2 offset:33792
    v_mfma_f32_16x16x32_bf16 v[20:23], a[252:255], a[156:159], v[20:23]
    v_exp_f32_e64 v47, v47
    v_mfma_f32_16x16x32_bf16 a[64:67], v[56:59], a[208:211], a[64:67]
    buffer_load_dwordx4 v4, s[20:23], s56 offen offset:1024 sc1 lds
    v_cvt_pk_bf16_f32 v63, v46, v47
    v_mfma_f32_16x16x32_bf16 a[68:71], v[56:59], a[212:215], a[68:71]
    buffer_load_dwordx4 v4, s[20:23], s56 offen offset:2048 sc1 lds
    v_mfma_f32_16x16x32_bf16 a[72:75], v[56:59], a[216:219], a[72:75]
    v_exp_f32_e64 v16, v16
    v_mfma_f32_16x16x32_bf16 a[76:79], v[56:59], a[220:223], a[76:79]
    ds_read_b128 v[72:75], v2 offset:34816
    v_mfma_f32_16x16x32_bf16 a[80:83], v[56:59], a[224:227], a[80:83]
    v_exp_f32_e64 v17, v17
    v_mfma_f32_16x16x32_bf16 a[84:87], v[56:59], a[228:231], a[84:87]
    buffer_load_dwordx4 v4, s[20:23], s56 offen offset:3072 sc1 lds
    v_cvt_pk_bf16_f32 v48, v16, v17
    v_mfma_f32_16x16x32_bf16 a[88:91], v[56:59], a[232:235], a[88:91]
    v_exp_f32_e64 v18, v18
    v_mfma_f32_16x16x32_bf16 a[92:95], v[56:59], a[236:239], a[92:95]
    ds_read_b128 v[76:79], v2 offset:35840
    s_add_u32 m0, s88, 0x1c000
    v_mfma_f32_16x16x32_bf16 a[136:139], v[56:59], a[240:243], a[136:139]
    v_exp_f32_e64 v19, v19
    v_mfma_f32_16x16x32_bf16 v[24:27], v[96:99], a[160:163], v[120:123]
    buffer_load_dwordx4 v4, s[20:23], s55 offen sc1 lds
    v_cvt_pk_bf16_f32 v49, v18, v19
    v_mfma_f32_16x16x32_bf16 v[24:27], v[100:103], a[164:167], v[24:27]
    v_exp_f32_e64 v20, v20
    v_mfma_f32_16x16x32_bf16 v[24:27], v[104:107], a[168:171], v[24:27]
    ds_read_b128 v[80:83], v2 offset:36864
    v_mov_b32_e64 v12, s92
    v_mfma_f32_16x16x32_bf16 v[24:27], v[108:111], a[172:175], v[24:27]
    v_exp_f32_e64 v21, v21
    v_mfma_f32_16x16x32_bf16 v[28:31], v[112:115], a[160:163], v[124:127]
    buffer_load_dwordx4 v4, s[20:23], s55 offen offset:1024 sc1 lds
    v_cvt_pk_bf16_f32 v50, v20, v21
    v_mfma_f32_16x16x32_bf16 v[28:31], v[116:119], a[164:167], v[28:31]
    v_exp_f32_e64 v22, v22
    v_mfma_f32_16x16x32_bf16 v[28:31], a[248:251], a[168:171], v[28:31]
    ds_read_b128 v[84:87], v2 offset:37888
    v_mov_b32_e64 v13, s93
    v_mfma_f32_16x16x32_bf16 v[28:31], a[252:255], a[172:175], v[28:31]
    v_exp_f32_e64 v23, v23
    v_mfma_f32_16x16x32_bf16 a[96:99], v[60:63], a[208:211], a[96:99]
    buffer_load_dwordx4 v4, s[20:23], s55 offen offset:2048 sc1 lds
    v_cvt_pk_bf16_f32 v51, v22, v23
    v_mfma_f32_16x16x32_bf16 a[100:103], v[60:63], a[212:215], a[100:103]
    buffer_load_dwordx4 v4, s[20:23], s55 offen offset:3072 sc1 lds
    v_mfma_f32_16x16x32_bf16 a[104:107], v[60:63], a[216:219], a[104:107]
    v_exp_f32_e64 v24, v24
    v_mfma_f32_16x16x32_bf16 a[108:111], v[60:63], a[220:223], a[108:111]
    ds_read_b128 v[88:91], v2 offset:38912
    s_mov_b32 m0, s85
    v_mfma_f32_16x16x32_bf16 a[112:115], v[60:63], a[224:227], a[112:115]
    v_exp_f32_e32 v25, v25
    v_mfma_f32_16x16x32_bf16 a[116:119], v[60:63], a[228:231], a[116:119]
    buffer_load_dword v15, s[80:83], s3 offen sc1 lds
    v_cvt_pk_bf16_f32 v52, v24, v25
    v_mfma_f32_16x16x32_bf16 a[120:123], v[60:63], a[232:235], a[120:123]
    v_exp_f32_e64 v26, v26
    v_mfma_f32_16x16x32_bf16 a[124:127], v[60:63], a[236:239], a[124:127]
    ds_read_b128 v[92:95], v2 offset:39936
    s_waitcnt lgkmcnt(8)
    v_mfma_f32_16x16x32_bf16 a[140:143], v[60:63], a[240:243], a[140:143]
    v_exp_f32_e32 v27, v27
    v_mfma_f32_16x16x32_bf16 v[32:35], v[96:99], a[176:179], v[120:123]
    buffer_store_dwordx2 v[12:13], v0, s[48:51], s87 offen sc1
    v_cvt_pk_bf16_f32 v53, v26, v27
    v_mfma_f32_16x16x32_bf16 v[32:35], v[100:103], a[180:183], v[32:35]
    v_exp_f32_e64 v28, v28
    v_mfma_f32_16x16x32_bf16 v[32:35], v[104:107], a[184:187], v[32:35]
    ds_read_b128 a[208:211], v2 offset:40960
    buffer_load_dwordx4 v[172:175], v5, s[24:27], s67 offen offset:16 nt
    v_mfma_f32_16x16x32_bf16 v[32:35], v[108:111], a[188:191], v[32:35]
    v_exp_f32_e64 v29, v29
    v_mfma_f32_16x16x32_bf16 v[36:39], v[112:115], a[176:179], v[124:127]
    v_cvt_pk_bf16_f32 v54, v28, v29
    s_add_u32 s67, s60, 0x2000
    v_mfma_f32_16x16x32_bf16 v[36:39], v[116:119], a[180:183], v[36:39]
    v_exp_f32_e64 v30, v30
    v_mfma_f32_16x16x32_bf16 v[36:39], a[248:251], a[184:187], v[36:39]
    ds_read_b128 a[212:215], v2 offset:41984
    buffer_load_dwordx4 v[176:179], v5, s[24:27], s67 offen nt
    v_mfma_f32_16x16x32_bf16 v[36:39], a[252:255], a[188:191], v[36:39]
    v_exp_f32_e64 v31, v31
    v_mfma_f32_16x16x32_bf16 a[0:3], v[48:51], v[128:131], a[0:3]
    buffer_load_dwordx4 v[180:183], v5, s[24:27], s67 offen offset:16 nt
    v_cvt_pk_bf16_f32 v55, v30, v31
    v_mfma_f32_16x16x32_bf16 a[4:7], v[48:51], v[132:135], a[4:7]
    s_add_u32 s67, s60, 0x3000
    v_mfma_f32_16x16x32_bf16 a[8:11], v[48:51], v[136:139], a[8:11]
    v_exp_f32_e64 v32, v32
    v_mfma_f32_16x16x32_bf16 a[12:15], v[48:51], v[140:143], a[12:15]
    ds_read_b128 a[216:219], v2 offset:43008
    buffer_load_dwordx4 v[184:187], v5, s[24:27], s67 offen nt
    v_mfma_f32_16x16x32_bf16 a[16:19], v[48:51], v[144:147], a[16:19]
    v_exp_f32_e64 v33, v33
    v_mfma_f32_16x16x32_bf16 a[20:23], v[48:51], v[148:151], a[20:23]
    buffer_load_dwordx4 v[188:191], v5, s[24:27], s67 offen offset:16 nt
    v_cvt_pk_bf16_f32 v56, v32, v33
    v_mfma_f32_16x16x32_bf16 a[24:27], v[48:51], v[152:155], a[24:27]
    v_exp_f32_e64 v34, v34
    v_mfma_f32_16x16x32_bf16 a[28:31], v[48:51], v[156:159], a[28:31]
    ds_read_b128 a[220:223], v2 offset:44032
    v_mfma_f32_16x16x32_bf16 a[128:131], v[48:51], a[244:247], a[128:131]
    v_exp_f32_e64 v35, v35
    v_mfma_f32_16x16x32_bf16 v[40:43], v[96:99], a[192:195], v[120:123]
    v_cvt_pk_bf16_f32 v57, v34, v35
    v_mfma_f32_16x16x32_bf16 v[40:43], v[100:103], a[196:199], v[40:43]
    v_exp_f32_e64 v36, v36
    v_mfma_f32_16x16x32_bf16 v[40:43], v[104:107], a[200:203], v[40:43]
    ds_read_b128 a[224:227], v2 offset:45056
    v_mfma_f32_16x16x32_bf16 v[40:43], v[108:111], a[204:207], v[40:43]
    v_exp_f32_e64 v37, v37
    v_mfma_f32_16x16x32_bf16 v[44:47], v[112:115], a[192:195], v[124:127]
    ds_read_b128 v[120:123], v1 offset:256
    v_cvt_pk_bf16_f32 v58, v36, v37
    v_mfma_f32_16x16x32_bf16 v[44:47], v[116:119], a[196:199], v[44:47]
    v_exp_f32_e64 v38, v38
    v_mfma_f32_16x16x32_bf16 v[44:47], a[248:251], a[200:203], v[44:47]
    ds_read_b128 a[228:231], v2 offset:46080
    v_mfma_f32_16x16x32_bf16 v[44:47], a[252:255], a[204:207], v[44:47]
    v_exp_f32_e64 v39, v39
    v_mfma_f32_16x16x32_bf16 a[32:35], v[52:55], v[128:131], a[32:35]
    ds_read_b128 v[124:127], v1 offset:320
    v_cvt_pk_bf16_f32 v59, v38, v39
    v_mfma_f32_16x16x32_bf16 a[36:39], v[52:55], v[132:135], a[36:39]
    v_mfma_f32_16x16x32_bf16 a[40:43], v[52:55], v[136:139], a[40:43]
    v_exp_f32_e64 v40, v40
    v_mfma_f32_16x16x32_bf16 a[44:47], v[52:55], v[140:143], a[44:47]
    ds_read_b128 a[232:235], v2 offset:47104
    v_mfma_f32_16x16x32_bf16 a[48:51], v[52:55], v[144:147], a[48:51]
    v_exp_f32_e64 v41, v41
    v_mfma_f32_16x16x32_bf16 a[52:55], v[52:55], v[148:151], a[52:55]
    ds_read2_b64 a[240:243], v14 offset0:64 offset1:68
    v_cvt_pk_bf16_f32 v60, v40, v41
    v_mfma_f32_16x16x32_bf16 a[56:59], v[52:55], v[152:155], a[56:59]
    v_exp_f32_e64 v42, v42
    v_mfma_f32_16x16x32_bf16 a[60:63], v[52:55], v[156:159], a[60:63]
    ds_read_b128 a[236:239], v2 offset:48128
    s_waitcnt lgkmcnt(5)
    v_mfma_f32_16x16x32_bf16 a[132:135], v[52:55], a[244:247], a[132:135]
    v_exp_f32_e32 v43, v43
    v_mfma_f32_16x16x32_bf16 v[16:19], v[64:67], a[144:147], v[120:123]
    v_cvt_pk_bf16_f32 v61, v42, v43
    v_mfma_f32_16x16x32_bf16 v[16:19], v[68:71], a[148:151], v[16:19]
    v_exp_f32_e64 v44, v44
    v_mfma_f32_16x16x32_bf16 v[16:19], v[72:75], a[152:155], v[16:19]
    ds_read_b128 v[96:99], v2 offset:49152
    s_waitcnt lgkmcnt(4)
    v_mfma_f32_16x16x32_bf16 v[16:19], v[76:79], a[156:159], v[16:19]
    v_exp_f32_e32 v45, v45
    v_mfma_f32_16x16x32_bf16 v[20:23], v[80:83], a[144:147], v[124:127]
    v_cvt_pk_bf16_f32 v62, v44, v45
    v_mfma_f32_16x16x32_bf16 v[20:23], v[84:87], a[148:151], v[20:23]
    v_exp_f32_e64 v46, v46
    v_mfma_f32_16x16x32_bf16 v[20:23], v[88:91], a[152:155], v[20:23]
    ds_read_b128 v[100:103], v2 offset:50176
    v_mfma_f32_16x16x32_bf16 v[20:23], v[92:95], a[156:159], v[20:23]
    v_exp_f32_e64 v47, v47
    v_mfma_f32_16x16x32_bf16 a[64:67], v[56:59], v[128:131], a[64:67]
    v_cvt_pk_bf16_f32 v63, v46, v47
    v_mfma_f32_16x16x32_bf16 a[68:71], v[56:59], v[132:135], a[68:71]
    v_mfma_f32_16x16x32_bf16 a[72:75], v[56:59], v[136:139], a[72:75]
    v_exp_f32_e64 v16, v16
    v_mfma_f32_16x16x32_bf16 a[76:79], v[56:59], v[140:143], a[76:79]
    ds_read_b128 v[104:107], v2 offset:51200
    v_mfma_f32_16x16x32_bf16 a[80:83], v[56:59], v[144:147], a[80:83]
    v_exp_f32_e64 v17, v17
    v_mfma_f32_16x16x32_bf16 a[84:87], v[56:59], v[148:151], a[84:87]
    v_cvt_pk_bf16_f32 v48, v16, v17
    v_mfma_f32_16x16x32_bf16 a[88:91], v[56:59], v[152:155], a[88:91]
    v_exp_f32_e64 v18, v18
    v_mfma_f32_16x16x32_bf16 a[92:95], v[56:59], v[156:159], a[92:95]
    ds_read_b128 v[108:111], v2 offset:52224
    v_mfma_f32_16x16x32_bf16 a[136:139], v[56:59], a[244:247], a[136:139]
    v_exp_f32_e64 v19, v19
    v_mfma_f32_16x16x32_bf16 v[24:27], v[64:67], a[160:163], v[120:123]
    v_cvt_pk_bf16_f32 v49, v18, v19
    v_mfma_f32_16x16x32_bf16 v[24:27], v[68:71], a[164:167], v[24:27]
    v_exp_f32_e64 v20, v20
    v_mfma_f32_16x16x32_bf16 v[24:27], v[72:75], a[168:171], v[24:27]
    ds_read_b128 v[112:115], v2 offset:53248
    v_mfma_f32_16x16x32_bf16 v[24:27], v[76:79], a[172:175], v[24:27]
    v_exp_f32_e64 v21, v21
    v_mfma_f32_16x16x32_bf16 v[28:31], v[80:83], a[160:163], v[124:127]
    v_cvt_pk_bf16_f32 v50, v20, v21
    v_mfma_f32_16x16x32_bf16 v[28:31], v[84:87], a[164:167], v[28:31]
    v_exp_f32_e64 v22, v22
    v_mfma_f32_16x16x32_bf16 v[28:31], v[88:91], a[168:171], v[28:31]
    ds_read_b128 v[116:119], v2 offset:54272
    v_mfma_f32_16x16x32_bf16 v[28:31], v[92:95], a[172:175], v[28:31]
    v_exp_f32_e64 v23, v23
    v_mfma_f32_16x16x32_bf16 a[96:99], v[60:63], v[128:131], a[96:99]
    v_cvt_pk_bf16_f32 v51, v22, v23
    v_mfma_f32_16x16x32_bf16 a[100:103], v[60:63], v[132:135], a[100:103]
    v_mfma_f32_16x16x32_bf16 a[104:107], v[60:63], v[136:139], a[104:107]
    v_exp_f32_e64 v24, v24
    v_mfma_f32_16x16x32_bf16 a[108:111], v[60:63], v[140:143], a[108:111]
    ds_read_b128 a[248:251], v2 offset:55296
    v_mfma_f32_16x16x32_bf16 a[112:115], v[60:63], v[144:147], a[112:115]
    v_exp_f32_e64 v25, v25
    v_mfma_f32_16x16x32_bf16 a[116:119], v[60:63], v[148:151], a[116:119]
    v_cvt_pk_bf16_f32 v52, v24, v25
    v_mfma_f32_16x16x32_bf16 a[120:123], v[60:63], v[152:155], a[120:123]
    v_exp_f32_e64 v26, v26
    v_mfma_f32_16x16x32_bf16 a[124:127], v[60:63], v[156:159], a[124:127]
    ds_read_b128 a[252:255], v2 offset:56320
    s_waitcnt lgkmcnt(8)
    v_mfma_f32_16x16x32_bf16 a[140:143], v[60:63], a[244:247], a[140:143]
    v_exp_f32_e32 v27, v27
    v_mfma_f32_16x16x32_bf16 v[32:35], v[64:67], a[176:179], v[120:123]
    v_cvt_pk_bf16_f32 v53, v26, v27
    v_mfma_f32_16x16x32_bf16 v[32:35], v[68:71], a[180:183], v[32:35]
    v_exp_f32_e64 v28, v28
    v_mfma_f32_16x16x32_bf16 v[32:35], v[72:75], a[184:187], v[32:35]
    ds_read_b128 v[128:131], v2 offset:57344
    v_mfma_f32_16x16x32_bf16 v[32:35], v[76:79], a[188:191], v[32:35]
    v_exp_f32_e64 v29, v29
    v_mfma_f32_16x16x32_bf16 v[36:39], v[80:83], a[176:179], v[124:127]
    v_cvt_pk_bf16_f32 v54, v28, v29
    v_mfma_f32_16x16x32_bf16 v[36:39], v[84:87], a[180:183], v[36:39]
    v_exp_f32_e64 v30, v30
    v_mfma_f32_16x16x32_bf16 v[36:39], v[88:91], a[184:187], v[36:39]
    ds_read_b128 v[132:135], v2 offset:58368
    v_mfma_f32_16x16x32_bf16 v[36:39], v[92:95], a[188:191], v[36:39]
    v_exp_f32_e64 v31, v31
    v_mfma_f32_16x16x32_bf16 a[0:3], v[48:51], a[208:211], a[0:3]
    v_cvt_pk_bf16_f32 v55, v30, v31
    v_mfma_f32_16x16x32_bf16 a[4:7], v[48:51], a[212:215], a[4:7]
    s_add_u32 s56, s70, s59
    s_add_u32 s55, s56, 0x4000
    v_mfma_f32_16x16x32_bf16 a[8:11], v[48:51], a[216:219], a[8:11]
    v_exp_f32_e32 v32, v32
    v_mfma_f32_16x16x32_bf16 a[12:15], v[48:51], a[220:223], a[12:15]
    ds_read_b128 v[136:139], v2 offset:59392
    v_mfma_f32_16x16x32_bf16 a[16:19], v[48:51], a[224:227], a[16:19]
    v_exp_f32_e64 v33, v33
    v_mfma_f32_16x16x32_bf16 a[20:23], v[48:51], a[228:231], a[20:23]
    v_cvt_pk_bf16_f32 v56, v32, v33
    v_mfma_f32_16x16x32_bf16 a[24:27], v[48:51], a[232:235], a[24:27]
    v_exp_f32_e64 v34, v34
    v_mfma_f32_16x16x32_bf16 a[28:31], v[48:51], a[236:239], a[28:31]
    ds_read_b128 v[140:143], v2 offset:60416
    v_mfma_f32_16x16x32_bf16 a[128:131], v[48:51], a[240:243], a[128:131]
    v_exp_f32_e64 v35, v35
    v_mfma_f32_16x16x32_bf16 v[40:43], v[64:67], a[192:195], v[120:123]
    v_cvt_pk_bf16_f32 v57, v34, v35
    v_mfma_f32_16x16x32_bf16 v[40:43], v[68:71], a[196:199], v[40:43]
    v_exp_f32_e64 v36, v36
    v_mfma_f32_16x16x32_bf16 v[40:43], v[72:75], a[200:203], v[40:43]
    ds_read_b128 v[144:147], v2 offset:61440
    v_mfma_f32_16x16x32_bf16 v[40:43], v[76:79], a[204:207], v[40:43]
    v_exp_f32_e64 v37, v37
    v_mfma_f32_16x16x32_bf16 v[44:47], v[80:83], a[192:195], v[124:127]
    ds_read_b128 v[120:123], v1 offset:384
    v_cvt_pk_bf16_f32 v58, v36, v37
    v_mfma_f32_16x16x32_bf16 v[44:47], v[84:87], a[196:199], v[44:47]
    v_exp_f32_e64 v38, v38
    v_mfma_f32_16x16x32_bf16 v[44:47], v[88:91], a[200:203], v[44:47]
    ds_read_b128 v[148:151], v2 offset:62464
    v_mfma_f32_16x16x32_bf16 v[44:47], v[92:95], a[204:207], v[44:47]
    v_exp_f32_e64 v39, v39
    v_mfma_f32_16x16x32_bf16 a[32:35], v[52:55], a[208:211], a[32:35]
    ds_read_b128 v[124:127], v1 offset:448
    v_cvt_pk_bf16_f32 v59, v38, v39
    v_mfma_f32_16x16x32_bf16 a[36:39], v[52:55], a[212:215], a[36:39]
    s_mov_b32 m0, s88
    s_lshr_b32 s3, s56, 5
    v_mfma_f32_16x16x32_bf16 a[40:43], v[52:55], a[216:219], a[40:43]
    v_exp_f32_e64 v40, v40
    v_mfma_f32_16x16x32_bf16 a[44:47], v[52:55], a[220:223], a[44:47]
    ds_read_b128 v[152:155], v2 offset:63488
    v_mfma_f32_16x16x32_bf16 a[48:51], v[52:55], a[224:227], a[48:51]
    v_exp_f32_e64 v41, v41
    v_mfma_f32_16x16x32_bf16 a[52:55], v[52:55], a[228:231], a[52:55]
    ds_read2_b64 a[244:247], v14 offset0:96 offset1:100
    v_cvt_pk_bf16_f32 v60, v40, v41
    v_mfma_f32_16x16x32_bf16 a[56:59], v[52:55], a[232:235], a[56:59]
    v_exp_f32_e64 v42, v42
    v_mfma_f32_16x16x32_bf16 a[60:63], v[52:55], a[236:239], a[60:63]
    ds_read_b128 v[156:159], v2 offset:64512
    s_waitcnt vmcnt(20) lgkmcnt(5)
    v_mfma_f32_16x16x32_bf16 a[132:135], v[52:55], a[240:243], a[132:135]
    v_exp_f32_e32 v43, v43
    v_mfma_f32_16x16x32_bf16 v[16:19], v[96:99], a[144:147], v[120:123]
    s_barrier
    v_cvt_pk_bf16_f32 v61, v42, v43
    v_mfma_f32_16x16x32_bf16 v[16:19], v[100:103], a[148:151], v[16:19]
    v_exp_f32_e32 v44, v44
    v_mfma_f32_16x16x32_bf16 v[16:19], v[104:107], a[152:155], v[16:19]
    ds_read_b128 v[64:67], v3
    s_waitcnt lgkmcnt(4)
    v_mfma_f32_16x16x32_bf16 v[16:19], v[108:111], a[156:159], v[16:19]
    v_exp_f32_e32 v45, v45
    v_mfma_f32_16x16x32_bf16 v[20:23], v[112:115], a[144:147], v[124:127]
    buffer_load_dwordx4 v4, s[20:23], s56 offen sc1 lds
    v_cvt_pk_bf16_f32 v62, v44, v45
    v_mfma_f32_16x16x32_bf16 v[20:23], v[116:119], a[148:151], v[20:23]
    v_exp_f32_e64 v46, v46
    v_mfma_f32_16x16x32_bf16 v[20:23], a[248:251], a[152:155], v[20:23]
    ds_read_b128 v[68:71], v3 offset:1024
    s_add_u32 s87, s87, 64
    v_mfma_f32_16x16x32_bf16 v[20:23], a[252:255], a[156:159], v[20:23]
    v_exp_f32_e32 v47, v47
    v_mfma_f32_16x16x32_bf16 a[64:67], v[56:59], a[208:211], a[64:67]
    buffer_load_dwordx4 v4, s[20:23], s56 offen offset:1024 sc1 lds
    v_cvt_pk_bf16_f32 v63, v46, v47
    v_mfma_f32_16x16x32_bf16 a[68:71], v[56:59], a[212:215], a[68:71]
    buffer_load_dwordx4 v4, s[20:23], s56 offen offset:2048 sc1 lds
    v_mfma_f32_16x16x32_bf16 a[72:75], v[56:59], a[216:219], a[72:75]
    v_exp_f32_e64 v16, v16
    v_mfma_f32_16x16x32_bf16 a[76:79], v[56:59], a[220:223], a[76:79]
    ds_read_b128 v[72:75], v3 offset:2048
    v_mfma_f32_16x16x32_bf16 a[80:83], v[56:59], a[224:227], a[80:83]
    v_exp_f32_e64 v17, v17
    v_mfma_f32_16x16x32_bf16 a[84:87], v[56:59], a[228:231], a[84:87]
    buffer_load_dwordx4 v4, s[20:23], s56 offen offset:3072 sc1 lds
    v_cvt_pk_bf16_f32 v48, v16, v17
    v_mfma_f32_16x16x32_bf16 a[88:91], v[56:59], a[232:235], a[88:91]
    v_exp_f32_e64 v18, v18
    v_mfma_f32_16x16x32_bf16 a[92:95], v[56:59], a[236:239], a[92:95]
    ds_read_b128 v[76:79], v3 offset:3072
    s_add_u32 m0, s88, 0x4000
    v_mfma_f32_16x16x32_bf16 a[136:139], v[56:59], a[240:243], a[136:139]
    v_exp_f32_e64 v19, v19
    v_mfma_f32_16x16x32_bf16 v[24:27], v[96:99], a[160:163], v[120:123]
    buffer_load_dwordx4 v4, s[20:23], s55 offen sc1 lds
    v_cvt_pk_bf16_f32 v49, v18, v19
    v_mfma_f32_16x16x32_bf16 v[24:27], v[100:103], a[164:167], v[24:27]
    v_exp_f32_e64 v20, v20
    v_mfma_f32_16x16x32_bf16 v[24:27], v[104:107], a[168:171], v[24:27]
    ds_read_b128 v[80:83], v3 offset:4096
    v_mfma_f32_16x16x32_bf16 v[24:27], v[108:111], a[172:175], v[24:27]
    v_exp_f32_e64 v21, v21
    v_mfma_f32_16x16x32_bf16 v[28:31], v[112:115], a[160:163], v[124:127]
    buffer_load_dwordx4 v4, s[20:23], s55 offen offset:1024 sc1 lds
    v_cvt_pk_bf16_f32 v50, v20, v21
    v_mfma_f32_16x16x32_bf16 v[28:31], v[116:119], a[164:167], v[28:31]
    v_exp_f32_e64 v22, v22
    v_mfma_f32_16x16x32_bf16 v[28:31], a[248:251], a[168:171], v[28:31]
    ds_read_b128 v[84:87], v3 offset:5120
    v_lshlrev_b32_e64 v12, 1, v15
    v_mfma_f32_16x16x32_bf16 v[28:31], a[252:255], a[172:175], v[28:31]
    v_exp_f32_e64 v23, v23
    v_mfma_f32_16x16x32_bf16 a[96:99], v[60:63], a[208:211], a[96:99]
    buffer_load_dwordx4 v4, s[20:23], s55 offen offset:2048 sc1 lds
    v_cvt_pk_bf16_f32 v51, v22, v23
    v_mfma_f32_16x16x32_bf16 a[100:103], v[60:63], a[212:215], a[100:103]
    buffer_load_dwordx4 v4, s[20:23], s55 offen offset:3072 sc1 lds
    v_mfma_f32_16x16x32_bf16 a[104:107], v[60:63], a[216:219], a[104:107]
    v_exp_f32_e64 v24, v24
    v_mfma_f32_16x16x32_bf16 a[108:111], v[60:63], a[220:223], a[108:111]
    ds_read_b128 v[88:91], v3 offset:6144
    s_mov_b32 m0, s10
    v_mfma_f32_16x16x32_bf16 a[112:115], v[60:63], a[224:227], a[112:115]
    v_exp_f32_e32 v25, v25
    v_mfma_f32_16x16x32_bf16 a[116:119], v[60:63], a[228:231], a[116:119]
    buffer_load_dword v15, s[80:83], s3 offen sc1 lds
    v_cvt_pk_bf16_f32 v52, v24, v25
    v_mfma_f32_16x16x32_bf16 a[120:123], v[60:63], a[232:235], a[120:123]
    v_exp_f32_e64 v26, v26
    v_mfma_f32_16x16x32_bf16 a[124:127], v[60:63], a[236:239], a[124:127]
    ds_read_b128 v[92:95], v3 offset:7168
    s_waitcnt lgkmcnt(8)
    v_mfma_f32_16x16x32_bf16 a[140:143], v[60:63], a[240:243], a[140:143]
    v_exp_f32_e32 v27, v27
    v_mfma_f32_16x16x32_bf16 v[32:35], v[96:99], a[176:179], v[120:123]
    buffer_load_dwordx2 v[12:13], v12, s[48:51], 0 offen sc1
    v_cvt_pk_bf16_f32 v53, v26, v27
    v_mfma_f32_16x16x32_bf16 v[32:35], v[100:103], a[180:183], v[32:35]
    v_exp_f32_e64 v28, v28
    v_mfma_f32_16x16x32_bf16 v[32:35], v[104:107], a[184:187], v[32:35]
    ds_read_b128 a[208:211], v3 offset:8192
    buffer_load_ushort v232, v10, s[40:43], s62 offen
    v_mfma_f32_16x16x32_bf16 v[32:35], v[108:111], a[188:191], v[32:35]
    v_exp_f32_e64 v29, v29
    v_mfma_f32_16x16x32_bf16 v[36:39], v[112:115], a[176:179], v[124:127]
    buffer_load_ushort v236, v10, s[44:47], s62 offen
    v_cvt_pk_bf16_f32 v54, v28, v29
    v_mfma_f32_16x16x32_bf16 v[36:39], v[116:119], a[180:183], v[36:39]
    v_exp_f32_e64 v30, v30
    v_mfma_f32_16x16x32_bf16 v[36:39], a[248:251], a[184:187], v[36:39]
    ds_read_b128 a[212:215], v3 offset:9216
    buffer_load_dwordx4 v[192:195], v8, s[28:31], s60 offen nt
    v_mfma_f32_16x16x32_bf16 v[36:39], a[252:255], a[188:191], v[36:39]
    v_exp_f32_e64 v31, v31
    v_mfma_f32_16x16x32_bf16 a[0:3], v[48:51], v[128:131], a[0:3]
    buffer_load_dwordx4 v[196:199], v8, s[28:31], s60 offen offset:512 nt
    v_cvt_pk_bf16_f32 v55, v30, v31
    v_mfma_f32_16x16x32_bf16 a[4:7], v[48:51], v[132:135], a[4:7]
    v_mfma_f32_16x16x32_bf16 a[8:11], v[48:51], v[136:139], a[8:11]
    v_exp_f32_e64 v32, v32
    v_mfma_f32_16x16x32_bf16 a[12:15], v[48:51], v[140:143], a[12:15]
    ds_read_b128 a[216:219], v3 offset:10240
    v_mfma_f32_16x16x32_bf16 a[16:19], v[48:51], v[144:147], a[16:19]
    v_exp_f32_e64 v33, v33
    v_mfma_f32_16x16x32_bf16 a[20:23], v[48:51], v[148:151], a[20:23]
    v_cvt_pk_bf16_f32 v56, v32, v33
    v_mfma_f32_16x16x32_bf16 a[24:27], v[48:51], v[152:155], a[24:27]
    v_exp_f32_e64 v34, v34
    v_mfma_f32_16x16x32_bf16 a[28:31], v[48:51], v[156:159], a[28:31]
    ds_read_b128 a[220:223], v3 offset:11264
    v_mfma_f32_16x16x32_bf16 a[128:131], v[48:51], a[244:247], a[128:131]
    v_exp_f32_e64 v35, v35
    v_mfma_f32_16x16x32_bf16 v[40:43], v[96:99], a[192:195], v[120:123]
    v_cvt_pk_bf16_f32 v57, v34, v35
    v_mfma_f32_16x16x32_bf16 v[40:43], v[100:103], a[196:199], v[40:43]
    v_exp_f32_e64 v36, v36
    v_mfma_f32_16x16x32_bf16 v[40:43], v[104:107], a[200:203], v[40:43]
    ds_read_b128 a[224:227], v3 offset:12288
    v_mfma_f32_16x16x32_bf16 v[40:43], v[108:111], a[204:207], v[40:43]
    v_exp_f32_e64 v37, v37
    v_mfma_f32_16x16x32_bf16 v[44:47], v[112:115], a[192:195], v[124:127]
    ds_read_b128 v[120:123], v1 offset:512
    v_cvt_pk_bf16_f32 v58, v36, v37
    v_mfma_f32_16x16x32_bf16 v[44:47], v[116:119], a[196:199], v[44:47]
    v_exp_f32_e64 v38, v38
    v_mfma_f32_16x16x32_bf16 v[44:47], a[248:251], a[200:203], v[44:47]
    ds_read_b128 a[228:231], v3 offset:13312
    s_waitcnt vmcnt(32)
    v_mfma_f32_16x16x32_bf16 v[44:47], a[252:255], a[204:207], v[44:47]
    v_exp_f32_e32 v39, v39
    v_mfma_f32_16x16x32_bf16 a[32:35], v[52:55], v[128:131], a[32:35]
    ds_read_b128 v[124:127], v1 offset:576
    v_cvt_pk_bf16_f32 v59, v38, v39
    v_mfma_f32_16x16x32_bf16 a[36:39], v[52:55], v[132:135], a[36:39]
    v_lshlrev_b32_e32 v240, 16, v224
    v_lshlrev_b32_e32 v248, 16, v228
    v_mfma_f32_16x16x32_bf16 a[40:43], v[52:55], v[136:139], a[40:43]
    v_exp_f32_e64 v40, v40
    v_mfma_f32_16x16x32_bf16 a[44:47], v[52:55], v[140:143], a[44:47]
    ds_read_b128 a[232:235], v3 offset:14336
    v_and_b32_e32 v241, 0xffff0000, v224
    v_mfma_f32_16x16x32_bf16 a[48:51], v[52:55], v[144:147], a[48:51]
    v_exp_f32_e64 v41, v41
    v_mfma_f32_16x16x32_bf16 a[52:55], v[52:55], v[148:151], a[52:55]
    ds_read2_b64 a[240:243], v14 offset0:128 offset1:132
    v_cvt_pk_bf16_f32 v60, v40, v41
    v_mfma_f32_16x16x32_bf16 a[56:59], v[52:55], v[152:155], a[56:59]
    v_exp_f32_e64 v42, v42
    v_mfma_f32_16x16x32_bf16 a[60:63], v[52:55], v[156:159], a[60:63]
    ds_read_b128 a[236:239], v3 offset:15360
    s_waitcnt lgkmcnt(5)
    v_mfma_f32_16x16x32_bf16 a[132:135], v[52:55], a[244:247], a[132:135]
    v_exp_f32_e32 v43, v43
    v_mfma_f32_16x16x32_bf16 v[16:19], v[64:67], a[144:147], v[120:123]
    v_cvt_pk_bf16_f32 v61, v42, v43
    v_mfma_f32_16x16x32_bf16 v[16:19], v[68:71], a[148:151], v[16:19]
    v_exp_f32_e64 v44, v44
    v_mfma_f32_16x16x32_bf16 v[16:19], v[72:75], a[152:155], v[16:19]
    ds_read_b128 v[96:99], v3 offset:16384
    s_waitcnt lgkmcnt(4)
    v_mfma_f32_16x16x32_bf16 v[16:19], v[76:79], a[156:159], v[16:19]
    v_exp_f32_e32 v45, v45
    v_mfma_f32_16x16x32_bf16 v[20:23], v[80:83], a[144:147], v[124:127]
    v_cvt_pk_bf16_f32 v62, v44, v45
    v_and_b32_e32 v249, 0xffff0000, v228
    v_mfma_f32_16x16x32_bf16 v[20:23], v[84:87], a[148:151], v[20:23]
    v_exp_f32_e64 v46, v46
    v_mfma_f32_16x16x32_bf16 v[20:23], v[88:91], a[152:155], v[20:23]
    ds_read_b128 v[100:103], v3 offset:17408
    v_lshlrev_b32_e64 v242, 16, v225
    v_mfma_f32_16x16x32_bf16 v[20:23], v[92:95], a[156:159], v[20:23]
    v_exp_f32_e64 v47, v47
    v_mfma_f32_16x16x32_bf16 a[64:67], v[56:59], v[128:131], a[64:67]
    v_cvt_pk_bf16_f32 v63, v46, v47
    v_lshlrev_b32_e64 v250, 16, v229
    v_mfma_f32_16x16x32_bf16 a[68:71], v[56:59], v[132:135], a[68:71]
    v_and_b32_e32 v243, 0xffff0000, v225
    v_and_b32_e32 v251, 0xffff0000, v229
    v_mfma_f32_16x16x32_bf16 a[72:75], v[56:59], v[136:139], a[72:75]
    v_exp_f32_e64 v16, v16
    v_mfma_f32_16x16x32_bf16 a[76:79], v[56:59], v[140:143], a[76:79]
    ds_read_b128 v[104:107], v3 offset:18432
    v_lshlrev_b32_e64 v244, 16, v226
    v_mfma_f32_16x16x32_bf16 a[80:83], v[56:59], v[144:147], a[80:83]
    v_exp_f32_e64 v17, v17
    v_mfma_f32_16x16x32_bf16 a[84:87], v[56:59], v[148:151], a[84:87]
    v_cvt_pk_bf16_f32 v48, v16, v17
    v_lshlrev_b32_e64 v252, 16, v230
    v_mfma_f32_16x16x32_bf16 a[88:91], v[56:59], v[152:155], a[88:91]
    v_exp_f32_e64 v18, v18
    v_mfma_f32_16x16x32_bf16 a[92:95], v[56:59], v[156:159], a[92:95]
    ds_read_b128 v[108:111], v3 offset:19456
    v_and_b32_e32 v245, 0xffff0000, v226
    v_mfma_f32_16x16x32_bf16 a[136:139], v[56:59], a[244:247], a[136:139]
    v_exp_f32_e64 v19, v19
    v_mfma_f32_16x16x32_bf16 v[24:27], v[64:67], a[160:163], v[120:123]
    v_cvt_pk_bf16_f32 v49, v18, v19
    v_and_b32_e32 v253, 0xffff0000, v230
    v_mfma_f32_16x16x32_bf16 v[24:27], v[68:71], a[164:167], v[24:27]
    v_exp_f32_e64 v20, v20
    v_mfma_f32_16x16x32_bf16 v[24:27], v[72:75], a[168:171], v[24:27]
    ds_read_b128 v[112:115], v3 offset:20480
    v_lshlrev_b32_e64 v246, 16, v227
    v_mfma_f32_16x16x32_bf16 v[24:27], v[76:79], a[172:175], v[24:27]
    v_exp_f32_e64 v21, v21
    v_mfma_f32_16x16x32_bf16 v[28:31], v[80:83], a[160:163], v[124:127]
    v_cvt_pk_bf16_f32 v50, v20, v21
    v_lshlrev_b32_e64 v254, 16, v231
    v_mfma_f32_16x16x32_bf16 v[28:31], v[84:87], a[164:167], v[28:31]
    v_exp_f32_e64 v22, v22
    v_mfma_f32_16x16x32_bf16 v[28:31], v[88:91], a[168:171], v[28:31]
    ds_read_b128 v[116:119], v3 offset:21504
    v_and_b32_e32 v247, 0xffff0000, v227
    v_mfma_f32_16x16x32_bf16 v[28:31], v[92:95], a[172:175], v[28:31]
    v_exp_f32_e64 v23, v23
    v_mfma_f32_16x16x32_bf16 a[96:99], v[60:63], v[128:131], a[96:99]
    v_cvt_pk_bf16_f32 v51, v22, v23
    v_and_b32_e32 v255, 0xffff0000, v231
    v_mfma_f32_16x16x32_bf16 a[100:103], v[60:63], v[132:135], a[100:103]
    v_mul_f32_e32 v240, s69, v240
    v_mul_f32_e32 v241, s69, v241
    v_mfma_f32_16x16x32_bf16 a[104:107], v[60:63], v[136:139], a[104:107]
    v_exp_f32_e64 v24, v24
    v_mfma_f32_16x16x32_bf16 a[108:111], v[60:63], v[140:143], a[108:111]
    ds_read_b128 a[248:251], v3 offset:22528
    v_mul_f32_e64 v242, s69, v242
    v_mfma_f32_16x16x32_bf16 a[112:115], v[60:63], v[144:147], a[112:115]
    v_exp_f32_e64 v25, v25
    v_mfma_f32_16x16x32_bf16 a[116:119], v[60:63], v[148:151], a[116:119]
    v_cvt_pk_bf16_f32 v52, v24, v25
    v_mul_f32_e64 v243, s69, v243
    v_mfma_f32_16x16x32_bf16 a[120:123], v[60:63], v[152:155], a[120:123]
    v_exp_f32_e64 v26, v26
    v_mfma_f32_16x16x32_bf16 a[124:127], v[60:63], v[156:159], a[124:127]
    ds_read_b128 a[252:255], v3 offset:23552
    s_waitcnt lgkmcnt(8)
    v_mfma_f32_16x16x32_bf16 a[140:143], v[60:63], a[244:247], a[140:143]
    v_exp_f32_e32 v27, v27
    v_mfma_f32_16x16x32_bf16 v[32:35], v[64:67], a[176:179], v[120:123]
    v_cvt_pk_bf16_f32 v53, v26, v27
    v_mul_f32_e64 v244, s69, v244
    v_mfma_f32_16x16x32_bf16 v[32:35], v[68:71], a[180:183], v[32:35]
    v_exp_f32_e64 v28, v28
    v_mfma_f32_16x16x32_bf16 v[32:35], v[72:75], a[184:187], v[32:35]
    ds_read_b128 v[128:131], v3 offset:24576
    v_mul_f32_e64 v245, s69, v245
    v_mfma_f32_16x16x32_bf16 v[32:35], v[76:79], a[188:191], v[32:35]
    v_exp_f32_e64 v29, v29
    v_mfma_f32_16x16x32_bf16 v[36:39], v[80:83], a[176:179], v[124:127]
    v_cvt_pk_bf16_f32 v54, v28, v29
    v_mul_f32_e64 v246, s69, v246
    v_mfma_f32_16x16x32_bf16 v[36:39], v[84:87], a[180:183], v[36:39]
    v_exp_f32_e64 v30, v30
    v_mfma_f32_16x16x32_bf16 v[36:39], v[88:91], a[184:187], v[36:39]
    ds_read_b128 v[132:135], v3 offset:25600
    v_mul_f32_e64 v247, s69, v247
    v_mfma_f32_16x16x32_bf16 v[36:39], v[92:95], a[188:191], v[36:39]
    v_exp_f32_e64 v31, v31
    v_mfma_f32_16x16x32_bf16 a[0:3], v[48:51], a[208:211], a[0:3]
    v_cvt_pk_bf16_f32 v55, v30, v31
    v_mul_f32_e64 v248, -v240, v248
    v_mfma_f32_16x16x32_bf16 a[4:7], v[48:51], a[212:215], a[4:7]
    s_add_u32 s56, s71, s59
    s_add_u32 s55, s56, 0x4000
    v_mfma_f32_16x16x32_bf16 a[8:11], v[48:51], a[216:219], a[8:11]
    v_exp_f32_e32 v32, v32
    v_mfma_f32_16x16x32_bf16 a[12:15], v[48:51], a[220:223], a[12:15]
    ds_read_b128 v[136:139], v3 offset:26624
    v_mul_f32_e64 v249, -v241, v249
    v_mfma_f32_16x16x32_bf16 a[16:19], v[48:51], a[224:227], a[16:19]
    v_exp_f32_e64 v33, v33
    v_mfma_f32_16x16x32_bf16 a[20:23], v[48:51], a[228:231], a[20:23]
    v_cvt_pk_bf16_f32 v56, v32, v33
    v_mul_f32_e64 v250, -v242, v250
    v_mfma_f32_16x16x32_bf16 a[24:27], v[48:51], a[232:235], a[24:27]
    v_exp_f32_e64 v34, v34
    v_mfma_f32_16x16x32_bf16 a[28:31], v[48:51], a[236:239], a[28:31]
    ds_read_b128 v[140:143], v3 offset:27648
    v_mul_f32_e64 v251, -v243, v251
    v_mfma_f32_16x16x32_bf16 a[128:131], v[48:51], a[240:243], a[128:131]
    v_exp_f32_e64 v35, v35
    v_mfma_f32_16x16x32_bf16 v[40:43], v[64:67], a[192:195], v[120:123]
    v_cvt_pk_bf16_f32 v57, v34, v35
    s_waitcnt vmcnt(4)
    v_mfma_f32_16x16x32_bf16 v[40:43], v[68:71], a[196:199], v[40:43]
    v_exp_f32_e32 v36, v36
    v_mfma_f32_16x16x32_bf16 v[40:43], v[72:75], a[200:203], v[40:43]
    ds_read_b128 v[144:147], v3 offset:28672
    v_cmp_eq_u64_e64 s[90:91], s[92:93], v[12:13]
    v_mfma_f32_16x16x32_bf16 v[40:43], v[76:79], a[204:207], v[40:43]
    v_exp_f32_e64 v37, v37
    v_mfma_f32_16x16x32_bf16 v[44:47], v[80:83], a[192:195], v[124:127]
    ds_read_b128 v[120:123], v1 offset:640
    v_cvt_pk_bf16_f32 v58, v36, v37
    v_mfma_f32_16x16x32_bf16 v[44:47], v[84:87], a[196:199], v[44:47]
    v_exp_f32_e64 v38, v38
    v_mfma_f32_16x16x32_bf16 v[44:47], v[88:91], a[200:203], v[44:47]
    ds_read_b128 v[148:151], v3 offset:29696
    s_lshr_b32 s64, s90, s66
    v_mfma_f32_16x16x32_bf16 v[44:47], v[92:95], a[204:207], v[44:47]
    v_exp_f32_e32 v39, v39
    v_mfma_f32_16x16x32_bf16 a[32:35], v[52:55], a[208:211], a[32:35]
    ds_read_b128 v[124:127], v1 offset:704
    v_cvt_pk_bf16_f32 v59, v38, v39
    s_and_b32 s64, s64, 0xff
    v_mfma_f32_16x16x32_bf16 a[36:39], v[52:55], a[212:215], a[36:39]
    s_add_u32 m0, s88, 0x8000
    s_lshr_b32 s3, s56, 5
    v_mfma_f32_16x16x32_bf16 a[40:43], v[52:55], a[216:219], a[40:43]
    v_exp_f32_e32 v40, v40
    v_mfma_f32_16x16x32_bf16 a[44:47], v[52:55], a[220:223], a[44:47]
    ds_read_b128 v[152:155], v3 offset:30720
    s_cmp_eq_u32 s64, 0xff
    s_cbranch_scc0 at_spin6_in
at_back6:
    v_mfma_f32_16x16x32_bf16 a[48:51], v[52:55], a[224:227], a[48:51]
    v_exp_f32_e32 v41, v41
    v_mfma_f32_16x16x32_bf16 a[52:55], v[52:55], a[228:231], a[52:55]
    ds_read2_b64 a[244:247], v14 offset0:160 offset1:164
    v_cvt_pk_bf16_f32 v60, v40, v41
    v_mfma_f32_16x16x32_bf16 a[56:59], v[52:55], a[232:235], a[56:59]
    v_exp_f32_e64 v42, v42
    v_mfma_f32_16x16x32_bf16 a[60:63], v[52:55], a[236:239], a[60:63]
    ds_read_b128 v[156:159], v3 offset:31744
    s_waitcnt vmcnt(20) lgkmcnt(5)
    v_mfma_f32_16x16x32_bf16 a[132:135], v[52:55], a[240:243], a[132:135]
    v_exp_f32_e32 v43, v43
    v_mfma_f32_16x16x32_bf16 v[16:19], v[96:99], a[144:147], v[120:123]
    s_barrier
    v_cvt_pk_bf16_f32 v61, v42, v43
    v_mfma_f32_16x16x32_bf16 v[16:19], v[100:103], a[148:151], v[16:19]
    v_exp_f32_e32 v44, v44
    v_mfma_f32_16x16x32_bf16 v[16:19], v[104:107], a[152:155], v[16:19]
    ds_read_b128 v[64:67], v3 offset:32768
    s_waitcnt lgkmcnt(4)
    v_mfma_f32_16x16x32_bf16 v[16:19], v[108:111], a[156:159], v[16:19]
    v_exp_f32_e32 v45, v45
    v_mfma_f32_16x16x32_bf16 v[20:23], v[112:115], a[144:147], v[124:127]
    buffer_load_dwordx4 v4, s[20:23], s56 offen sc1 lds
    v_cvt_pk_bf16_f32 v62, v44, v45
    v_mfma_f32_16x16x32_bf16 v[20:23], v[116:119], a[148:151], v[20:23]
    v_exp_f32_e64 v46, v46
    v_mfma_f32_16x16x32_bf16 v[20:23], a[248:251], a[152:155], v[20:23]
    ds_read_b128 v[68:71], v3 offset:33792
    v_mul_f32_e64 v252, -v244, v252
    v_mfma_f32_16x16x32_bf16 v[20:23], a[252:255], a[156:159], v[20:23]
    v_exp_f32_e64 v47, v47
    v_mfma_f32_16x16x32_bf16 a[64:67], v[56:59], a[208:211], a[64:67]
    buffer_load_dwordx4 v4, s[20:23], s56 offen offset:1024 sc1 lds
    v_cvt_pk_bf16_f32 v63, v46, v47
    v_mfma_f32_16x16x32_bf16 a[68:71], v[56:59], a[212:215], a[68:71]
    buffer_load_dwordx4 v4, s[20:23], s56 offen offset:2048 sc1 lds
    v_mul_f32_e64 v253, -v245, v253
    v_mfma_f32_16x16x32_bf16 a[72:75], v[56:59], a[216:219], a[72:75]
    v_exp_f32_e64 v16, v16
    v_mfma_f32_16x16x32_bf16 a[76:79], v[56:59], a[220:223], a[76:79]
    ds_read_b128 v[72:75], v3 offset:34816
    v_mul_f32_e64 v254, -v246, v254
    v_mfma_f32_16x16x32_bf16 a[80:83], v[56:59], a[224:227], a[80:83]
    v_exp_f32_e64 v17, v17
    v_mfma_f32_16x16x32_bf16 a[84:87], v[56:59], a[228:231], a[84:87]
    buffer_load_dwordx4 v4, s[20:23], s56 offen offset:3072 sc1 lds
    v_cvt_pk_bf16_f32 v48, v16, v17
    v_mfma_f32_16x16x32_bf16 a[88:91], v[56:59], a[232:235], a[88:91]
    v_exp_f32_e64 v18, v18
    v_mfma_f32_16x16x32_bf16 a[92:95], v[56:59], a[236:239], a[92:95]
    ds_read_b128 v[76:79], v3 offset:35840
    s_add_u32 m0, s88, 0xc000
    v_mfma_f32_16x16x32_bf16 a[136:139], v[56:59], a[240:243], a[136:139]
    v_exp_f32_e64 v19, v19
    v_mfma_f32_16x16x32_bf16 v[24:27], v[96:99], a[160:163], v[120:123]
    buffer_load_dwordx4 v4, s[20:23], s55 offen sc1 lds
    v_cvt_pk_bf16_f32 v49, v18, v19
    v_mfma_f32_16x16x32_bf16 v[24:27], v[100:103], a[164:167], v[24:27]
    v_exp_f32_e64 v20, v20
    v_mfma_f32_16x16x32_bf16 v[24:27], v[104:107], a[168:171], v[24:27]
    ds_read_b128 v[80:83], v3 offset:36864
    v_mul_f32_e64 v255, -v247, v255
    v_mfma_f32_16x16x32_bf16 v[24:27], v[108:111], a[172:175], v[24:27]
    v_exp_f32_e64 v21, v21
    v_mfma_f32_16x16x32_bf16 v[28:31], v[112:115], a[160:163], v[124:127]
    buffer_load_dwordx4 v4, s[20:23], s55 offen offset:1024 sc1 lds
    v_cvt_pk_bf16_f32 v50, v20, v21
    v_mfma_f32_16x16x32_bf16 v[28:31], v[116:119], a[164:167], v[28:31]
    v_exp_f32_e64 v22, v22
    v_mfma_f32_16x16x32_bf16 v[28:31], a[248:251], a[168:171], v[28:31]
    ds_read_b128 v[84:87], v3 offset:37888
    s_waitcnt vmcnt(20)
    v_mfma_f32_16x16x32_bf16 v[28:31], a[252:255], a[172:175], v[28:31]
    v_exp_f32_e32 v23, v23
    v_mfma_f32_16x16x32_bf16 a[96:99], v[60:63], a[208:211], a[96:99]
    buffer_load_dwordx4 v4, s[20:23], s55 offen offset:2048 sc1 lds
    v_cvt_pk_bf16_f32 v51, v22, v23
    v_mfma_f32_16x16x32_bf16 a[100:103], v[60:63], a[212:215], a[100:103]
    buffer_load_dwordx4 v4, s[20:23], s55 offen offset:3072 sc1 lds
    v_cvt_f32_i32_e64 v160, v160
    v_mfma_f32_16x16x32_bf16 a[104:107], v[60:63], a[216:219], a[104:107]
    v_exp_f32_e64 v24, v24
    v_mfma_f32_16x16x32_bf16 a[108:111], v[60:63], a[220:223], a[108:111]
    ds_read_b128 v[88:91], v3 offset:38912
    s_add_u32 m0, s10, s84
    v_mfma_f32_16x16x32_bf16 a[112:115], v[60:63], a[224:227], a[112:115]
    v_exp_f32_e32 v25, v25
    v_mfma_f32_16x16x32_bf16 a[116:119], v[60:63], a[228:231], a[116:119]
    buffer_load_dword v15, s[80:83], s3 offen sc1 lds
    v_cvt_pk_bf16_f32 v52, v24, v25
    v_mfma_f32_16x16x32_bf16 a[120:123], v[60:63], a[232:235], a[120:123]
    v_exp_f32_e64 v26, v26
    v_mfma_f32_16x16x32_bf16 a[124:127], v[60:63], a[236:239], a[124:127]
    ds_read_b128 v[92:95], v3 offset:39936
    s_waitcnt lgkmcnt(8)
    v_mfma_f32_16x16x32_bf16 a[140:143], v[60:63], a[240:243], a[140:143]
    v_exp_f32_e32 v27, v27
    v_mfma_f32_16x16x32_bf16 v[32:35], v[96:99], a[176:179], v[120:123]
    v_cvt_pk_bf16_f32 v53, v26, v27
    v_cvt_f32_i32_e64 v161, v161
    v_mfma_f32_16x16x32_bf16 v[32:35], v[100:103], a[180:183], v[32:35]
    v_exp_f32_e64 v28, v28
    v_mfma_f32_16x16x32_bf16 v[32:35], v[104:107], a[184:187], v[32:35]
    ds_read_b128 a[208:211], v3 offset:40960
    buffer_load_dwordx4 v[200:203], v8, s[28:31], s60 offen offset:1024 nt
    v_mfma_f32_16x16x32_bf16 v[32:35], v[108:111], a[188:191], v[32:35]
    v_exp_f32_e64 v29, v29
    v_mfma_f32_16x16x32_bf16 v[36:39], v[112:115], a[176:179], v[124:127]
    buffer_load_dwordx4 v[204:207], v8, s[28:31], s60 offen offset:1536 nt
    v_cvt_pk_bf16_f32 v54, v28, v29
    v_mfma_f32_16x16x32_bf16 v[36:39], v[116:119], a[180:183], v[36:39]
    v_exp_f32_e64 v30, v30
    v_mfma_f32_16x16x32_bf16 v[36:39], a[248:251], a[184:187], v[36:39]
    ds_read_b128 a[212:215], v3 offset:41984
    s_add_u32 s67, s60, 0x2000
    v_mfma_f32_16x16x32_bf16 v[36:39], a[252:255], a[188:191], v[36:39]
    v_exp_f32_e64 v31, v31
    v_mfma_f32_16x16x32_bf16 a[0:3], v[48:51], v[128:131], a[0:3]
    buffer_load_dwordx4 v[208:211], v8, s[28:31], s67 offen nt
    v_cvt_pk_bf16_f32 v55, v30, v31
    v_mfma_f32_16x16x32_bf16 a[4:7], v[48:51], v[132:135], a[4:7]
    v_cvt_f32_i32_e32 v162, v162
    v_cvt_f32_i32_e32 v163, v163
    v_mfma_f32_16x16x32_bf16 a[8:11], v[48:51], v[136:139], a[8:11]
    v_exp_f32_e64 v32, v32
    v_mfma_f32_16x16x32_bf16 a[12:15], v[48:51], v[140:143], a[12:15]
    ds_read_b128 a[216:219], v3 offset:43008
    v_cvt_f32_i32_e64 v164, v164
    v_mfma_f32_16x16x32_bf16 a[16:19], v[48:51], v[144:147], a[16:19]
    v_exp_f32_e64 v33, v33
    v_mfma_f32_16x16x32_bf16 a[20:23], v[48:51], v[148:151], a[20:23]
    v_cvt_pk_bf16_f32 v56, v32, v33
    v_cvt_f32_i32_e64 v165, v165
    v_mfma_f32_16x16x32_bf16 a[24:27], v[48:51], v[152:155], a[24:27]
    v_exp_f32_e64 v34, v34
    v_mfma_f32_16x16x32_bf16 a[28:31], v[48:51], v[156:159], a[28:31]
    ds_read_b128 a[220:223], v3 offset:44032
    v_cvt_f32_i32_e64 v166, v166
    v_mfma_f32_16x16x32_bf16 a[128:131], v[48:51], a[244:247], a[128:131]
    v_exp_f32_e64 v35, v35
    v_mfma_f32_16x16x32_bf16 v[40:43], v[96:99], a[192:195], v[120:123]
    v_cvt_pk_bf16_f32 v57, v34, v35
    v_cvt_f32_i32_e64 v167, v167
    v_mfma_f32_16x16x32_bf16 v[40:43], v[100:103], a[196:199], v[40:43]
    v_exp_f32_e64 v36, v36
    v_mfma_f32_16x16x32_bf16 v[40:43], v[104:107], a[200:203], v[40:43]
    ds_read_b128 a[224:227], v3 offset:45056
    v_fma_f32 v160, v160, v240, v248
    v_mfma_f32_16x16x32_bf16 v[40:43], v[108:111], a[204:207], v[40:43]
    v_exp_f32_e64 v37, v37
    v_mfma_f32_16x16x32_bf16 v[44:47], v[112:115], a[192:195], v[124:127]
    ds_read_b128 v[120:123], v1 offset:768
    v_cvt_pk_bf16_f32 v58, v36, v37
    v_mfma_f32_16x16x32_bf16 v[44:47], v[116:119], a[196:199], v[44:47]
    v_exp_f32_e64 v38, v38
    v_mfma_f32_16x16x32_bf16 v[44:47], a[248:251], a[200:203], v[44:47]
    ds_read_b128 a[228:231], v3 offset:46080
    v_fma_f32 v161, v161, v241, v249
    v_mfma_f32_16x16x32_bf16 v[44:47], a[252:255], a[204:207], v[44:47]
    v_exp_f32_e64 v39, v39
    v_mfma_f32_16x16x32_bf16 a[32:35], v[52:55], v[128:131], a[32:35]
    ds_read_b128 v[124:127], v1 offset:832
    v_cvt_pk_bf16_f32 v59, v38, v39
    v_mfma_f32_16x16x32_bf16 a[36:39], v[52:55], v[132:135], a[36:39]
    v_fma_f32 v162, v162, v242, v250
    v_fma_f32 v163, v163, v243, v251
    v_mfma_f32_16x16x32_bf16 a[40:43], v[52:55], v[136:139], a[40:43]
    v_exp_f32_e64 v40, v40
    v_mfma_f32_16x16x32_bf16 a[44:47], v[52:55], v[140:143], a[44:47]
    ds_read_b128 a[232:235], v3 offset:47104
    v_fma_f32 v164, v164, v244, v252
    v_mfma_f32_16x16x32_bf16 a[48:51], v[52:55], v[144:147], a[48:51]
    v_exp_f32_e64 v41, v41
    v_mfma_f32_16x16x32_bf16 a[52:55], v[52:55], v[148:151], a[52:55]
    ds_read2_b64 a[240:243], v14 offset0:192 offset1:196
    v_cvt_pk_bf16_f32 v60, v40, v41
    v_mfma_f32_16x16x32_bf16 a[56:59], v[52:55], v[152:155], a[56:59]
    v_exp_f32_e64 v42, v42
    v_mfma_f32_16x16x32_bf16 a[60:63], v[52:55], v[156:159], a[60:63]
    ds_read_b128 a[236:239], v3 offset:48128
    s_waitcnt lgkmcnt(5)
    v_mfma_f32_16x16x32_bf16 a[132:135], v[52:55], a[244:247], a[132:135]
    v_exp_f32_e32 v43, v43
    v_mfma_f32_16x16x32_bf16 v[16:19], v[64:67], a[144:147], v[120:123]
    v_cvt_pk_bf16_f32 v61, v42, v43
    v_mfma_f32_16x16x32_bf16 v[16:19], v[68:71], a[148:151], v[16:19]
    v_exp_f32_e64 v44, v44
    v_mfma_f32_16x16x32_bf16 v[16:19], v[72:75], a[152:155], v[16:19]
    ds_read_b128 v[96:99], v3 offset:49152
    s_waitcnt lgkmcnt(4)
    v_mfma_f32_16x16x32_bf16 v[16:19], v[76:79], a[156:159], v[16:19]
    v_exp_f32_e32 v45, v45
    v_mfma_f32_16x16x32_bf16 v[20:23], v[80:83], a[144:147], v[124:127]
    v_cvt_pk_bf16_f32 v62, v44, v45
    v_fma_f32 v165, v165, v245, v253
    v_mfma_f32_16x16x32_bf16 v[20:23], v[84:87], a[148:151], v[20:23]
    v_exp_f32_e64 v46, v46
    v_mfma_f32_16x16x32_bf16 v[20:23], v[88:91], a[152:155], v[20:23]
    ds_read_b128 v[100:103], v3 offset:50176
    v_fma_f32 v166, v166, v246, v254
    v_mfma_f32_16x16x32_bf16 v[20:23], v[92:95], a[156:159], v[20:23]
    v_exp_f32_e64 v47, v47
    v_mfma_f32_16x16x32_bf16 a[64:67], v[56:59], v[128:131], a[64:67]
    v_cvt_pk_bf16_f32 v63, v46, v47
    v_fma_f32 v167, v167, v247, v255
    v_mfma_f32_16x16x32_bf16 a[68:71], v[56:59], v[132:135], a[68:71]
    v_cvt_pk_bf16_f32 v160, v160, v161
    v_cvt_pk_bf16_f32 v161, v162, v163
    v_mfma_f32_16x16x32_bf16 a[72:75], v[56:59], v[136:139], a[72:75]
    v_exp_f32_e64 v16, v16
    v_mfma_f32_16x16x32_bf16 a[76:79], v[56:59], v[140:143], a[76:79]
    ds_read_b128 v[104:107], v3 offset:51200
    v_cvt_pk_bf16_f32 v162, v164, v165
    v_mfma_f32_16x16x32_bf16 a[80:83], v[56:59], v[144:147], a[80:83]
    v_exp_f32_e64 v17, v17
    v_mfma_f32_16x16x32_bf16 a[84:87], v[56:59], v[148:151], a[84:87]
    v_cvt_pk_bf16_f32 v48, v16, v17
    v_cvt_pk_bf16_f32 v163, v166, v167
    v_mfma_f32_16x16x32_bf16 a[88:91], v[56:59], v[152:155], a[88:91]
    v_exp_f32_e64 v18, v18
    v_mfma_f32_16x16x32_bf16 a[92:95], v[56:59], v[156:159], a[92:95]
    ds_read_b128 v[108:111], v3 offset:52224
    buffer_store_dwordx4 v[160:163], v6, s[20:23], s60 offen sc1
    v_mfma_f32_16x16x32_bf16 a[136:139], v[56:59], a[244:247], a[136:139]
    v_exp_f32_e64 v19, v19
    v_mfma_f32_16x16x32_bf16 v[24:27], v[64:67], a[160:163], v[120:123]
    v_cvt_pk_bf16_f32 v49, v18, v19
    v_cvt_f32_i32_e64 v168, v168
    v_mfma_f32_16x16x32_bf16 v[24:27], v[68:71], a[164:167], v[24:27]
    v_exp_f32_e64 v20, v20
    v_mfma_f32_16x16x32_bf16 v[24:27], v[72:75], a[168:171], v[24:27]
    ds_read_b128 v[112:115], v3 offset:53248
    v_cvt_f32_i32_e64 v169, v169
    v_mfma_f32_16x16x32_bf16 v[24:27], v[76:79], a[172:175], v[24:27]
    v_exp_f32_e64 v21, v21
    v_mfma_f32_16x16x32_bf16 v[28:31], v[80:83], a[160:163], v[124:127]
    v_cvt_pk_bf16_f32 v50, v20, v21
    v_cvt_f32_i32_e64 v170, v170
    v_mfma_f32_16x16x32_bf16 v[28:31], v[84:87], a[164:167], v[28:31]
    v_exp_f32_e64 v22, v22
    v_mfma_f32_16x16x32_bf16 v[28:31], v[88:91], a[168:171], v[28:31]
    ds_read_b128 v[116:119], v3 offset:54272
    v_cvt_f32_i32_e64 v171, v171
    v_mfma_f32_16x16x32_bf16 v[28:31], v[92:95], a[172:175], v[28:31]
    v_exp_f32_e64 v23, v23
    v_mfma_f32_16x16x32_bf16 a[96:99], v[60:63], v[128:131], a[96:99]
    v_cvt_pk_bf16_f32 v51, v22, v23
    v_cvt_f32_i32_e64 v172, v172
    v_mfma_f32_16x16x32_bf16 a[100:103], v[60:63], v[132:135], a[100:103]
    v_cvt_f32_i32_e32 v173, v173
    v_cvt_f32_i32_e32 v174, v174
    v_mfma_f32_16x16x32_bf16 a[104:107], v[60:63], v[136:139], a[104:107]
    v_exp_f32_e64 v24, v24
    v_mfma_f32_16x16x32_bf16 a[108:111], v[60:63], v[140:143], a[108:111]
    ds_read_b128 a[248:251], v3 offset:55296
    v_cvt_f32_i32_e64 v175, v175
    v_mfma_f32_16x16x32_bf16 a[112:115], v[60:63], v[144:147], a[112:115]
    v_exp_f32_e64 v25, v25
    v_mfma_f32_16x16x32_bf16 a[116:119], v[60:63], v[148:151], a[116:119]
    v_cvt_pk_bf16_f32 v52, v24, v25
    v_fma_f32 v168, v168, v240, v248
    v_mfma_f32_16x16x32_bf16 a[120:123], v[60:63], v[152:155], a[120:123]
    v_exp_f32_e64 v26, v26
    v_mfma_f32_16x16x32_bf16 a[124:127], v[60:63], v[156:159], a[124:127]
    ds_read_b128 a[252:255], v3 offset:56320
    s_waitcnt lgkmcnt(8)
    v_mfma_f32_16x16x32_bf16 a[140:143], v[60:63], a[244:247], a[140:143]
    v_exp_f32_e32 v27, v27
    v_mfma_f32_16x16x32_bf16 v[32:35], v[64:67], a[176:179], v[120:123]
    v_cvt_pk_bf16_f32 v53, v26, v27
    v_fma_f32 v169, v169, v241, v249
    v_mfma_f32_16x16x32_bf16 v[32:35], v[68:71], a[180:183], v[32:35]
    v_exp_f32_e64 v28, v28
    v_mfma_f32_16x16x32_bf16 v[32:35], v[72:75], a[184:187], v[32:35]
    ds_read_b128 v[128:131], v3 offset:57344
    v_fma_f32 v170, v170, v242, v250
    v_mfma_f32_16x16x32_bf16 v[32:35], v[76:79], a[188:191], v[32:35]
    v_exp_f32_e64 v29, v29
    v_mfma_f32_16x16x32_bf16 v[36:39], v[80:83], a[176:179], v[124:127]
    v_cvt_pk_bf16_f32 v54, v28, v29
    v_fma_f32 v171, v171, v243, v251
    v_mfma_f32_16x16x32_bf16 v[36:39], v[84:87], a[180:183], v[36:39]
    v_exp_f32_e64 v30, v30
    v_mfma_f32_16x16x32_bf16 v[36:39], v[88:91], a[184:187], v[36:39]
    ds_read_b128 v[132:135], v3 offset:58368
    v_fma_f32 v172, v172, v244, v252
    v_mfma_f32_16x16x32_bf16 v[36:39], v[92:95], a[188:191], v[36:39]
    v_exp_f32_e64 v31, v31
    v_mfma_f32_16x16x32_bf16 a[0:3], v[48:51], a[208:211], a[0:3]
    v_cvt_pk_bf16_f32 v55, v30, v31
    v_fma_f32 v173, v173, v245, v253
    v_mfma_f32_16x16x32_bf16 a[4:7], v[48:51], a[212:215], a[4:7]
    s_add_u32 s56, s72, s59
    s_add_u32 s55, s56, 0x4000
    v_mfma_f32_16x16x32_bf16 a[8:11], v[48:51], a[216:219], a[8:11]
    v_exp_f32_e32 v32, v32
    v_mfma_f32_16x16x32_bf16 a[12:15], v[48:51], a[220:223], a[12:15]
    ds_read_b128 v[136:139], v3 offset:59392
    v_fma_f32 v174, v174, v246, v254
    v_mfma_f32_16x16x32_bf16 a[16:19], v[48:51], a[224:227], a[16:19]
    v_exp_f32_e64 v33, v33
    v_mfma_f32_16x16x32_bf16 a[20:23], v[48:51], a[228:231], a[20:23]
    v_cvt_pk_bf16_f32 v56, v32, v33
    v_fma_f32 v175, v175, v247, v255
    v_mfma_f32_16x16x32_bf16 a[24:27], v[48:51], a[232:235], a[24:27]
    v_exp_f32_e64 v34, v34
    v_mfma_f32_16x16x32_bf16 a[28:31], v[48:51], a[236:239], a[28:31]
    ds_read_b128 v[140:143], v3 offset:60416
    v_cvt_pk_bf16_f32 v168, v168, v169
    v_mfma_f32_16x16x32_bf16 a[128:131], v[48:51], a[240:243], a[128:131]
    v_exp_f32_e64 v35, v35
    v_mfma_f32_16x16x32_bf16 v[40:43], v[64:67], a[192:195], v[120:123]
    v_cvt_pk_bf16_f32 v57, v34, v35
    v_cvt_pk_bf16_f32 v169, v170, v171
    v_mfma_f32_16x16x32_bf16 v[40:43], v[68:71], a[196:199], v[40:43]
    v_exp_f32_e64 v36, v36
    v_mfma_f32_16x16x32_bf16 v[40:43], v[72:75], a[200:203], v[40:43]
    ds_read_b128 v[144:147], v3 offset:61440
    v_cvt_pk_bf16_f32 v170, v172, v173
    v_mfma_f32_16x16x32_bf16 v[40:43], v[76:79], a[204:207], v[40:43]
    v_exp_f32_e64 v37, v37
    v_mfma_f32_16x16x32_bf16 v[44:47], v[80:83], a[192:195], v[124:127]
    ds_read_b128 v[120:123], v1 offset:896
    v_cvt_pk_bf16_f32 v58, v36, v37
    v_mfma_f32_16x16x32_bf16 v[44:47], v[84:87], a[196:199], v[44:47]
    v_exp_f32_e64 v38, v38
    v_mfma_f32_16x16x32_bf16 v[44:47], v[88:91], a[200:203], v[44:47]
    ds_read_b128 v[148:151], v3 offset:62464
    v_cvt_pk_bf16_f32 v171, v174, v175
    v_mfma_f32_16x16x32_bf16 v[44:47], v[92:95], a[204:207], v[44:47]
    v_exp_f32_e64 v39, v39
    v_mfma_f32_16x16x32_bf16 a[32:35], v[52:55], a[208:211], a[32:35]
    ds_read_b128 v[124:127], v1 offset:960
    v_cvt_pk_bf16_f32 v59, v38, v39
    v_mfma_f32_16x16x32_bf16 a[36:39], v[52:55], a[212:215], a[36:39]
    s_add_u32 m0, s88, 0x10000
    s_lshr_b32 s3, s56, 5
    v_mfma_f32_16x16x32_bf16 a[40:43], v[52:55], a[216:219], a[40:43]
    v_exp_f32_e32 v40, v40
    v_mfma_f32_16x16x32_bf16 a[44:47], v[52:55], a[220:223], a[44:47]
    ds_read_b128 v[152:155], v3 offset:63488
    buffer_store_dwordx4 v[168:171], v6, s[20:23], s60 offen offset:128 sc1
    v_mfma_f32_16x16x32_bf16 a[48:51], v[52:55], a[224:227], a[48:51]
    v_exp_f32_e64 v41, v41
    v_mfma_f32_16x16x32_bf16 a[52:55], v[52:55], a[228:231], a[52:55]
    ds_read2_b64 a[244:247], v14 offset0:224 offset1:228
    v_cvt_pk_bf16_f32 v60, v40, v41
    v_mfma_f32_16x16x32_bf16 a[56:59], v[52:55], a[232:235], a[56:59]
    v_exp_f32_e64 v42, v42
    v_mfma_f32_16x16x32_bf16 a[60:63], v[52:55], a[236:239], a[60:63]
    ds_read_b128 v[156:159], v3 offset:64512
    s_waitcnt vmcnt(19) lgkmcnt(5)
    v_mfma_f32_16x16x32_bf16 a[132:135], v[52:55], a[240:243], a[132:135]
    v_exp_f32_e32 v43, v43
    v_mfma_f32_16x16x32_bf16 v[16:19], v[96:99], a[144:147], v[120:123]
    s_barrier
    v_cvt_pk_bf16_f32 v61, v42, v43
    v_mfma_f32_16x16x32_bf16 v[16:19], v[100:103], a[148:151], v[16:19]
    v_exp_f32_e32 v44, v44
    v_mfma_f32_16x16x32_bf16 v[16:19], v[104:107], a[152:155], v[16:19]
    ds_read_b128 v[64:67], v2
    s_waitcnt lgkmcnt(4)
    v_mfma_f32_16x16x32_bf16 v[16:19], v[108:111], a[156:159], v[16:19]
    v_exp_f32_e32 v45, v45
    v_mfma_f32_16x16x32_bf16 v[20:23], v[112:115], a[144:147], v[124:127]
    buffer_load_dwordx4 v4, s[20:23], s56 offen sc1 lds
    v_cvt_pk_bf16_f32 v62, v44, v45
    v_mfma_f32_16x16x32_bf16 v[20:23], v[116:119], a[148:151], v[20:23]
    v_exp_f32_e64 v46, v46
    v_mfma_f32_16x16x32_bf16 v[20:23], a[248:251], a[152:155], v[20:23]
    ds_read_b128 v[68:71], v2 offset:1024
    v_cvt_f32_i32_e64 v176, v176
    v_mfma_f32_16x16x32_bf16 v[20:23], a[252:255], a[156:159], v[20:23]
    v_exp_f32_e64 v47, v47
    v_mfma_f32_16x16x32_bf16 a[64:67], v[56:59], a[208:211], a[64:67]
    buffer_load_dwordx4 v4, s[20:23], s56 offen offset:1024 sc1 lds
    v_cvt_pk_bf16_f32 v63, v46, v47
    v_mfma_f32_16x16x32_bf16 a[68:71], v[56:59], a[212:215], a[68:71]
    buffer_load_dwordx4 v4, s[20:23], s56 offen offset:2048 sc1 lds
    v_cvt_f32_i32_e64 v177, v177
    v_mfma_f32_16x16x32_bf16 a[72:75], v[56:59], a[216:219], a[72:75]
    v_exp_f32_e64 v16, v16
    v_mfma_f32_16x16x32_bf16 a[76:79], v[56:59], a[220:223], a[76:79]
    ds_read_b128 v[72:75], v2 offset:2048
    v_cvt_f32_i32_e64 v178, v178
    v_mfma_f32_16x16x32_bf16 a[80:83], v[56:59], a[224:227], a[80:83]
    v_exp_f32_e64 v17, v17
    v_mfma_f32_16x16x32_bf16 a[84:87], v[56:59], a[228:231], a[84:87]
    buffer_load_dwordx4 v4, s[20:23], s56 offen offset:3072 sc1 lds
    v_cvt_pk_bf16_f32 v48, v16, v17
    v_mfma_f32_16x16x32_bf16 a[88:91], v[56:59], a[232:235], a[88:91]
    v_exp_f32_e64 v18, v18
    v_mfma_f32_16x16x32_bf16 a[92:95], v[56:59], a[236:239], a[92:95]
    ds_read_b128 v[76:79], v2 offset:3072
    s_add_u32 m0, s88, 0x14000
    v_mfma_f32_16x16x32_bf16 a[136:139], v[56:59], a[240:243], a[136:139]
    v_exp_f32_e64 v19, v19
    v_mfma_f32_16x16x32_bf16 v[24:27], v[96:99], a[160:163], v[120:123]
    buffer_load_dwordx4 v4, s[20:23], s55 offen sc1 lds
    v_cvt_pk_bf16_f32 v49, v18, v19
    v_mfma_f32_16x16x32_bf16 v[24:27], v[100:103], a[164:167], v[24:27]
    v_exp_f32_e64 v20, v20
    v_mfma_f32_16x16x32_bf16 v[24:27], v[104:107], a[168:171], v[24:27]
    ds_read_b128 v[80:83], v2 offset:4096
    v_cvt_f32_i32_e64 v179, v179
    v_mfma_f32_16x16x32_bf16 v[24:27], v[108:111], a[172:175], v[24:27]
    v_exp_f32_e64 v21, v21
    v_mfma_f32_16x16x32_bf16 v[28:31], v[112:115], a[160:163], v[124:127]
    buffer_load_dwordx4 v4, s[20:23], s55 offen offset:1024 sc1 lds
    v_cvt_pk_bf16_f32 v50, v20, v21
    v_mfma_f32_16x16x32_bf16 v[28:31], v[116:119], a[164:167], v[28:31]
    v_exp_f32_e64 v22, v22
    v_mfma_f32_16x16x32_bf16 v[28:31], a[248:251], a[168:171], v[28:31]
    ds_read_b128 v[84:87], v2 offset:5120
    v_cvt_f32_i32_e64 v180, v180
    v_mfma_f32_16x16x32_bf16 v[28:31], a[252:255], a[172:175], v[28:31]
    v_exp_f32_e64 v23, v23
    v_mfma_f32_16x16x32_bf16 a[96:99], v[60:63], a[208:211], a[96:99]
    buffer_load_dwordx4 v4, s[20:23], s55 offen offset:2048 sc1 lds
    v_cvt_pk_bf16_f32 v51, v22, v23
    v_mfma_f32_16x16x32_bf16 a[100:103], v[60:63], a[212:215], a[100:103]
    buffer_load_dwordx4 v4, s[20:23], s55 offen offset:3072 sc1 lds
    v_cvt_f32_i32_e64 v181, v181
    v_mfma_f32_16x16x32_bf16 a[104:107], v[60:63], a[216:219], a[104:107]
    v_exp_f32_e64 v24, v24
    v_mfma_f32_16x16x32_bf16 a[108:111], v[60:63], a[220:223], a[108:111]
    ds_read_b128 v[88:91], v2 offset:6144
    s_lshl1_add_u32 m0, s84, s10
    v_mfma_f32_16x16x32_bf16 a[112:115], v[60:63], a[224:227], a[112:115]
    v_exp_f32_e32 v25, v25
    v_mfma_f32_16x16x32_bf16 a[116:119], v[60:63], a[228:231], a[116:119]
    buffer_load_dword v15, s[80:83], s3 offen sc1 lds
    v_cvt_pk_bf16_f32 v52, v24, v25
    v_mfma_f32_16x16x32_bf16 a[120:123], v[60:63], a[232:235], a[120:123]
    v_exp_f32_e64 v26, v26
    v_mfma_f32_16x16x32_bf16 a[124:127], v[60:63], a[236:239], a[124:127]
    ds_read_b128 v[92:95], v2 offset:7168
    s_waitcnt lgkmcnt(8)
    v_mfma_f32_16x16x32_bf16 a[140:143], v[60:63], a[240:243], a[140:143]
    v_exp_f32_e32 v27, v27
    v_mfma_f32_16x16x32_bf16 v[32:35], v[96:99], a[176:179], v[120:123]
    v_cvt_pk_bf16_f32 v53, v26, v27
    v_cvt_f32_i32_e64 v182, v182
    v_mfma_f32_16x16x32_bf16 v[32:35], v[100:103], a[180:183], v[32:35]
    v_exp_f32_e64 v28, v28
    v_mfma_f32_16x16x32_bf16 v[32:35], v[104:107], a[184:187], v[32:35]
    ds_read_b128 a[208:211], v2 offset:8192
    s_mov_b32 s58, s59
    v_mfma_f32_16x16x32_bf16 v[32:35], v[108:111], a[188:191], v[32:35]
    v_exp_f32_e32 v29, v29
    v_mfma_f32_16x16x32_bf16 v[36:39], v[112:115], a[176:179], v[124:127]
    buffer_load_dwordx4 v[212:215], v8, s[28:31], s67 offen offset:512 nt
    v_cvt_pk_bf16_f32 v54, v28, v29
    v_mfma_f32_16x16x32_bf16 v[36:39], v[116:119], a[180:183], v[36:39]
    v_exp_f32_e64 v30, v30
    v_mfma_f32_16x16x32_bf16 v[36:39], a[248:251], a[184:187], v[36:39]
    ds_read_b128 a[212:215], v2 offset:9216
    s_add_u32 s59, s59, 0x40000
    v_mfma_f32_16x16x32_bf16 v[36:39], a[252:255], a[188:191], v[36:39]
    v_exp_f32_e64 v31, v31
    v_mfma_f32_16x16x32_bf16 a[0:3], v[48:51], v[128:131], a[0:3]
    buffer_load_dwordx4 v[216:219], v8, s[28:31], s67 offen offset:1024 nt
    v_cvt_pk_bf16_f32 v55, v30, v31
    v_mfma_f32_16x16x32_bf16 a[4:7], v[48:51], v[132:135], a[4:7]
    buffer_load_dwordx4 v[220:223], v8, s[28:31], s67 offen offset:1536 nt
    v_cvt_f32_i32_e64 v183, v183
    v_mfma_f32_16x16x32_bf16 a[8:11], v[48:51], v[136:139], a[8:11]
    v_exp_f32_e64 v32, v32
    v_mfma_f32_16x16x32_bf16 a[12:15], v[48:51], v[140:143], a[12:15]
    ds_read_b128 a[216:219], v2 offset:10240
    s_mov_b32 s65, s66
    v_mfma_f32_16x16x32_bf16 a[16:19], v[48:51], v[144:147], a[16:19]
    v_exp_f32_e32 v33, v33
    v_mfma_f32_16x16x32_bf16 a[20:23], v[48:51], v[148:151], a[20:23]
    v_cvt_pk_bf16_f32 v56, v32, v33
    v_fma_f32 v176, v176, v240, v248
    v_mfma_f32_16x16x32_bf16 a[24:27], v[48:51], v[152:155], a[24:27]
    v_exp_f32_e64 v34, v34
    v_mfma_f32_16x16x32_bf16 a[28:31], v[48:51], v[156:159], a[28:31]
    ds_read_b128 a[220:223], v2 offset:11264
    s_add_u32 s66, s66, 8
    v_mfma_f32_16x16x32_bf16 a[128:131], v[48:51], a[244:247], a[128:131]
    v_exp_f32_e32 v35, v35
    v_mfma_f32_16x16x32_bf16 v[40:43], v[96:99], a[192:195], v[120:123]
    v_cvt_pk_bf16_f32 v57, v34, v35
    v_fma_f32 v177, v177, v241, v249
    v_mfma_f32_16x16x32_bf16 v[40:43], v[100:103], a[196:199], v[40:43]
    v_exp_f32_e64 v36, v36
    v_mfma_f32_16x16x32_bf16 v[40:43], v[104:107], a[200:203], v[40:43]
    ds_read_b128 a[224:227], v2 offset:12288
    v_fma_f32 v178, v178, v242, v250
    v_mfma_f32_16x16x32_bf16 v[40:43], v[108:111], a[204:207], v[40:43]
    v_exp_f32_e64 v37, v37
    v_mfma_f32_16x16x32_bf16 v[44:47], v[112:115], a[192:195], v[124:127]
    ds_read_b128 v[120:123], v1
    v_cvt_pk_bf16_f32 v58, v36, v37
    v_mfma_f32_16x16x32_bf16 v[44:47], v[116:119], a[196:199], v[44:47]
    v_exp_f32_e64 v38, v38
    v_mfma_f32_16x16x32_bf16 v[44:47], a[248:251], a[200:203], v[44:47]
    ds_read_b128 a[228:231], v2 offset:13312
    s_sub_u32 s57, s57, 1
    v_mfma_f32_16x16x32_bf16 v[44:47], a[252:255], a[204:207], v[44:47]
    v_exp_f32_e32 v39, v39
    v_mfma_f32_16x16x32_bf16 a[32:35], v[52:55], v[128:131], a[32:35]
    ds_read_b128 v[124:127], v1 offset:64
    v_cvt_pk_bf16_f32 v59, v38, v39
    v_mfma_f32_16x16x32_bf16 a[36:39], v[52:55], v[132:135], a[36:39]
    v_mfma_f32_16x16x32_bf16 a[40:43], v[52:55], v[136:139], a[40:43]
    v_exp_f32_e64 v40, v40
    v_mfma_f32_16x16x32_bf16 a[44:47], v[52:55], v[140:143], a[44:47]
    ds_read_b128 a[232:235], v2 offset:14336
    s_cmp_lg_u32 s57, 0
    v_mfma_f32_16x16x32_bf16 a[48:51], v[52:55], v[144:147], a[48:51]
    v_exp_f32_e32 v41, v41
    v_mfma_f32_16x16x32_bf16 a[52:55], v[52:55], v[148:151], a[52:55]
    ds_read2_b64 a[240:243], v14 offset0:0 offset1:4
    v_cvt_pk_bf16_f32 v60, v40, v41
    v_mfma_f32_16x16x32_bf16 a[56:59], v[52:55], v[152:155], a[56:59]
    v_exp_f32_e64 v42, v42
    v_mfma_f32_16x16x32_bf16 a[60:63], v[52:55], v[156:159], a[60:63]
    ds_read_b128 a[236:239], v2 offset:15360
    s_waitcnt lgkmcnt(5)
    v_mfma_f32_16x16x32_bf16 a[132:135], v[52:55], a[244:247], a[132:135]
    v_exp_f32_e32 v43, v43
    s_cbranch_scc1 at_loop
    v_mfma_f32_16x16x32_bf16 a[64:67], v[56:59], v[128:131], a[64:67]
    v_cvt_pk_bf16_f32 v61, v42, v43
    v_exp_f32_e32 v44, v44
    v_mfma_f32_16x16x32_bf16 a[68:71], v[56:59], v[132:135], a[68:71]
    v_exp_f32_e32 v45, v45
    v_bfe_u32 v8, v2, 4, 4
    v_mfma_f32_16x16x32_bf16 a[72:75], v[56:59], v[136:139], a[72:75]
    v_cvt_pk_bf16_f32 v62, v44, v45
    v_exp_f32_e32 v46, v46
    v_mfma_f32_16x16x32_bf16 a[76:79], v[56:59], v[140:143], a[76:79]
    v_exp_f32_e32 v47, v47
    v_lshrrev_b32_e32 v9, 8, v2
    v_mfma_f32_16x16x32_bf16 a[80:83], v[56:59], v[144:147], a[80:83]
    v_cvt_pk_bf16_f32 v63, v46, v47
    v_mfma_f32_16x16x32_bf16 a[84:87], v[56:59], v[148:151], a[84:87]
    v_lshlrev_b32_e32 v5, 10, v9
    v_mfma_f32_16x16x32_bf16 a[88:91], v[56:59], v[152:155], a[88:91]
    v_lshl_add_u32 v5, v8, 4, v5
    v_mfma_f32_16x16x32_bf16 a[92:95], v[56:59], v[156:159], a[92:95]
    s_mov_b32 s67, 0x26800000
    v_mfma_f32_16x16x32_bf16 a[136:139], v[56:59], a[244:247], a[136:139]
    s_mov_b32 s68, 0x5d800000
    s_nop 1
    v_mfma_f32_16x16x32_bf16 a[96:99], v[60:63], v[128:131], a[96:99]
    v_accvgpr_read_b32 v160, a128
    v_accvgpr_read_b32 v161, a129
    v_accvgpr_read_b32 v162, a130
    v_accvgpr_read_b32 v163, a131
    s_nop 1
    v_mov_b32_dpp v64, v160 row_newbcast:0 row_mask:0xf bank_mask:0xf
    v_mfma_f32_16x16x32_bf16 a[100:103], v[60:63], v[132:135], a[100:103]
    v_mov_b32_dpp v65, v161 row_newbcast:0 row_mask:0xf bank_mask:0xf
    v_mov_b32_dpp v66, v162 row_newbcast:0 row_mask:0xf bank_mask:0xf
    v_mov_b32_dpp v67, v163 row_newbcast:0 row_mask:0xf bank_mask:0xf
    v_mov_b32_dpp v80, v160 row_newbcast:2 row_mask:0xf bank_mask:0xf
    v_mov_b32_dpp v81, v161 row_newbcast:2 row_mask:0xf bank_mask:0xf
    v_mov_b32_dpp v82, v162 row_newbcast:2 row_mask:0xf bank_mask:0xf
    v_mfma_f32_16x16x32_bf16 a[104:107], v[60:63], v[136:139], a[104:107]
    v_mov_b32_dpp v83, v163 row_newbcast:2 row_mask:0xf bank_mask:0xf
    v_add_f32_dpp v64, v160, v64 row_newbcast:1 row_mask:0xf bank_mask:0xf
    v_add_f32_dpp v65, v161, v65 row_newbcast:1 row_mask:0xf bank_mask:0xf
    v_add_f32_dpp v66, v162, v66 row_newbcast:1 row_mask:0xf bank_mask:0xf
    v_add_f32_dpp v67, v163, v67 row_newbcast:1 row_mask:0xf bank_mask:0xf
    v_accvgpr_read_b32 v160, a132
    v_mfma_f32_16x16x32_bf16 a[108:111], v[60:63], v[140:143], a[108:111]
    v_accvgpr_read_b32 v161, a133
    v_accvgpr_read_b32 v162, a134
    v_accvgpr_read_b32 v163, a135
    s_nop 1
    v_mov_b32_dpp v68, v160 row_newbcast:0 row_mask:0xf bank_mask:0xf
    v_mov_b32_dpp v69, v161 row_newbcast:0 row_mask:0xf bank_mask:0xf
    v_mfma_f32_16x16x32_bf16 a[112:115], v[60:63], v[144:147], a[112:115]
    v_mov_b32_dpp v70, v162 row_newbcast:0 row_mask:0xf bank_mask:0xf
    v_mov_b32_dpp v71, v163 row_newbcast:0 row_mask:0xf bank_mask:0xf
    v_mov_b32_dpp v84, v160 row_newbcast:2 row_mask:0xf bank_mask:0xf
    v_mov_b32_dpp v85, v161 row_newbcast:2 row_mask:0xf bank_mask:0xf
    v_mov_b32_dpp v86, v162 row_newbcast:2 row_mask:0xf bank_mask:0xf
    v_mfma_f32_16x16x32_bf16 a[116:119], v[60:63], v[148:151], a[116:119]
    v_mov_b32_dpp v87, v163 row_newbcast:2 row_mask:0xf bank_mask:0xf
    v_add_f32_dpp v68, v160, v68 row_newbcast:1 row_mask:0xf bank_mask:0xf
    v_add_f32_dpp v69, v161, v69 row_newbcast:1 row_mask:0xf bank_mask:0xf
    v_add_f32_dpp v70, v162, v70 row_newbcast:1 row_mask:0xf bank_mask:0xf
    v_add_f32_dpp v71, v163, v71 row_newbcast:1 row_mask:0xf bank_mask:0xf
    v_mfma_f32_16x16x32_bf16 a[120:123], v[60:63], v[152:155], a[120:123]
    v_min3_f32 v10, v64, v65, v66
    v_max3_f32 v11, v64, v65, v66
    v_add_f32_e32 v12, v64, v65
    v_min3_f32 v10, v10, v67, v68
    v_max3_f32 v11, v11, v67, v68
    v_mfma_f32_16x16x32_bf16 a[124:127], v[60:63], v[156:159], a[124:127]
    v_min3_f32 v10, v10, v69, v70
    v_max3_f32 v11, v11, v69, v70
    v_min_f32_e32 v10, v10, v71
    v_max_f32_e32 v11, v11, v71
    v_add_f32_e32 v12, v12, v66
    v_mfma_f32_16x16x32_bf16 a[140:143], v[60:63], a[244:247], a[140:143]
    v_add_f32_e32 v12, v12, v67
    v_add_f32_e32 v12, v12, v68
    v_add_f32_e32 v12, v12, v69
    v_add_f32_e32 v12, v12, v70
    v_add_f32_e32 v12, v12, v71
    v_cmp_lt_f32_e64 s[90:91], s67, v10
    v_cmp_gt_f32_e64 s[92:93], s68, v11
    v_cmp_o_f32_e64 s[96:97], v12, v12
    s_nop 4
    s_and_b64 s[90:91], s[90:91], s[92:93]
    s_and_b64 s[90:91], s[90:91], s[96:97]
    s_cmp_eq_u64 s[90:91], exec
    s_cbranch_scc0 at_slow
    s_add_u32 s63, s86, 0
    v_rcp_f32_e32 v64, v64
    v_rcp_f32_e32 v65, v65
    v_rcp_f32_e32 v66, v66
    v_rcp_f32_e32 v67, v67
    s_nop 0
    v_mul_f32_e64 v80, -v80, v64
    v_mul_f32_e64 v81, -v81, v65
    v_mul_f32_e64 v82, -v82, v66
    v_mul_f32_e64 v83, -v83, v67
    v_accvgpr_read_b32 v96, a0
    v_accvgpr_read_b32 v97, a4
    v_accvgpr_read_b32 v98, a8
    v_accvgpr_read_b32 v99, a12
    v_accvgpr_read_b32 v100, a16
    v_accvgpr_read_b32 v101, a20
    v_accvgpr_read_b32 v102, a24
    v_accvgpr_read_b32 v103, a28
    v_pk_fma_f32 v[96:97], v[96:97], v[64:65], v[80:81] op_sel:[0,0,0] op_sel_hi:[1,0,0]
    v_pk_fma_f32 v[98:99], v[98:99], v[64:65], v[80:81] op_sel:[0,0,0] op_sel_hi:[1,0,0]
    v_pk_fma_f32 v[100:101], v[100:101], v[64:65], v[80:81] op_sel:[0,0,0] op_sel_hi:[1,0,0]
    v_pk_fma_f32 v[102:103], v[102:103], v[64:65], v[80:81] op_sel:[0,0,0] op_sel_hi:[1,0,0]
    v_cvt_pk_bf16_f32 v104, v96, v97
    v_cvt_pk_bf16_f32 v105, v98, v99
    v_cvt_pk_bf16_f32 v106, v100, v101
    v_cvt_pk_bf16_f32 v107, v102, v103
    buffer_store_dwordx4 v[104:107], v5, s[16:19], s63 offen sc1
    v_accvgpr_read_b32 v108, a1
    v_accvgpr_read_b32 v109, a5
    v_accvgpr_read_b32 v110, a9
    v_accvgpr_read_b32 v111, a13
    v_accvgpr_read_b32 v112, a17
    v_accvgpr_read_b32 v113, a21
    v_accvgpr_read_b32 v114, a25
    v_accvgpr_read_b32 v115, a29
    v_pk_fma_f32 v[108:109], v[108:109], v[64:65], v[80:81] op_sel:[0,1,1] op_sel_hi:[1,1,1]
    v_pk_fma_f32 v[110:111], v[110:111], v[64:65], v[80:81] op_sel:[0,1,1] op_sel_hi:[1,1,1]
    v_pk_fma_f32 v[112:113], v[112:113], v[64:65], v[80:81] op_sel:[0,1,1] op_sel_hi:[1,1,1]
    v_pk_fma_f32 v[114:115], v[114:115], v[64:65], v[80:81] op_sel:[0,1,1] op_sel_hi:[1,1,1]
    v_cvt_pk_bf16_f32 v116, v108, v109
    v_cvt_pk_bf16_f32 v117, v110, v111
    v_cvt_pk_bf16_f32 v118, v112, v113
    v_cvt_pk_bf16_f32 v119, v114, v115
    buffer_store_dwordx4 v[116:119], v5, s[16:19], s63 offen offset:256 sc1
    v_accvgpr_read_b32 v120, a2
    v_accvgpr_read_b32 v121, a6
    v_accvgpr_read_b32 v122, a10
    v_accvgpr_read_b32 v123, a14
    v_accvgpr_read_b32 v124, a18
    v_accvgpr_read_b32 v125, a22
    v_accvgpr_read_b32 v126, a26
    v_accvgpr_read_b32 v127, a30
    v_pk_fma_f32 v[120:121], v[120:121], v[66:67], v[82:83] op_sel:[0,0,0] op_sel_hi:[1,0,0]
    v_pk_fma_f32 v[122:123], v[122:123], v[66:67], v[82:83] op_sel:[0,0,0] op_sel_hi:[1,0,0]
    v_pk_fma_f32 v[124:125], v[124:125], v[66:67], v[82:83] op_sel:[0,0,0] op_sel_hi:[1,0,0]
    v_pk_fma_f32 v[126:127], v[126:127], v[66:67], v[82:83] op_sel:[0,0,0] op_sel_hi:[1,0,0]
    v_cvt_pk_bf16_f32 v128, v120, v121
    v_cvt_pk_bf16_f32 v129, v122, v123
    v_cvt_pk_bf16_f32 v130, v124, v125
    v_cvt_pk_bf16_f32 v131, v126, v127
    buffer_store_dwordx4 v[128:131], v5, s[16:19], s63 offen offset:512 sc1
    v_accvgpr_read_b32 v132, a3
    v_accvgpr_read_b32 v133, a7
    v_accvgpr_read_b32 v134, a11
    v_accvgpr_read_b32 v135, a15
    v_accvgpr_read_b32 v136, a19
    v_accvgpr_read_b32 v137, a23
    v_accvgpr_read_b32 v138, a27
    v_accvgpr_read_b32 v139, a31
    v_pk_fma_f32 v[132:133], v[132:133], v[66:67], v[82:83] op_sel:[0,1,1] op_sel_hi:[1,1,1]
    v_pk_fma_f32 v[134:135], v[134:135], v[66:67], v[82:83] op_sel:[0,1,1] op_sel_hi:[1,1,1]
    v_pk_fma_f32 v[136:137], v[136:137], v[66:67], v[82:83] op_sel:[0,1,1] op_sel_hi:[1,1,1]
    v_pk_fma_f32 v[138:139], v[138:139], v[66:67], v[82:83] op_sel:[0,1,1] op_sel_hi:[1,1,1]
    v_cvt_pk_bf16_f32 v140, v132, v133
    v_cvt_pk_bf16_f32 v141, v134, v135
    v_cvt_pk_bf16_f32 v142, v136, v137
    v_cvt_pk_bf16_f32 v143, v138, v139
    buffer_store_dwordx4 v[140:143], v5, s[16:19], s63 offen offset:768 sc1
    s_add_u32 s63, s86, 0x1000
    v_rcp_f32_e32 v68, v68
    v_rcp_f32_e32 v69, v69
    v_rcp_f32_e32 v70, v70
    v_rcp_f32_e32 v71, v71
    s_nop 0
    v_mul_f32_e64 v84, -v84, v68
    v_mul_f32_e64 v85, -v85, v69
    v_mul_f32_e64 v86, -v86, v70
    v_mul_f32_e64 v87, -v87, v71
    v_accvgpr_read_b32 v144, a32
    v_accvgpr_read_b32 v145, a36
    v_accvgpr_read_b32 v146, a40
    v_accvgpr_read_b32 v147, a44
    v_accvgpr_read_b32 v148, a48
    v_accvgpr_read_b32 v149, a52
    v_accvgpr_read_b32 v150, a56
    v_accvgpr_read_b32 v151, a60
    v_pk_fma_f32 v[144:145], v[144:145], v[68:69], v[84:85] op_sel:[0,0,0] op_sel_hi:[1,0,0]
    v_pk_fma_f32 v[146:147], v[146:147], v[68:69], v[84:85] op_sel:[0,0,0] op_sel_hi:[1,0,0]
    v_pk_fma_f32 v[148:149], v[148:149], v[68:69], v[84:85] op_sel:[0,0,0] op_sel_hi:[1,0,0]
    v_pk_fma_f32 v[150:151], v[150:151], v[68:69], v[84:85] op_sel:[0,0,0] op_sel_hi:[1,0,0]
    v_cvt_pk_bf16_f32 v152, v144, v145
    v_cvt_pk_bf16_f32 v153, v146, v147
    v_cvt_pk_bf16_f32 v154, v148, v149
    v_cvt_pk_bf16_f32 v155, v150, v151
    buffer_store_dwordx4 v[152:155], v5, s[16:19], s63 offen sc1
    v_accvgpr_read_b32 v96, a33
    v_accvgpr_read_b32 v97, a37
    v_accvgpr_read_b32 v98, a41
    v_accvgpr_read_b32 v99, a45
    v_accvgpr_read_b32 v100, a49
    v_accvgpr_read_b32 v101, a53
    v_accvgpr_read_b32 v102, a57
    v_accvgpr_read_b32 v103, a61
    v_pk_fma_f32 v[96:97], v[96:97], v[68:69], v[84:85] op_sel:[0,1,1] op_sel_hi:[1,1,1]
    v_pk_fma_f32 v[98:99], v[98:99], v[68:69], v[84:85] op_sel:[0,1,1] op_sel_hi:[1,1,1]
    v_pk_fma_f32 v[100:101], v[100:101], v[68:69], v[84:85] op_sel:[0,1,1] op_sel_hi:[1,1,1]
    v_pk_fma_f32 v[102:103], v[102:103], v[68:69], v[84:85] op_sel:[0,1,1] op_sel_hi:[1,1,1]
    v_cvt_pk_bf16_f32 v104, v96, v97
    v_cvt_pk_bf16_f32 v105, v98, v99
    v_cvt_pk_bf16_f32 v106, v100, v101
    v_cvt_pk_bf16_f32 v107, v102, v103
    buffer_store_dwordx4 v[104:107], v5, s[16:19], s63 offen offset:256 sc1
    v_accvgpr_read_b32 v108, a34
    v_accvgpr_read_b32 v109, a38
    v_accvgpr_read_b32 v110, a42
    v_accvgpr_read_b32 v111, a46
    v_accvgpr_read_b32 v112, a50
    v_accvgpr_read_b32 v113, a54
    v_accvgpr_read_b32 v114, a58
    v_accvgpr_read_b32 v115, a62
    v_pk_fma_f32 v[108:109], v[108:109], v[70:71], v[86:87] op_sel:[0,0,0] op_sel_hi:[1,0,0]
    v_pk_fma_f32 v[110:111], v[110:111], v[70:71], v[86:87] op_sel:[0,0,0] op_sel_hi:[1,0,0]
    v_pk_fma_f32 v[112:113], v[112:113], v[70:71], v[86:87] op_sel:[0,0,0] op_sel_hi:[1,0,0]
    v_pk_fma_f32 v[114:115], v[114:115], v[70:71], v[86:87] op_sel:[0,0,0] op_sel_hi:[1,0,0]
    v_cvt_pk_bf16_f32 v116, v108, v109
    v_cvt_pk_bf16_f32 v117, v110, v111
    v_cvt_pk_bf16_f32 v118, v112, v113
    v_cvt_pk_bf16_f32 v119, v114, v115
    buffer_store_dwordx4 v[116:119], v5, s[16:19], s63 offen offset:512 sc1
    v_accvgpr_read_b32 v120, a35
    v_accvgpr_read_b32 v121, a39
    v_accvgpr_read_b32 v122, a43
    v_accvgpr_read_b32 v123, a47
    v_accvgpr_read_b32 v124, a51
    v_accvgpr_read_b32 v125, a55
    v_accvgpr_read_b32 v126, a59
    v_accvgpr_read_b32 v127, a63
    v_pk_fma_f32 v[120:121], v[120:121], v[70:71], v[86:87] op_sel:[0,1,1] op_sel_hi:[1,1,1]
    v_pk_fma_f32 v[122:123], v[122:123], v[70:71], v[86:87] op_sel:[0,1,1] op_sel_hi:[1,1,1]
    v_pk_fma_f32 v[124:125], v[124:125], v[70:71], v[86:87] op_sel:[0,1,1] op_sel_hi:[1,1,1]
    v_pk_fma_f32 v[126:127], v[126:127], v[70:71], v[86:87] op_sel:[0,1,1] op_sel_hi:[1,1,1]
    v_cvt_pk_bf16_f32 v128, v120, v121
    v_cvt_pk_bf16_f32 v129, v122, v123
    v_cvt_pk_bf16_f32 v130, v124, v125
    v_cvt_pk_bf16_f32 v131, v126, v127
    buffer_store_dwordx4 v[128:131], v5, s[16:19], s63 offen offset:768 sc1
    v_accvgpr_read_b32 v160, a136
    v_accvgpr_read_b32 v161, a137
    v_accvgpr_read_b32 v162, a138
    v_accvgpr_read_b32 v163, a139
    s_nop 1
    v_mov_b32_dpp v72, v160 row_newbcast:0 row_mask:0xf bank_mask:0xf
    v_mov_b32_dpp v73, v161 row_newbcast:0 row_mask:0xf bank_mask:0xf
    v_mov_b32_dpp v74, v162 row_newbcast:0 row_mask:0xf bank_mask:0xf
    v_mov_b32_dpp v75, v163 row_newbcast:0 row_mask:0xf bank_mask:0xf
    v_mov_b32_dpp v88, v160 row_newbcast:2 row_mask:0xf bank_mask:0xf
    v_mov_b32_dpp v89, v161 row_newbcast:2 row_mask:0xf bank_mask:0xf
    v_mov_b32_dpp v90, v162 row_newbcast:2 row_mask:0xf bank_mask:0xf
    v_mov_b32_dpp v91, v163 row_newbcast:2 row_mask:0xf bank_mask:0xf
    v_add_f32_dpp v72, v160, v72 row_newbcast:1 row_mask:0xf bank_mask:0xf
    v_add_f32_dpp v73, v161, v73 row_newbcast:1 row_mask:0xf bank_mask:0xf
    v_add_f32_dpp v74, v162, v74 row_newbcast:1 row_mask:0xf bank_mask:0xf
    v_add_f32_dpp v75, v163, v75 row_newbcast:1 row_mask:0xf bank_mask:0xf
    v_accvgpr_read_b32 v160, a140
    v_accvgpr_read_b32 v161, a141
    v_accvgpr_read_b32 v162, a142
    v_accvgpr_read_b32 v163, a143
    s_nop 1
    v_mov_b32_dpp v76, v160 row_newbcast:0 row_mask:0xf bank_mask:0xf
    v_mov_b32_dpp v77, v161 row_newbcast:0 row_mask:0xf bank_mask:0xf
    v_mov_b32_dpp v78, v162 row_newbcast:0 row_mask:0xf bank_mask:0xf
    v_mov_b32_dpp v79, v163 row_newbcast:0 row_mask:0xf bank_mask:0xf
    v_mov_b32_dpp v92, v160 row_newbcast:2 row_mask:0xf bank_mask:0xf
    v_mov_b32_dpp v93, v161 row_newbcast:2 row_mask:0xf bank_mask:0xf
    v_mov_b32_dpp v94, v162 row_newbcast:2 row_mask:0xf bank_mask:0xf
    v_mov_b32_dpp v95, v163 row_newbcast:2 row_mask:0xf bank_mask:0xf
    v_add_f32_dpp v76, v160, v76 row_newbcast:1 row_mask:0xf bank_mask:0xf
    v_add_f32_dpp v77, v161, v77 row_newbcast:1 row_mask:0xf bank_mask:0xf
    v_add_f32_dpp v78, v162, v78 row_newbcast:1 row_mask:0xf bank_mask:0xf
    v_add_f32_dpp v79, v163, v79 row_newbcast:1 row_mask:0xf bank_mask:0xf
    s_nop 0
    v_min3_f32 v10, v72, v73, v74
    v_max3_f32 v11, v72, v73, v74
    v_add_f32_e32 v12, v72, v73
    v_min3_f32 v10, v10, v75, v76
    v_max3_f32 v11, v11, v75, v76
    v_min3_f32 v10, v10, v77, v78
    v_max3_f32 v11, v11, v77, v78
    v_min_f32_e32 v10, v10, v79
    v_max_f32_e32 v11, v11, v79
    v_add_f32_e32 v12, v12, v74
    v_add_f32_e32 v12, v12, v75
    v_add_f32_e32 v12, v12, v76
    v_add_f32_e32 v12, v12, v77
    v_add_f32_e32 v12, v12, v78
    v_add_f32_e32 v12, v12, v79
    v_cmp_lt_f32_e64 s[90:91], s67, v10
    v_cmp_gt_f32_e64 s[92:93], s68, v11
    v_cmp_o_f32_e64 s[96:97], v12, v12
    s_nop 4
    s_and_b64 s[90:91], s[90:91], s[92:93]
    s_and_b64 s[90:91], s[90:91], s[96:97]
    s_cmp_eq_u64 s[90:91], exec
    s_cbranch_scc0 at_slow
    s_add_u32 s63, s86, 0x2000
    v_rcp_f32_e32 v72, v72
    v_rcp_f32_e32 v73, v73
    v_rcp_f32_e32 v74, v74
    v_rcp_f32_e32 v75, v75
    s_nop 0
    v_mul_f32_e64 v88, -v88, v72
    v_mul_f32_e64 v89, -v89, v73
    v_mul_f32_e64 v90, -v90, v74
    v_mul_f32_e64 v91, -v91, v75
    v_accvgpr_read_b32 v132, a64
    v_accvgpr_read_b32 v133, a68
    v_accvgpr_read_b32 v134, a72
    v_accvgpr_read_b32 v135, a76
    v_accvgpr_read_b32 v136, a80
    v_accvgpr_read_b32 v137, a84
    v_accvgpr_read_b32 v138, a88
    v_accvgpr_read_b32 v139, a92
    v_pk_fma_f32 v[132:133], v[132:133], v[72:73], v[88:89] op_sel:[0,0,0] op_sel_hi:[1,0,0]
    v_pk_fma_f32 v[134:135], v[134:135], v[72:73], v[88:89] op_sel:[0,0,0] op_sel_hi:[1,0,0]
    v_pk_fma_f32 v[136:137], v[136:137], v[72:73], v[88:89] op_sel:[0,0,0] op_sel_hi:[1,0,0]
    v_pk_fma_f32 v[138:139], v[138:139], v[72:73], v[88:89] op_sel:[0,0,0] op_sel_hi:[1,0,0]
    v_cvt_pk_bf16_f32 v140, v132, v133
    v_cvt_pk_bf16_f32 v141, v134, v135
    v_cvt_pk_bf16_f32 v142, v136, v137
    v_cvt_pk_bf16_f32 v143, v138, v139
    buffer_store_dwordx4 v[140:143], v5, s[16:19], s63 offen sc1
    v_accvgpr_read_b32 v144, a65
    v_accvgpr_read_b32 v145, a69
    v_accvgpr_read_b32 v146, a73
    v_accvgpr_read_b32 v147, a77
    v_accvgpr_read_b32 v148, a81
    v_accvgpr_read_b32 v149, a85
    v_accvgpr_read_b32 v150, a89
    v_accvgpr_read_b32 v151, a93
    v_pk_fma_f32 v[144:145], v[144:145], v[72:73], v[88:89] op_sel:[0,1,1] op_sel_hi:[1,1,1]
    v_pk_fma_f32 v[146:147], v[146:147], v[72:73], v[88:89] op_sel:[0,1,1] op_sel_hi:[1,1,1]
    v_pk_fma_f32 v[148:149], v[148:149], v[72:73], v[88:89] op_sel:[0,1,1] op_sel_hi:[1,1,1]
    v_pk_fma_f32 v[150:151], v[150:151], v[72:73], v[88:89] op_sel:[0,1,1] op_sel_hi:[1,1,1]
    v_cvt_pk_bf16_f32 v152, v144, v145
    v_cvt_pk_bf16_f32 v153, v146, v147
    v_cvt_pk_bf16_f32 v154, v148, v149
    v_cvt_pk_bf16_f32 v155, v150, v151
    buffer_store_dwordx4 v[152:155], v5, s[16:19], s63 offen offset:256 sc1
    v_accvgpr_read_b32 v96, a66
    v_accvgpr_read_b32 v97, a70
    v_accvgpr_read_b32 v98, a74
    v_accvgpr_read_b32 v99, a78
    v_accvgpr_read_b32 v100, a82
    v_accvgpr_read_b32 v101, a86
    v_accvgpr_read_b32 v102, a90
    v_accvgpr_read_b32 v103, a94
    v_pk_fma_f32 v[96:97], v[96:97], v[74:75], v[90:91] op_sel:[0,0,0] op_sel_hi:[1,0,0]
    v_pk_fma_f32 v[98:99], v[98:99], v[74:75], v[90:91] op_sel:[0,0,0] op_sel_hi:[1,0,0]
    v_pk_fma_f32 v[100:101], v[100:101], v[74:75], v[90:91] op_sel:[0,0,0] op_sel_hi:[1,0,0]
    v_pk_fma_f32 v[102:103], v[102:103], v[74:75], v[90:91] op_sel:[0,0,0] op_sel_hi:[1,0,0]
    v_cvt_pk_bf16_f32 v104, v96, v97
    v_cvt_pk_bf16_f32 v105, v98, v99
    v_cvt_pk_bf16_f32 v106, v100, v101
    v_cvt_pk_bf16_f32 v107, v102, v103
    buffer_store_dwordx4 v[104:107], v5, s[16:19], s63 offen offset:512 sc1
    v_accvgpr_read_b32 v108, a67
    v_accvgpr_read_b32 v109, a71
    v_accvgpr_read_b32 v110, a75
    v_accvgpr_read_b32 v111, a79
    v_accvgpr_read_b32 v112, a83
    v_accvgpr_read_b32 v113, a87
    v_accvgpr_read_b32 v114, a91
    v_accvgpr_read_b32 v115, a95
    v_pk_fma_f32 v[108:109], v[108:109], v[74:75], v[90:91] op_sel:[0,1,1] op_sel_hi:[1,1,1]
    v_pk_fma_f32 v[110:111], v[110:111], v[74:75], v[90:91] op_sel:[0,1,1] op_sel_hi:[1,1,1]
    v_pk_fma_f32 v[112:113], v[112:113], v[74:75], v[90:91] op_sel:[0,1,1] op_sel_hi:[1,1,1]
    v_pk_fma_f32 v[114:115], v[114:115], v[74:75], v[90:91] op_sel:[0,1,1] op_sel_hi:[1,1,1]
    v_cvt_pk_bf16_f32 v116, v108, v109
    v_cvt_pk_bf16_f32 v117, v110, v111
    v_cvt_pk_bf16_f32 v118, v112, v113
    v_cvt_pk_bf16_f32 v119, v114, v115
    buffer_store_dwordx4 v[116:119], v5, s[16:19], s63 offen offset:768 sc1
    s_add_u32 s63, s86, 0x3000
    v_rcp_f32_e32 v76, v76
    v_rcp_f32_e32 v77, v77
    v_rcp_f32_e32 v78, v78
    v_rcp_f32_e32 v79, v79
    s_nop 0
    v_mul_f32_e64 v92, -v92, v76
    v_mul_f32_e64 v93, -v93, v77
    v_mul_f32_e64 v94, -v94, v78
    v_mul_f32_e64 v95, -v95, v79
    v_accvgpr_read_b32 v120, a96
    v_accvgpr_read_b32 v121, a100
    v_accvgpr_read_b32 v122, a104
    v_accvgpr_read_b32 v123, a108
    v_accvgpr_read_b32 v124, a112
    v_accvgpr_read_b32 v125, a116
    v_accvgpr_read_b32 v126, a120
    v_accvgpr_read_b32 v127, a124
    v_pk_fma_f32 v[120:121], v[120:121], v[76:77], v[92:93] op_sel:[0,0,0] op_sel_hi:[1,0,0]
    v_pk_fma_f32 v[122:123], v[122:123], v[76:77], v[92:93] op_sel:[0,0,0] op_sel_hi:[1,0,0]
    v_pk_fma_f32 v[124:125], v[124:125], v[76:77], v[92:93] op_sel:[0,0,0] op_sel_hi:[1,0,0]
    v_pk_fma_f32 v[126:127], v[126:127], v[76:77], v[92:93] op_sel:[0,0,0] op_sel_hi:[1,0,0]
    v_cvt_pk_bf16_f32 v128, v120, v121
    v_cvt_pk_bf16_f32 v129, v122, v123
    v_cvt_pk_bf16_f32 v130, v124, v125
    v_cvt_pk_bf16_f32 v131, v126, v127
    buffer_store_dwordx4 v[128:131], v5, s[16:19], s63 offen sc1
    v_accvgpr_read_b32 v132, a97
    v_accvgpr_read_b32 v133, a101
    v_accvgpr_read_b32 v134, a105
    v_accvgpr_read_b32 v135, a109
    v_accvgpr_read_b32 v136, a113
    v_accvgpr_read_b32 v137, a117
    v_accvgpr_read_b32 v138, a121
    v_accvgpr_read_b32 v139, a125
    v_pk_fma_f32 v[132:133], v[132:133], v[76:77], v[92:93] op_sel:[0,1,1] op_sel_hi:[1,1,1]
    v_pk_fma_f32 v[134:135], v[134:135], v[76:77], v[92:93] op_sel:[0,1,1] op_sel_hi:[1,1,1]
    v_pk_fma_f32 v[136:137], v[136:137], v[76:77], v[92:93] op_sel:[0,1,1] op_sel_hi:[1,1,1]
    v_pk_fma_f32 v[138:139], v[138:139], v[76:77], v[92:93] op_sel:[0,1,1] op_sel_hi:[1,1,1]
    v_cvt_pk_bf16_f32 v140, v132, v133
    v_cvt_pk_bf16_f32 v141, v134, v135
    v_cvt_pk_bf16_f32 v142, v136, v137
    v_cvt_pk_bf16_f32 v143, v138, v139
    buffer_store_dwordx4 v[140:143], v5, s[16:19], s63 offen offset:256 sc1
    v_accvgpr_read_b32 v144, a98
    v_accvgpr_read_b32 v145, a102
    v_accvgpr_read_b32 v146, a106
    v_accvgpr_read_b32 v147, a110
    v_accvgpr_read_b32 v148, a114
    v_accvgpr_read_b32 v149, a118
    v_accvgpr_read_b32 v150, a122
    v_accvgpr_read_b32 v151, a126
    v_pk_fma_f32 v[144:145], v[144:145], v[78:79], v[94:95] op_sel:[0,0,0] op_sel_hi:[1,0,0]
    v_pk_fma_f32 v[146:147], v[146:147], v[78:79], v[94:95] op_sel:[0,0,0] op_sel_hi:[1,0,0]
    v_pk_fma_f32 v[148:149], v[148:149], v[78:79], v[94:95] op_sel:[0,0,0] op_sel_hi:[1,0,0]
    v_pk_fma_f32 v[150:151], v[150:151], v[78:79], v[94:95] op_sel:[0,0,0] op_sel_hi:[1,0,0]
    v_cvt_pk_bf16_f32 v152, v144, v145
    v_cvt_pk_bf16_f32 v153, v146, v147
    v_cvt_pk_bf16_f32 v154, v148, v149
    v_cvt_pk_bf16_f32 v155, v150, v151
    buffer_store_dwordx4 v[152:155], v5, s[16:19], s63 offen offset:512 sc1
    v_accvgpr_read_b32 v96, a99
    v_accvgpr_read_b32 v97, a103
    v_accvgpr_read_b32 v98, a107
    v_accvgpr_read_b32 v99, a111
    v_accvgpr_read_b32 v100, a115
    v_accvgpr_read_b32 v101, a119
    v_accvgpr_read_b32 v102, a123
    v_accvgpr_read_b32 v103, a127
    v_pk_fma_f32 v[96:97], v[96:97], v[78:79], v[94:95] op_sel:[0,1,1] op_sel_hi:[1,1,1]
    v_pk_fma_f32 v[98:99], v[98:99], v[78:79], v[94:95] op_sel:[0,1,1] op_sel_hi:[1,1,1]
    v_pk_fma_f32 v[100:101], v[100:101], v[78:79], v[94:95] op_sel:[0,1,1] op_sel_hi:[1,1,1]
    v_pk_fma_f32 v[102:103], v[102:103], v[78:79], v[94:95] op_sel:[0,1,1] op_sel_hi:[1,1,1]
    v_cvt_pk_bf16_f32 v104, v96, v97
    v_cvt_pk_bf16_f32 v105, v98, v99
    v_cvt_pk_bf16_f32 v106, v100, v101
    v_cvt_pk_bf16_f32 v107, v102, v103
    buffer_store_dwordx4 v[104:107], v5, s[16:19], s63 offen offset:768 sc1
    s_endpgm
at_spin6_in:
    s_mov_b32 s94, 0x100000
at_spin6:
    v_lshlrev_b32_e32 v12, 1, v15
    buffer_load_dwordx2 v[12:13], v12, s[48:51], 0 offen sc1
    s_sub_u32 s94, s94, 1
    s_cbranch_scc1 at_spin6_out
    s_waitcnt vmcnt(0)
    v_cmp_eq_u64_e64 s[90:91], s[92:93], v[12:13]
    s_nop 4
    s_lshr_b32 s64, s90, s66
    s_and_b32 s64, s64, 0xff
    s_cmp_eq_u32 s64, 0xff
    s_cbranch_scc0 at_spin6
at_spin6_out:
    s_branch at_back6
at_slow:
    v_bfe_u32 v8, v2, 4, 4
    v_lshrrev_b32_e32 v9, 8, v2
    v_lshlrev_b32_e32 v5, 10, v9
    v_lshl_add_u32 v5, v8, 4, v5
    s_mov_b32 s67, 0x26800000
    s_mov_b32 s68, 0x5d800000
    v_mov_b32_e32 v10, 0x3f803f80
    v_cmp_eq_u32_e32 vcc, 0, v8
    v_lshlrev_b32_e32 v100, 3, v9
    s_nop 0
    v_cndmask_b32_e32 v10, 0, v10, vcc
    s_nop 15
    v_accvgpr_write_b32 a240, v10
    v_accvgpr_write_b32 a241, v10
    v_accvgpr_write_b32 a242, v10
    v_accvgpr_write_b32 a243, v10
    v_mov_b32_e32 v96, 0xff800000
    v_mov_b32_e32 v97, 0xff800000
    v_mov_b32_e32 v98, 0xff800000
    v_mov_b32_e32 v99, 0xff800000
    s_mov_b32 s56, 0
at_slow1:
    s_add_u32 s63, s56, 0
    buffer_load_dwordx4 v[64:67], v2, s[20:23], s63 offen sc1
    buffer_load_dwordx4 v[68:71], v2, s[20:23], s63 offen offset:1024 sc1
    buffer_load_dwordx4 v[72:75], v2, s[20:23], s63 offen offset:2048 sc1
    buffer_load_dwordx4 v[76:79], v2, s[20:23], s63 offen offset:3072 sc1
    s_add_u32 s63, s56, 0x1000
    buffer_load_dwordx4 v[80:83], v2, s[20:23], s63 offen sc1
    buffer_load_dwordx4 v[84:87], v2, s[20:23], s63 offen offset:1024 sc1
    buffer_load_dwordx4 v[88:91], v2, s[20:23], s63 offen offset:2048 sc1
    buffer_load_dwordx4 v[92:95], v2, s[20:23], s63 offen offset:3072 sc1
    s_waitcnt vmcnt(0)
    v_mfma_f32_16x16x32_bf16 v[16:19], v[64:67], a[144:147], 0
    v_mfma_f32_16x16x32_bf16 v[16:19], v[68:71], a[148:151], v[16:19]
    v_mfma_f32_16x16x32_bf16 v[16:19], v[72:75], a[152:155], v[16:19]
    v_mfma_f32_16x16x32_bf16 v[16:19], v[76:79], a[156:159], v[16:19]
    v_mfma_f32_16x16x32_bf16 v[20:23], v[80:83], a[144:147], 0
    v_mfma_f32_16x16x32_bf16 v[20:23], v[84:87], a[148:151], v[20:23]
    v_mfma_f32_16x16x32_bf16 v[20:23], v[88:91], a[152:155], v[20:23]
    v_mfma_f32_16x16x32_bf16 v[20:23], v[92:95], a[156:159], v[20:23]
    v_mfma_f32_16x16x32_bf16 v[24:27], v[64:67], a[160:163], 0
    v_mfma_f32_16x16x32_bf16 v[24:27], v[68:71], a[164:167], v[24:27]
    v_mfma_f32_16x16x32_bf16 v[24:27], v[72:75], a[168:171], v[24:27]
    v_mfma_f32_16x16x32_bf16 v[24:27], v[76:79], a[172:175], v[24:27]
    v_mfma_f32_16x16x32_bf16 v[28:31], v[80:83], a[160:163], 0
    v_mfma_f32_16x16x32_bf16 v[28:31], v[84:87], a[164:167], v[28:31]
    v_mfma_f32_16x16x32_bf16 v[28:31], v[88:91], a[168:171], v[28:31]
    v_mfma_f32_16x16x32_bf16 v[28:31], v[92:95], a[172:175], v[28:31]
    v_mfma_f32_16x16x32_bf16 v[32:35], v[64:67], a[176:179], 0
    v_mfma_f32_16x16x32_bf16 v[32:35], v[68:71], a[180:183], v[32:35]
    v_mfma_f32_16x16x32_bf16 v[32:35], v[72:75], a[184:187], v[32:35]
    v_mfma_f32_16x16x32_bf16 v[32:35], v[76:79], a[188:191], v[32:35]
    v_mfma_f32_16x16x32_bf16 v[36:39], v[80:83], a[176:179], 0
    v_mfma_f32_16x16x32_bf16 v[36:39], v[84:87], a[180:183], v[36:39]
    v_mfma_f32_16x16x32_bf16 v[36:39], v[88:91], a[184:187], v[36:39]
    v_mfma_f32_16x16x32_bf16 v[36:39], v[92:95], a[188:191], v[36:39]
    v_mfma_f32_16x16x32_bf16 v[40:43], v[64:67], a[192:195], 0
    v_mfma_f32_16x16x32_bf16 v[40:43], v[68:71], a[196:199], v[40:43]
    v_mfma_f32_16x16x32_bf16 v[40:43], v[72:75], a[200:203], v[40:43]
    v_mfma_f32_16x16x32_bf16 v[40:43], v[76:79], a[204:207], v[40:43]
    v_mfma_f32_16x16x32_bf16 v[44:47], v[80:83], a[192:195], 0
    v_mfma_f32_16x16x32_bf16 v[44:47], v[84:87], a[196:199], v[44:47]
    v_mfma_f32_16x16x32_bf16 v[44:47], v[88:91], a[200:203], v[44:47]
    v_mfma_f32_16x16x32_bf16 v[44:47], v[92:95], a[204:207], v[44:47]
    s_nop 15
    v_max3_f32 v96, v96, v16, v17
    v_max3_f32 v96, v96, v18, v19
    v_max3_f32 v96, v96, v20, v21
    v_max3_f32 v96, v96, v22, v23
    v_max3_f32 v97, v97, v24, v25
    v_max3_f32 v97, v97, v26, v27
    v_max3_f32 v97, v97, v28, v29
    v_max3_f32 v97, v97, v30, v31
    v_max3_f32 v98, v98, v32, v33
    v_max3_f32 v98, v98, v34, v35
    v_max3_f32 v98, v98, v36, v37
    v_max3_f32 v98, v98, v38, v39
    v_max3_f32 v99, v99, v40, v41
    v_max3_f32 v99, v99, v42, v43
    v_max3_f32 v99, v99, v44, v45
    v_max3_f32 v99, v99, v46, v47
    s_add_u32 s56, s56, 0x4000
    s_cmp_lt_u32 s56, 0x100000
    s_cbranch_scc1 at_slow1
    v_mov_b32_e32 v10, v96
    v_mov_b32_e32 v11, v96
    s_nop 1
    v_permlane32_swap_b32 v10, v11
    s_nop 1
    v_max_f32_e32 v96, v10, v11
    v_mov_b32_e32 v10, v96
    v_mov_b32_e32 v11, v96
    s_nop 1
    v_permlane16_swap_b32 v10, v11
    s_nop 1
    v_max_f32_e32 v96, v10, v11
    v_mov_b32_e32 v10, v97
    v_mov_b32_e32 v11, v97
    s_nop 1
    v_permlane32_swap_b32 v10, v11
    s_nop 1
    v_max_f32_e32 v97, v10, v11
    v_mov_b32_e32 v10, v97
    v_mov_b32_e32 v11, v97
    s_nop 1
    v_permlane16_swap_b32 v10, v11
    s_nop 1
    v_max_f32_e32 v97, v10, v11
    v_mov_b32_e32 v10, v98
    v_mov_b32_e32 v11, v98
    s_nop 1
    v_permlane32_swap_b32 v10, v11
    s_nop 1
    v_max_f32_e32 v98, v10, v11
    v_mov_b32_e32 v10, v98
    v_mov_b32_e32 v11, v98
    s_nop 1
    v_permlane16_swap_b32 v10, v11
    s_nop 1
    v_max_f32_e32 v98, v10, v11
    v_mov_b32_e32 v10, v99
    v_mov_b32_e32 v11, v99
    s_nop 1
    v_permlane32_swap_b32 v10, v11
    s_nop 1
    v_max_f32_e32 v99, v10, v11
    v_mov_b32_e32 v10, v99
    v_mov_b32_e32 v11, v99
    s_nop 1
    v_permlane16_swap_b32 v10, v11
    s_nop 1
    v_max_f32_e32 v99, v10, v11
    v_accvgpr_write_b32 a0, 0
    v_accvgpr_write_b32 a1, 0
    v_accvgpr_write_b32 a2, 0
    v_accvgpr_write_b32 a3, 0
    v_accvgpr_write_b32 a4, 0
    v_accvgpr_write_b32 a5, 0
    v_accvgpr_write_b32 a6, 0
    v_accvgpr_write_b32 a7, 0
    v_accvgpr_write_b32 a8, 0
    v_accvgpr_write_b32 a9, 0
    v_accvgpr_write_b32 a10, 0
    v_accvgpr_write_b32 a11, 0
    v_accvgpr_write_b32 a12, 0
    v_accvgpr_write_b32 a13, 0
    v_accvgpr_write_b32 a14, 0
    v_accvgpr_write_b32 a15, 0
    v_accvgpr_write_b32 a16, 0
    v_accvgpr_write_b32 a17, 0
    v_accvgpr_write_b32 a18, 0
    v_accvgpr_write_b32 a19, 0
    v_accvgpr_write_b32 a20, 0
    v_accvgpr_write_b32 a21, 0
    v_accvgpr_write_b32 a22, 0
    v_accvgpr_write_b32 a23, 0
    v_accvgpr_write_b32 a24, 0
    v_accvgpr_write_b32 a25, 0
    v_accvgpr_write_b32 a26, 0
    v_accvgpr_write_b32 a27, 0
    v_accvgpr_write_b32 a28, 0
    v_accvgpr_write_b32 a29, 0
    v_accvgpr_write_b32 a30, 0
    v_accvgpr_write_b32 a31, 0
    v_accvgpr_write_b32 a32, 0
    v_accvgpr_write_b32 a33, 0
    v_accvgpr_write_b32 a34, 0
    v_accvgpr_write_b32 a35, 0
    v_accvgpr_write_b32 a36, 0
    v_accvgpr_write_b32 a37, 0
    v_accvgpr_write_b32 a38, 0
    v_accvgpr_write_b32 a39, 0
    v_accvgpr_write_b32 a40, 0
    v_accvgpr_write_b32 a41, 0
    v_accvgpr_write_b32 a42, 0
    v_accvgpr_write_b32 a43, 0
    v_accvgpr_write_b32 a44, 0
    v_accvgpr_write_b32 a45, 0
    v_accvgpr_write_b32 a46, 0
    v_accvgpr_write_b32 a47, 0
    v_accvgpr_write_b32 a48, 0
    v_accvgpr_write_b32 a49, 0
    v_accvgpr_write_b32 a50, 0
    v_accvgpr_write_b32 a51, 0
    v_accvgpr_write_b32 a52, 0
    v_accvgpr_write_b32 a53, 0
    v_accvgpr_write_b32 a54, 0
    v_accvgpr_write_b32 a55, 0
    v_accvgpr_write_b32 a56, 0
    v_accvgpr_write_b32 a57, 0
    v_accvgpr_write_b32 a58, 0
    v_accvgpr_write_b32 a59, 0
    v_accvgpr_write_b32 a60, 0
    v_accvgpr_write_b32 a61, 0
    v_accvgpr_write_b32 a62, 0
    v_accvgpr_write_b32 a63, 0
    v_accvgpr_write_b32 a64, 0
    v_accvgpr_write_b32 a65, 0
    v_accvgpr_write_b32 a66, 0
    v_accvgpr_write_b32 a67, 0
    v_accvgpr_write_b32 a68, 0
    v_accvgpr_write_b32 a69, 0
    v_accvgpr_write_b32 a70, 0
    v_accvgpr_write_b32 a71, 0
    v_accvgpr_write_b32 a72, 0
    v_accvgpr_write_b32 a73, 0
    v_accvgpr_write_b32 a74, 0
    v_accvgpr_write_b32 a75, 0
    v_accvgpr_write_b32 a76, 0
    v_accvgpr_write_b32 a77, 0
    v_accvgpr_write_b32 a78, 0
    v_accvgpr_write_b32 a79, 0
    v_accvgpr_write_b32 a80, 0
    v_accvgpr_write_b32 a81, 0
    v_accvgpr_write_b32 a82, 0
    v_accvgpr_write_b32 a83, 0
    v_accvgpr_write_b32 a84, 0
    v_accvgpr_write_b32 a85, 0
    v_accvgpr_write_b32 a86, 0
    v_accvgpr_write_b32 a87, 0
    v_accvgpr_write_b32 a88, 0
    v_accvgpr_write_b32 a89, 0
    v_accvgpr_write_b32 a90, 0
    v_accvgpr_write_b32 a91, 0
    v_accvgpr_write_b32 a92, 0
    v_accvgpr_write_b32 a93, 0
    v_accvgpr_write_b32 a94, 0
    v_accvgpr_write_b32 a95, 0
    v_accvgpr_write_b32 a96, 0
    v_accvgpr_write_b32 a97, 0
    v_accvgpr_write_b32 a98, 0
    v_accvgpr_write_b32 a99, 0
    v_accvgpr_write_b32 a100, 0
    v_accvgpr_write_b32 a101, 0
    v_accvgpr_write_b32 a102, 0
    v_accvgpr_write_b32 a103, 0
    v_accvgpr_write_b32 a104, 0
    v_accvgpr_write_b32 a105, 0
    v_accvgpr_write_b32 a106, 0
    v_accvgpr_write_b32 a107, 0
    v_accvgpr_write_b32 a108, 0
    v_accvgpr_write_b32 a109, 0
    v_accvgpr_write_b32 a110, 0
    v_accvgpr_write_b32 a111, 0
    v_accvgpr_write_b32 a112, 0
    v_accvgpr_write_b32 a113, 0
    v_accvgpr_write_b32 a114, 0
    v_accvgpr_write_b32 a115, 0
    v_accvgpr_write_b32 a116, 0
    v_accvgpr_write_b32 a117, 0
    v_accvgpr_write_b32 a118, 0
    v_accvgpr_write_b32 a119, 0
    v_accvgpr_write_b32 a120, 0
    v_accvgpr_write_b32 a121, 0
    v_accvgpr_write_b32 a122, 0
    v_accvgpr_write_b32 a123, 0
    v_accvgpr_write_b32 a124, 0
    v_accvgpr_write_b32 a125, 0
    v_accvgpr_write_b32 a126, 0
    v_accvgpr_write_b32 a127, 0
    v_accvgpr_write_b32 a128, 0
    v_accvgpr_write_b32 a129, 0
    v_accvgpr_write_b32 a130, 0
    v_accvgpr_write_b32 a131, 0
    v_accvgpr_write_b32 a132, 0
    v_accvgpr_write_b32 a133, 0
    v_accvgpr_write_b32 a134, 0
    v_accvgpr_write_b32 a135, 0
    v_accvgpr_write_b32 a136, 0
    v_accvgpr_write_b32 a137, 0
    v_accvgpr_write_b32 a138, 0
    v_accvgpr_write_b32 a139, 0
    v_accvgpr_write_b32 a140, 0
    v_accvgpr_write_b32 a141, 0
    v_accvgpr_write_b32 a142, 0
    v_accvgpr_write_b32 a143, 0
    s_mov_b32 s56, 0
at_slow2:
    s_add_u32 s63, s56, 0
    buffer_load_dwordx4 v[64:67], v2, s[20:23], s63 offen sc1
    buffer_load_dwordx4 v[68:71], v2, s[20:23], s63 offen offset:1024 sc1
    buffer_load_dwordx4 v[72:75], v2, s[20:23], s63 offen offset:2048 sc1
    buffer_load_dwordx4 v[76:79], v2, s[20:23], s63 offen offset:3072 sc1
    s_add_u32 s63, s56, 0x1000
    buffer_load_dwordx4 v[80:83], v2, s[20:23], s63 offen sc1
    buffer_load_dwordx4 v[84:87], v2, s[20:23], s63 offen offset:1024 sc1
    buffer_load_dwordx4 v[88:91], v2, s[20:23], s63 offen offset:2048 sc1
    buffer_load_dwordx4 v[92:95], v2, s[20:23], s63 offen offset:3072 sc1
    s_add_u32 s63, s56, 0x2000
    buffer_load_dwordx4 v[128:131], v2, s[20:23], s63 offen sc1
    buffer_load_dwordx4 v[132:135], v2, s[20:23], s63 offen offset:1024 sc1
    buffer_load_dwordx4 v[136:139], v2, s[20:23], s63 offen offset:2048 sc1
    buffer_load_dwordx4 v[140:143], v2, s[20:23], s63 offen offset:3072 sc1
    s_add_u32 s63, s56, 0x3000
    buffer_load_dwordx4 v[144:147], v2, s[20:23], s63 offen sc1
    buffer_load_dwordx4 v[148:151], v2, s[20:23], s63 offen offset:1024 sc1
    buffer_load_dwordx4 v[152:155], v2, s[20:23], s63 offen offset:2048 sc1
    buffer_load_dwordx4 v[156:159], v2, s[20:23], s63 offen offset:3072 sc1
    s_lshr_b32 s63, s56, 8
    buffer_load_dwordx2 v[232:233], v100, s[40:43], s63 offen
    buffer_load_dwordx2 v[236:237], v100, s[44:47], s63 offen
    buffer_load_dwordx2 v[234:235], v100, s[40:43], s63 offen offset:32
    buffer_load_dwordx2 v[238:239], v100, s[44:47], s63 offen offset:32
    s_waitcnt vmcnt(0)
    v_mfma_f32_16x16x32_bf16 v[16:19], v[64:67], a[144:147], 0
    v_mfma_f32_16x16x32_bf16 v[16:19], v[68:71], a[148:151], v[16:19]
    v_mfma_f32_16x16x32_bf16 v[16:19], v[72:75], a[152:155], v[16:19]
    v_mfma_f32_16x16x32_bf16 v[16:19], v[76:79], a[156:159], v[16:19]
    v_mfma_f32_16x16x32_bf16 v[20:23], v[80:83], a[144:147], 0
    v_mfma_f32_16x16x32_bf16 v[20:23], v[84:87], a[148:151], v[20:23]
    v_mfma_f32_16x16x32_bf16 v[20:23], v[88:91], a[152:155], v[20:23]
    v_mfma_f32_16x16x32_bf16 v[20:23], v[92:95], a[156:159], v[20:23]
    v_mfma_f32_16x16x32_bf16 v[24:27], v[64:67], a[160:163], 0
    v_mfma_f32_16x16x32_bf16 v[24:27], v[68:71], a[164:167], v[24:27]
    v_mfma_f32_16x16x32_bf16 v[24:27], v[72:75], a[168:171], v[24:27]
    v_mfma_f32_16x16x32_bf16 v[24:27], v[76:79], a[172:175], v[24:27]
    v_mfma_f32_16x16x32_bf16 v[28:31], v[80:83], a[160:163], 0
    v_mfma_f32_16x16x32_bf16 v[28:31], v[84:87], a[164:167], v[28:31]
    v_mfma_f32_16x16x32_bf16 v[28:31], v[88:91], a[168:171], v[28:31]
    v_mfma_f32_16x16x32_bf16 v[28:31], v[92:95], a[172:175], v[28:31]
    v_mfma_f32_16x16x32_bf16 v[32:35], v[64:67], a[176:179], 0
    v_mfma_f32_16x16x32_bf16 v[32:35], v[68:71], a[180:183], v[32:35]
    v_mfma_f32_16x16x32_bf16 v[32:35], v[72:75], a[184:187], v[32:35]
    v_mfma_f32_16x16x32_bf16 v[32:35], v[76:79], a[188:191], v[32:35]
    v_mfma_f32_16x16x32_bf16 v[36:39], v[80:83], a[176:179], 0
    v_mfma_f32_16x16x32_bf16 v[36:39], v[84:87], a[180:183], v[36:39]
    v_mfma_f32_16x16x32_bf16 v[36:39], v[88:91], a[184:187], v[36:39]
    v_mfma_f32_16x16x32_bf16 v[36:39], v[92:95], a[188:191], v[36:39]
    v_mfma_f32_16x16x32_bf16 v[40:43], v[64:67], a[192:195], 0
    v_mfma_f32_16x16x32_bf16 v[40:43], v[68:71], a[196:199], v[40:43]
    v_mfma_f32_16x16x32_bf16 v[40:43], v[72:75], a[200:203], v[40:43]
    v_mfma_f32_16x16x32_bf16 v[40:43], v[76:79], a[204:207], v[40:43]
    v_mfma_f32_16x16x32_bf16 v[44:47], v[80:83], a[192:195], 0
    v_mfma_f32_16x16x32_bf16 v[44:47], v[84:87], a[196:199], v[44:47]
    v_mfma_f32_16x16x32_bf16 v[44:47], v[88:91], a[200:203], v[44:47]
    v_mfma_f32_16x16x32_bf16 v[44:47], v[92:95], a[204:207], v[44:47]
    v_lshlrev_b32_e32 v240, 16, v232
    v_lshlrev_b32_e32 v248, 16, v236
    v_and_b32_e32 v241, 0xffff0000, v232
    v_and_b32_e32 v249, 0xffff0000, v236
    v_lshlrev_b32_e32 v242, 16, v233
    v_lshlrev_b32_e32 v250, 16, v237
    v_and_b32_e32 v243, 0xffff0000, v233
    v_and_b32_e32 v251, 0xffff0000, v237
    v_lshlrev_b32_e32 v244, 16, v234
    v_lshlrev_b32_e32 v252, 16, v238
    v_and_b32_e32 v245, 0xffff0000, v234
    v_and_b32_e32 v253, 0xffff0000, v238
    v_lshlrev_b32_e32 v246, 16, v235
    v_lshlrev_b32_e32 v254, 16, v239
    v_and_b32_e32 v247, 0xffff0000, v235
    v_and_b32_e32 v255, 0xffff0000, v239
    v_mul_f32_e64 v248, -v240, v248
    v_mul_f32_e64 v249, -v241, v249
    v_mul_f32_e64 v250, -v242, v250
    v_mul_f32_e64 v251, -v243, v251
    v_mul_f32_e64 v252, -v244, v252
    v_mul_f32_e64 v253, -v245, v253
    v_mul_f32_e64 v254, -v246, v254
    v_mul_f32_e64 v255, -v247, v255
    v_lshlrev_b32_e32 v102, 16, v128
    v_and_b32_e32 v103, 0xffff0000, v128
    v_fma_f32 v102, v102, v240, v248
    v_fma_f32 v103, v103, v241, v249
    v_cvt_pk_bf16_f32 v128, v102, v103
    v_lshlrev_b32_e32 v102, 16, v129
    v_and_b32_e32 v103, 0xffff0000, v129
    v_fma_f32 v102, v102, v242, v250
    v_fma_f32 v103, v103, v243, v251
    v_cvt_pk_bf16_f32 v129, v102, v103
    v_lshlrev_b32_e32 v102, 16, v130
    v_and_b32_e32 v103, 0xffff0000, v130
    v_fma_f32 v102, v102, v244, v252
    v_fma_f32 v103, v103, v245, v253
    v_cvt_pk_bf16_f32 v130, v102, v103
    v_lshlrev_b32_e32 v102, 16, v131
    v_and_b32_e32 v103, 0xffff0000, v131
    v_fma_f32 v102, v102, v246, v254
    v_fma_f32 v103, v103, v247, v255
    v_cvt_pk_bf16_f32 v131, v102, v103
    v_lshlrev_b32_e32 v102, 16, v132
    v_and_b32_e32 v103, 0xffff0000, v132
    v_fma_f32 v102, v102, v240, v248
    v_fma_f32 v103, v103, v241, v249
    v_cvt_pk_bf16_f32 v132, v102, v103
    v_lshlrev_b32_e32 v102, 16, v133
    v_and_b32_e32 v103, 0xffff0000, v133
    v_fma_f32 v102, v102, v242, v250
    v_fma_f32 v103, v103, v243, v251
    v_cvt_pk_bf16_f32 v133, v102, v103
    v_lshlrev_b32_e32 v102, 16, v134
    v_and_b32_e32 v103, 0xffff0000, v134
    v_fma_f32 v102, v102, v244, v252
    v_fma_f32 v103, v103, v245, v253
    v_cvt_pk_bf16_f32 v134, v102, v103
    v_lshlrev_b32_e32 v102, 16, v135
    v_and_b32_e32 v103, 0xffff0000, v135
    v_fma_f32 v102, v102, v246, v254
    v_fma_f32 v103, v103, v247, v255
    v_cvt_pk_bf16_f32 v135, v102, v103
    v_lshlrev_b32_e32 v102, 16, v136
    v_and_b32_e32 v103, 0xffff0000, v136
    v_fma_f32 v102, v102, v240, v248
    v_fma_f32 v103, v103, v241, v249
    v_cvt_pk_bf16_f32 v136, v102, v103
    v_lshlrev_b32_e32 v102, 16, v137
    v_and_b32_e32 v103, 0xffff0000, v137
    v_fma_f32 v102, v102, v242, v250
    v_fma_f32 v103, v103, v243, v251
    v_cvt_pk_bf16_f32 v137, v102, v103
    v_lshlrev_b32_e32 v102, 16, v138
    v_and_b32_e32 v103, 0xffff0000, v138
    v_fma_f32 v102, v102, v244, v252
    v_fma_f32 v103, v103, v245, v253
    v_cvt_pk_bf16_f32 v138, v102, v103
    v_lshlrev_b32_e32 v102, 16, v139
    v_and_b32_e32 v103, 0xffff0000, v139
    v_fma_f32 v102, v102, v246, v254
    v_fma_f32 v103, v103, v247, v255
    v_cvt_pk_bf16_f32 v139, v102, v103
    v_lshlrev_b32_e32 v102, 16, v140
    v_and_b32_e32 v103, 0xffff0000, v140
    v_fma_f32 v102, v102, v240, v248
    v_fma_f32 v103, v103, v241, v249
    v_cvt_pk_bf16_f32 v140, v102, v103
    v_lshlrev_b32_e32 v102, 16, v141
    v_and_b32_e32 v103, 0xffff0000, v141
    v_fma_f32 v102, v102, v242, v250
    v_fma_f32 v103, v103, v243, v251
    v_cvt_pk_bf16_f32 v141, v102, v103
    v_lshlrev_b32_e32 v102, 16, v142
    v_and_b32_e32 v103, 0xffff0000, v142
    v_fma_f32 v102, v102, v244, v252
    v_fma_f32 v103, v103, v245, v253
    v_cvt_pk_bf16_f32 v142, v102, v103
    v_lshlrev_b32_e32 v102, 16, v143
    v_and_b32_e32 v103, 0xffff0000, v143
    v_fma_f32 v102, v102, v246, v254
    v_fma_f32 v103, v103, v247, v255
    v_cvt_pk_bf16_f32 v143, v102, v103
    v_lshlrev_b32_e32 v102, 16, v144
    v_and_b32_e32 v103, 0xffff0000, v144
    v_fma_f32 v102, v102, v240, v248
    v_fma_f32 v103, v103, v241, v249
    v_cvt_pk_bf16_f32 v144, v102, v103
    v_lshlrev_b32_e32 v102, 16, v145
    v_and_b32_e32 v103, 0xffff0000, v145
    v_fma_f32 v102, v102, v242, v250
    v_fma_f32 v103, v103, v243, v251
    v_cvt_pk_bf16_f32 v145, v102, v103
    v_lshlrev_b32_e32 v102, 16, v146
    v_and_b32_e32 v103, 0xffff0000, v146
    v_fma_f32 v102, v102, v244, v252
    v_fma_f32 v103, v103, v245, v253
    v_cvt_pk_bf16_f32 v146, v102, v103
    v_lshlrev_b32_e32 v102, 16, v147
    v_and_b32_e32 v103, 0xffff0000, v147
    v_fma_f32 v102, v102, v246, v254
    v_fma_f32 v103, v103, v247, v255
    v_cvt_pk_bf16_f32 v147, v102, v103
    v_lshlrev_b32_e32 v102, 16, v148
    v_and_b32_e32 v103, 0xffff0000, v148
    v_fma_f32 v102, v102, v240, v248
    v_fma_f32 v103, v103, v241, v249
    v_cvt_pk_bf16_f32 v148, v102, v103
    v_lshlrev_b32_e32 v102, 16, v149
    v_and_b32_e32 v103, 0xffff0000, v149
    v_fma_f32 v102, v102, v242, v250
    v_fma_f32 v103, v103, v243, v251
    v_cvt_pk_bf16_f32 v149, v102, v103
    v_lshlrev_b32_e32 v102, 16, v150
    v_and_b32_e32 v103, 0xffff0000, v150
    v_fma_f32 v102, v102, v244, v252
    v_fma_f32 v103, v103, v245, v253
    v_cvt_pk_bf16_f32 v150, v102, v103
    v_lshlrev_b32_e32 v102, 16, v151
    v_and_b32_e32 v103, 0xffff0000, v151
    v_fma_f32 v102, v102, v246, v254
    v_fma_f32 v103, v103, v247, v255
    v_cvt_pk_bf16_f32 v151, v102, v103
    v_lshlrev_b32_e32 v102, 16, v152
    v_and_b32_e32 v103, 0xffff0000, v152
    v_fma_f32 v102, v102, v240, v248
    v_fma_f32 v103, v103, v241, v249
    v_cvt_pk_bf16_f32 v152, v102, v103
    v_lshlrev_b32_e32 v102, 16, v153
    v_and_b32_e32 v103, 0xffff0000, v153
    v_fma_f32 v102, v102, v242, v250
    v_fma_f32 v103, v103, v243, v251
    v_cvt_pk_bf16_f32 v153, v102, v103
    v_lshlrev_b32_e32 v102, 16, v154
    v_and_b32_e32 v103, 0xffff0000, v154
    v_fma_f32 v102, v102, v244, v252
    v_fma_f32 v103, v103, v245, v253
    v_cvt_pk_bf16_f32 v154, v102, v103
    v_lshlrev_b32_e32 v102, 16, v155
    v_and_b32_e32 v103, 0xffff0000, v155
    v_fma_f32 v102, v102, v246, v254
    v_fma_f32 v103, v103, v247, v255
    v_cvt_pk_bf16_f32 v155, v102, v103
    v_lshlrev_b32_e32 v102, 16, v156
    v_and_b32_e32 v103, 0xffff0000, v156
    v_fma_f32 v102, v102, v240, v248
    v_fma_f32 v103, v103, v241, v249
    v_cvt_pk_bf16_f32 v156, v102, v103
    v_lshlrev_b32_e32 v102, 16, v157
    v_and_b32_e32 v103, 0xffff0000, v157
    v_fma_f32 v102, v102, v242, v250
    v_fma_f32 v103, v103, v243, v251
    v_cvt_pk_bf16_f32 v157, v102, v103
    v_lshlrev_b32_e32 v102, 16, v158
    v_and_b32_e32 v103, 0xffff0000, v158
    v_fma_f32 v102, v102, v244, v252
    v_fma_f32 v103, v103, v245, v253
    v_cvt_pk_bf16_f32 v158, v102, v103
    v_lshlrev_b32_e32 v102, 16, v159
    v_and_b32_e32 v103, 0xffff0000, v159
    v_fma_f32 v102, v102, v246, v254
    v_fma_f32 v103, v103, v247, v255
    v_cvt_pk_bf16_f32 v159, v102, v103
    v_sub_f32_e32 v16, v16, v96
    v_sub_f32_e32 v17, v17, v96
    v_sub_f32_e32 v18, v18, v96
    v_sub_f32_e32 v19, v19, v96
    v_sub_f32_e32 v20, v20, v96
    v_sub_f32_e32 v21, v21, v96
    v_sub_f32_e32 v22, v22, v96
    v_sub_f32_e32 v23, v23, v96
    v_exp_f32_e32 v16, v16
    v_exp_f32_e32 v17, v17
    v_exp_f32_e32 v18, v18
    v_exp_f32_e32 v19, v19
    v_exp_f32_e32 v20, v20
    v_exp_f32_e32 v21, v21
    v_exp_f32_e32 v22, v22
    v_exp_f32_e32 v23, v23
    s_nop 0
    v_cvt_pk_bf16_f32 v48, v16, v17
    v_cvt_pk_bf16_f32 v49, v18, v19
    v_cvt_pk_bf16_f32 v50, v20, v21
    v_cvt_pk_bf16_f32 v51, v22, v23
    v_sub_f32_e32 v24, v24, v97
    v_sub_f32_e32 v25, v25, v97
    v_sub_f32_e32 v26, v26, v97
    v_sub_f32_e32 v27, v27, v97
    v_sub_f32_e32 v28, v28, v97
    v_sub_f32_e32 v29, v29, v97
    v_sub_f32_e32 v30, v30, v97
    v_sub_f32_e32 v31, v31, v97
    v_exp_f32_e32 v24, v24
    v_exp_f32_e32 v25, v25
    v_exp_f32_e32 v26, v26
    v_exp_f32_e32 v27, v27
    v_exp_f32_e32 v28, v28
    v_exp_f32_e32 v29, v29
    v_exp_f32_e32 v30, v30
    v_exp_f32_e32 v31, v31
    s_nop 0
    v_cvt_pk_bf16_f32 v52, v24, v25
    v_cvt_pk_bf16_f32 v53, v26, v27
    v_cvt_pk_bf16_f32 v54, v28, v29
    v_cvt_pk_bf16_f32 v55, v30, v31
    v_sub_f32_e32 v32, v32, v98
    v_sub_f32_e32 v33, v33, v98
    v_sub_f32_e32 v34, v34, v98
    v_sub_f32_e32 v35, v35, v98
    v_sub_f32_e32 v36, v36, v98
    v_sub_f32_e32 v37, v37, v98
    v_sub_f32_e32 v38, v38, v98
    v_sub_f32_e32 v39, v39, v98
    v_exp_f32_e32 v32, v32
    v_exp_f32_e32 v33, v33
    v_exp_f32_e32 v34, v34
    v_exp_f32_e32 v35, v35
    v_exp_f32_e32 v36, v36
    v_exp_f32_e32 v37, v37
    v_exp_f32_e32 v38, v38
    v_exp_f32_e32 v39, v39
    s_nop 0
    v_cvt_pk_bf16_f32 v56, v32, v33
    v_cvt_pk_bf16_f32 v57, v34, v35
    v_cvt_pk_bf16_f32 v58, v36, v37
    v_cvt_pk_bf16_f32 v59, v38, v39
    v_sub_f32_e32 v40, v40, v99
    v_sub_f32_e32 v41, v41, v99
    v_sub_f32_e32 v42, v42, v99
    v_sub_f32_e32 v43, v43, v99
    v_sub_f32_e32 v44, v44, v99
    v_sub_f32_e32 v45, v45, v99
    v_sub_f32_e32 v46, v46, v99
    v_sub_f32_e32 v47, v47, v99
    v_exp_f32_e32 v40, v40
    v_exp_f32_e32 v41, v41
    v_exp_f32_e32 v42, v42
    v_exp_f32_e32 v43, v43
    v_exp_f32_e32 v44, v44
    v_exp_f32_e32 v45, v45
    v_exp_f32_e32 v46, v46
    v_exp_f32_e32 v47, v47
    s_nop 0
    v_cvt_pk_bf16_f32 v60, v40, v41
    v_cvt_pk_bf16_f32 v61, v42, v43
    v_cvt_pk_bf16_f32 v62, v44, v45
    v_cvt_pk_bf16_f32 v63, v46, v47
    s_nop 1
    v_mfma_f32_16x16x32_bf16 a[0:3], v[48:51], v[128:131], a[0:3]
    v_mfma_f32_16x16x32_bf16 a[4:7], v[48:51], v[132:135], a[4:7]
    v_mfma_f32_16x16x32_bf16 a[8:11], v[48:51], v[136:139], a[8:11]
    v_mfma_f32_16x16x32_bf16 a[12:15], v[48:51], v[140:143], a[12:15]
    v_mfma_f32_16x16x32_bf16 a[16:19], v[48:51], v[144:147], a[16:19]
    v_mfma_f32_16x16x32_bf16 a[20:23], v[48:51], v[148:151], a[20:23]
    v_mfma_f32_16x16x32_bf16 a[24:27], v[48:51], v[152:155], a[24:27]
    v_mfma_f32_16x16x32_bf16 a[28:31], v[48:51], v[156:159], a[28:31]
    v_mfma_f32_16x16x32_bf16 a[128:131], v[48:51], a[240:243], a[128:131]
    v_mfma_f32_16x16x32_bf16 a[32:35], v[52:55], v[128:131], a[32:35]
    v_mfma_f32_16x16x32_bf16 a[36:39], v[52:55], v[132:135], a[36:39]
    v_mfma_f32_16x16x32_bf16 a[40:43], v[52:55], v[136:139], a[40:43]
    v_mfma_f32_16x16x32_bf16 a[44:47], v[52:55], v[140:143], a[44:47]
    v_mfma_f32_16x16x32_bf16 a[48:51], v[52:55], v[144:147], a[48:51]
    v_mfma_f32_16x16x32_bf16 a[52:55], v[52:55], v[148:151], a[52:55]
    v_mfma_f32_16x16x32_bf16 a[56:59], v[52:55], v[152:155], a[56:59]
    v_mfma_f32_16x16x32_bf16 a[60:63], v[52:55], v[156:159], a[60:63]
    v_mfma_f32_16x16x32_bf16 a[132:135], v[52:55], a[240:243], a[132:135]
    v_mfma_f32_16x16x32_bf16 a[64:67], v[56:59], v[128:131], a[64:67]
    v_mfma_f32_16x16x32_bf16 a[68:71], v[56:59], v[132:135], a[68:71]
    v_mfma_f32_16x16x32_bf16 a[72:75], v[56:59], v[136:139], a[72:75]
    v_mfma_f32_16x16x32_bf16 a[76:79], v[56:59], v[140:143], a[76:79]
    v_mfma_f32_16x16x32_bf16 a[80:83], v[56:59], v[144:147], a[80:83]
    v_mfma_f32_16x16x32_bf16 a[84:87], v[56:59], v[148:151], a[84:87]
    v_mfma_f32_16x16x32_bf16 a[88:91], v[56:59], v[152:155], a[88:91]
    v_mfma_f32_16x16x32_bf16 a[92:95], v[56:59], v[156:159], a[92:95]
    v_mfma_f32_16x16x32_bf16 a[136:139], v[56:59], a[240:243], a[136:139]
    v_mfma_f32_16x16x32_bf16 a[96:99], v[60:63], v[128:131], a[96:99]
    v_mfma_f32_16x16x32_bf16 a[100:103], v[60:63], v[132:135], a[100:103]
    v_mfma_f32_16x16x32_bf16 a[104:107], v[60:63], v[136:139], a[104:107]
    v_mfma_f32_16x16x32_bf16 a[108:111], v[60:63], v[140:143], a[108:111]
    v_mfma_f32_16x16x32_bf16 a[112:115], v[60:63], v[144:147], a[112:115]
    v_mfma_f32_16x16x32_bf16 a[116:119], v[60:63], v[148:151], a[116:119]
    v_mfma_f32_16x16x32_bf16 a[120:123], v[60:63], v[152:155], a[120:123]
    v_mfma_f32_16x16x32_bf16 a[124:127], v[60:63], v[156:159], a[124:127]
    v_mfma_f32_16x16x32_bf16 a[140:143], v[60:63], a[240:243], a[140:143]
    s_nop 15
    s_add_u32 s56, s56, 0x4000
    s_cmp_lt_u32 s56, 0x100000
    s_cbranch_scc1 at_slow2
    v_accvgpr_read_b32 v160, a128
    v_accvgpr_read_b32 v161, a129
    v_accvgpr_read_b32 v162, a130
    v_accvgpr_read_b32 v163, a131
    s_nop 1
    v_mov_b32_dpp v64, v160 row_newbcast:0 row_mask:0xf bank_mask:0xf
    v_mov_b32_dpp v65, v161 row_newbcast:0 row_mask:0xf bank_mask:0xf
    v_mov_b32_dpp v66, v162 row_newbcast:0 row_mask:0xf bank_mask:0xf
    v_mov_b32_dpp v67, v163 row_newbcast:0 row_mask:0xf bank_mask:0xf
    v_accvgpr_read_b32 v160, a132
    v_accvgpr_read_b32 v161, a133
    v_accvgpr_read_b32 v162, a134
    v_accvgpr_read_b32 v163, a135
    s_nop 1
    v_mov_b32_dpp v68, v160 row_newbcast:0 row_mask:0xf bank_mask:0xf
    v_mov_b32_dpp v69, v161 row_newbcast:0 row_mask:0xf bank_mask:0xf
    v_mov_b32_dpp v70, v162 row_newbcast:0 row_mask:0xf bank_mask:0xf
    v_mov_b32_dpp v71, v163 row_newbcast:0 row_mask:0xf bank_mask:0xf
    v_accvgpr_read_b32 v160, a136
    v_accvgpr_read_b32 v161, a137
    v_accvgpr_read_b32 v162, a138
    v_accvgpr_read_b32 v163, a139
    s_nop 1
    v_mov_b32_dpp v72, v160 row_newbcast:0 row_mask:0xf bank_mask:0xf
    v_mov_b32_dpp v73, v161 row_newbcast:0 row_mask:0xf bank_mask:0xf
    v_mov_b32_dpp v74, v162 row_newbcast:0 row_mask:0xf bank_mask:0xf
    v_mov_b32_dpp v75, v163 row_newbcast:0 row_mask:0xf bank_mask:0xf
    v_accvgpr_read_b32 v160, a140
    v_accvgpr_read_b32 v161, a141
    v_accvgpr_read_b32 v162, a142
    v_accvgpr_read_b32 v163, a143
    s_nop 1
    v_mov_b32_dpp v76, v160 row_newbcast:0 row_mask:0xf bank_mask:0xf
    v_mov_b32_dpp v77, v161 row_newbcast:0 row_mask:0xf bank_mask:0xf
    v_mov_b32_dpp v78, v162 row_newbcast:0 row_mask:0xf bank_mask:0xf
    v_mov_b32_dpp v79, v163 row_newbcast:0 row_mask:0xf bank_mask:0xf
    s_nop 1
    s_add_u32 s63, s86, 0
    v_rcp_f32_e32 v64, v64
    v_rcp_f32_e32 v65, v65
    v_rcp_f32_e32 v66, v66
    v_rcp_f32_e32 v67, v67
    v_accvgpr_read_b32 v96, a0
    v_accvgpr_read_b32 v97, a4
    v_accvgpr_read_b32 v98, a8
    v_accvgpr_read_b32 v99, a12
    v_accvgpr_read_b32 v100, a16
    v_accvgpr_read_b32 v101, a20
    v_accvgpr_read_b32 v102, a24
    v_accvgpr_read_b32 v103, a28
    v_pk_mul_f32 v[96:97], v[96:97], v[64:65] op_sel:[0,0] op_sel_hi:[1,0]
    v_pk_mul_f32 v[98:99], v[98:99], v[64:65] op_sel:[0,0] op_sel_hi:[1,0]
    v_pk_mul_f32 v[100:101], v[100:101], v[64:65] op_sel:[0,0] op_sel_hi:[1,0]
    v_pk_mul_f32 v[102:103], v[102:103], v[64:65] op_sel:[0,0] op_sel_hi:[1,0]
    v_cvt_pk_bf16_f32 v104, v96, v97
    v_cvt_pk_bf16_f32 v105, v98, v99
    v_cvt_pk_bf16_f32 v106, v100, v101
    v_cvt_pk_bf16_f32 v107, v102, v103
    buffer_store_dwordx4 v[104:107], v5, s[16:19], s63 offen sc1
    v_accvgpr_read_b32 v108, a1
    v_accvgpr_read_b32 v109, a5
    v_accvgpr_read_b32 v110, a9
    v_accvgpr_read_b32 v111, a13
    v_accvgpr_read_b32 v112, a17
    v_accvgpr_read_b32 v113, a21
    v_accvgpr_read_b32 v114, a25
    v_accvgpr_read_b32 v115, a29
    v_pk_mul_f32 v[108:109], v[108:109], v[64:65] op_sel:[0,1] op_sel_hi:[1,1]
    v_pk_mul_f32 v[110:111], v[110:111], v[64:65] op_sel:[0,1] op_sel_hi:[1,1]
    v_pk_mul_f32 v[112:113], v[112:113], v[64:65] op_sel:[0,1] op_sel_hi:[1,1]
    v_pk_mul_f32 v[114:115], v[114:115], v[64:65] op_sel:[0,1] op_sel_hi:[1,1]
    v_cvt_pk_bf16_f32 v116, v108, v109
    v_cvt_pk_bf16_f32 v117, v110, v111
    v_cvt_pk_bf16_f32 v118, v112, v113
    v_cvt_pk_bf16_f32 v119, v114, v115
    buffer_store_dwordx4 v[116:119], v5, s[16:19], s63 offen offset:256 sc1
    v_accvgpr_read_b32 v120, a2
    v_accvgpr_read_b32 v121, a6
    v_accvgpr_read_b32 v122, a10
    v_accvgpr_read_b32 v123, a14
    v_accvgpr_read_b32 v124, a18
    v_accvgpr_read_b32 v125, a22
    v_accvgpr_read_b32 v126, a26
    v_accvgpr_read_b32 v127, a30
    v_pk_mul_f32 v[120:121], v[120:121], v[66:67] op_sel:[0,0] op_sel_hi:[1,0]
    v_pk_mul_f32 v[122:123], v[122:123], v[66:67] op_sel:[0,0] op_sel_hi:[1,0]
    v_pk_mul_f32 v[124:125], v[124:125], v[66:67] op_sel:[0,0] op_sel_hi:[1,0]
    v_pk_mul_f32 v[126:127], v[126:127], v[66:67] op_sel:[0,0] op_sel_hi:[1,0]
    v_cvt_pk_bf16_f32 v128, v120, v121
    v_cvt_pk_bf16_f32 v129, v122, v123
    v_cvt_pk_bf16_f32 v130, v124, v125
    v_cvt_pk_bf16_f32 v131, v126, v127
    buffer_store_dwordx4 v[128:131], v5, s[16:19], s63 offen offset:512 sc1
    v_accvgpr_read_b32 v132, a3
    v_accvgpr_read_b32 v133, a7
    v_accvgpr_read_b32 v134, a11
    v_accvgpr_read_b32 v135, a15
    v_accvgpr_read_b32 v136, a19
    v_accvgpr_read_b32 v137, a23
    v_accvgpr_read_b32 v138, a27
    v_accvgpr_read_b32 v139, a31
    v_pk_mul_f32 v[132:133], v[132:133], v[66:67] op_sel:[0,1] op_sel_hi:[1,1]
    v_pk_mul_f32 v[134:135], v[134:135], v[66:67] op_sel:[0,1] op_sel_hi:[1,1]
    v_pk_mul_f32 v[136:137], v[136:137], v[66:67] op_sel:[0,1] op_sel_hi:[1,1]
    v_pk_mul_f32 v[138:139], v[138:139], v[66:67] op_sel:[0,1] op_sel_hi:[1,1]
    v_cvt_pk_bf16_f32 v140, v132, v133
    v_cvt_pk_bf16_f32 v141, v134, v135
    v_cvt_pk_bf16_f32 v142, v136, v137
    v_cvt_pk_bf16_f32 v143, v138, v139
    buffer_store_dwordx4 v[140:143], v5, s[16:19], s63 offen offset:768 sc1
    s_add_u32 s63, s86, 0x1000
    v_rcp_f32_e32 v68, v68
    v_rcp_f32_e32 v69, v69
    v_rcp_f32_e32 v70, v70
    v_rcp_f32_e32 v71, v71
    v_accvgpr_read_b32 v144, a32
    v_accvgpr_read_b32 v145, a36
    v_accvgpr_read_b32 v146, a40
    v_accvgpr_read_b32 v147, a44
    v_accvgpr_read_b32 v148, a48
    v_accvgpr_read_b32 v149, a52
    v_accvgpr_read_b32 v150, a56
    v_accvgpr_read_b32 v151, a60
    v_pk_mul_f32 v[144:145], v[144:145], v[68:69] op_sel:[0,0] op_sel_hi:[1,0]
    v_pk_mul_f32 v[146:147], v[146:147], v[68:69] op_sel:[0,0] op_sel_hi:[1,0]
    v_pk_mul_f32 v[148:149], v[148:149], v[68:69] op_sel:[0,0] op_sel_hi:[1,0]
    v_pk_mul_f32 v[150:151], v[150:151], v[68:69] op_sel:[0,0] op_sel_hi:[1,0]
    v_cvt_pk_bf16_f32 v152, v144, v145
    v_cvt_pk_bf16_f32 v153, v146, v147
    v_cvt_pk_bf16_f32 v154, v148, v149
    v_cvt_pk_bf16_f32 v155, v150, v151
    buffer_store_dwordx4 v[152:155], v5, s[16:19], s63 offen sc1
    v_accvgpr_read_b32 v96, a33
    v_accvgpr_read_b32 v97, a37
    v_accvgpr_read_b32 v98, a41
    v_accvgpr_read_b32 v99, a45
    v_accvgpr_read_b32 v100, a49
    v_accvgpr_read_b32 v101, a53
    v_accvgpr_read_b32 v102, a57
    v_accvgpr_read_b32 v103, a61
    v_pk_mul_f32 v[96:97], v[96:97], v[68:69] op_sel:[0,1] op_sel_hi:[1,1]
    v_pk_mul_f32 v[98:99], v[98:99], v[68:69] op_sel:[0,1] op_sel_hi:[1,1]
    v_pk_mul_f32 v[100:101], v[100:101], v[68:69] op_sel:[0,1] op_sel_hi:[1,1]
    v_pk_mul_f32 v[102:103], v[102:103], v[68:69] op_sel:[0,1] op_sel_hi:[1,1]
    v_cvt_pk_bf16_f32 v104, v96, v97
    v_cvt_pk_bf16_f32 v105, v98, v99
    v_cvt_pk_bf16_f32 v106, v100, v101
    v_cvt_pk_bf16_f32 v107, v102, v103
    buffer_store_dwordx4 v[104:107], v5, s[16:19], s63 offen offset:256 sc1
    v_accvgpr_read_b32 v108, a34
    v_accvgpr_read_b32 v109, a38
    v_accvgpr_read_b32 v110, a42
    v_accvgpr_read_b32 v111, a46
    v_accvgpr_read_b32 v112, a50
    v_accvgpr_read_b32 v113, a54
    v_accvgpr_read_b32 v114, a58
    v_accvgpr_read_b32 v115, a62
    v_pk_mul_f32 v[108:109], v[108:109], v[70:71] op_sel:[0,0] op_sel_hi:[1,0]
    v_pk_mul_f32 v[110:111], v[110:111], v[70:71] op_sel:[0,0] op_sel_hi:[1,0]
    v_pk_mul_f32 v[112:113], v[112:113], v[70:71] op_sel:[0,0] op_sel_hi:[1,0]
    v_pk_mul_f32 v[114:115], v[114:115], v[70:71] op_sel:[0,0] op_sel_hi:[1,0]
    v_cvt_pk_bf16_f32 v116, v108, v109
    v_cvt_pk_bf16_f32 v117, v110, v111
    v_cvt_pk_bf16_f32 v118, v112, v113
    v_cvt_pk_bf16_f32 v119, v114, v115
    buffer_store_dwordx4 v[116:119], v5, s[16:19], s63 offen offset:512 sc1
    v_accvgpr_read_b32 v120, a35
    v_accvgpr_read_b32 v121, a39
    v_accvgpr_read_b32 v122, a43
    v_accvgpr_read_b32 v123, a47
    v_accvgpr_read_b32 v124, a51
    v_accvgpr_read_b32 v125, a55
    v_accvgpr_read_b32 v126, a59
    v_accvgpr_read_b32 v127, a63
    v_pk_mul_f32 v[120:121], v[120:121], v[70:71] op_sel:[0,1] op_sel_hi:[1,1]
    v_pk_mul_f32 v[122:123], v[122:123], v[70:71] op_sel:[0,1] op_sel_hi:[1,1]
    v_pk_mul_f32 v[124:125], v[124:125], v[70:71] op_sel:[0,1] op_sel_hi:[1,1]
    v_pk_mul_f32 v[126:127], v[126:127], v[70:71] op_sel:[0,1] op_sel_hi:[1,1]
    v_cvt_pk_bf16_f32 v128, v120, v121
    v_cvt_pk_bf16_f32 v129, v122, v123
    v_cvt_pk_bf16_f32 v130, v124, v125
    v_cvt_pk_bf16_f32 v131, v126, v127
    buffer_store_dwordx4 v[128:131], v5, s[16:19], s63 offen offset:768 sc1
    s_add_u32 s63, s86, 0x2000
    v_rcp_f32_e32 v72, v72
    v_rcp_f32_e32 v73, v73
    v_rcp_f32_e32 v74, v74
    v_rcp_f32_e32 v75, v75
    v_accvgpr_read_b32 v132, a64
    v_accvgpr_read_b32 v133, a68
    v_accvgpr_read_b32 v134, a72
    v_accvgpr_read_b32 v135, a76
    v_accvgpr_read_b32 v136, a80
    v_accvgpr_read_b32 v137, a84
    v_accvgpr_read_b32 v138, a88
    v_accvgpr_read_b32 v139, a92
    v_pk_mul_f32 v[132:133], v[132:133], v[72:73] op_sel:[0,0] op_sel_hi:[1,0]
    v_pk_mul_f32 v[134:135], v[134:135], v[72:73] op_sel:[0,0] op_sel_hi:[1,0]
    v_pk_mul_f32 v[136:137], v[136:137], v[72:73] op_sel:[0,0] op_sel_hi:[1,0]
    v_pk_mul_f32 v[138:139], v[138:139], v[72:73] op_sel:[0,0] op_sel_hi:[1,0]
    v_cvt_pk_bf16_f32 v140, v132, v133
    v_cvt_pk_bf16_f32 v141, v134, v135
    v_cvt_pk_bf16_f32 v142, v136, v137
    v_cvt_pk_bf16_f32 v143, v138, v139
    buffer_store_dwordx4 v[140:143], v5, s[16:19], s63 offen sc1
    v_accvgpr_read_b32 v144, a65
    v_accvgpr_read_b32 v145, a69
    v_accvgpr_read_b32 v146, a73
    v_accvgpr_read_b32 v147, a77
    v_accvgpr_read_b32 v148, a81
    v_accvgpr_read_b32 v149, a85
    v_accvgpr_read_b32 v150, a89
    v_accvgpr_read_b32 v151, a93
    v_pk_mul_f32 v[144:145], v[144:145], v[72:73] op_sel:[0,1] op_sel_hi:[1,1]
    v_pk_mul_f32 v[146:147], v[146:147], v[72:73] op_sel:[0,1] op_sel_hi:[1,1]
    v_pk_mul_f32 v[148:149], v[148:149], v[72:73] op_sel:[0,1] op_sel_hi:[1,1]
    v_pk_mul_f32 v[150:151], v[150:151], v[72:73] op_sel:[0,1] op_sel_hi:[1,1]
    v_cvt_pk_bf16_f32 v152, v144, v145
    v_cvt_pk_bf16_f32 v153, v146, v147
    v_cvt_pk_bf16_f32 v154, v148, v149
    v_cvt_pk_bf16_f32 v155, v150, v151
    buffer_store_dwordx4 v[152:155], v5, s[16:19], s63 offen offset:256 sc1
    v_accvgpr_read_b32 v96, a66
    v_accvgpr_read_b32 v97, a70
    v_accvgpr_read_b32 v98, a74
    v_accvgpr_read_b32 v99, a78
    v_accvgpr_read_b32 v100, a82
    v_accvgpr_read_b32 v101, a86
    v_accvgpr_read_b32 v102, a90
    v_accvgpr_read_b32 v103, a94
    v_pk_mul_f32 v[96:97], v[96:97], v[74:75] op_sel:[0,0] op_sel_hi:[1,0]
    v_pk_mul_f32 v[98:99], v[98:99], v[74:75] op_sel:[0,0] op_sel_hi:[1,0]
    v_pk_mul_f32 v[100:101], v[100:101], v[74:75] op_sel:[0,0] op_sel_hi:[1,0]
    v_pk_mul_f32 v[102:103], v[102:103], v[74:75] op_sel:[0,0] op_sel_hi:[1,0]
    v_cvt_pk_bf16_f32 v104, v96, v97
    v_cvt_pk_bf16_f32 v105, v98, v99
    v_cvt_pk_bf16_f32 v106, v100, v101
    v_cvt_pk_bf16_f32 v107, v102, v103
    buffer_store_dwordx4 v[104:107], v5, s[16:19], s63 offen offset:512 sc1
    v_accvgpr_read_b32 v108, a67
    v_accvgpr_read_b32 v109, a71
    v_accvgpr_read_b32 v110, a75
    v_accvgpr_read_b32 v111, a79
    v_accvgpr_read_b32 v112, a83
    v_accvgpr_read_b32 v113, a87
    v_accvgpr_read_b32 v114, a91
    v_accvgpr_read_b32 v115, a95
    v_pk_mul_f32 v[108:109], v[108:109], v[74:75] op_sel:[0,1] op_sel_hi:[1,1]
    v_pk_mul_f32 v[110:111], v[110:111], v[74:75] op_sel:[0,1] op_sel_hi:[1,1]
    v_pk_mul_f32 v[112:113], v[112:113], v[74:75] op_sel:[0,1] op_sel_hi:[1,1]
    v_pk_mul_f32 v[114:115], v[114:115], v[74:75] op_sel:[0,1] op_sel_hi:[1,1]
    v_cvt_pk_bf16_f32 v116, v108, v109
    v_cvt_pk_bf16_f32 v117, v110, v111
    v_cvt_pk_bf16_f32 v118, v112, v113
    v_cvt_pk_bf16_f32 v119, v114, v115
    buffer_store_dwordx4 v[116:119], v5, s[16:19], s63 offen offset:768 sc1
    s_add_u32 s63, s86, 0x3000
    v_rcp_f32_e32 v76, v76
    v_rcp_f32_e32 v77, v77
    v_rcp_f32_e32 v78, v78
    v_rcp_f32_e32 v79, v79
    v_accvgpr_read_b32 v120, a96
    v_accvgpr_read_b32 v121, a100
    v_accvgpr_read_b32 v122, a104
    v_accvgpr_read_b32 v123, a108
    v_accvgpr_read_b32 v124, a112
    v_accvgpr_read_b32 v125, a116
    v_accvgpr_read_b32 v126, a120
    v_accvgpr_read_b32 v127, a124
    v_pk_mul_f32 v[120:121], v[120:121], v[76:77] op_sel:[0,0] op_sel_hi:[1,0]
    v_pk_mul_f32 v[122:123], v[122:123], v[76:77] op_sel:[0,0] op_sel_hi:[1,0]
    v_pk_mul_f32 v[124:125], v[124:125], v[76:77] op_sel:[0,0] op_sel_hi:[1,0]
    v_pk_mul_f32 v[126:127], v[126:127], v[76:77] op_sel:[0,0] op_sel_hi:[1,0]
    v_cvt_pk_bf16_f32 v128, v120, v121
    v_cvt_pk_bf16_f32 v129, v122, v123
    v_cvt_pk_bf16_f32 v130, v124, v125
    v_cvt_pk_bf16_f32 v131, v126, v127
    buffer_store_dwordx4 v[128:131], v5, s[16:19], s63 offen sc1
    v_accvgpr_read_b32 v132, a97
    v_accvgpr_read_b32 v133, a101
    v_accvgpr_read_b32 v134, a105
    v_accvgpr_read_b32 v135, a109
    v_accvgpr_read_b32 v136, a113
    v_accvgpr_read_b32 v137, a117
    v_accvgpr_read_b32 v138, a121
    v_accvgpr_read_b32 v139, a125
    v_pk_mul_f32 v[132:133], v[132:133], v[76:77] op_sel:[0,1] op_sel_hi:[1,1]
    v_pk_mul_f32 v[134:135], v[134:135], v[76:77] op_sel:[0,1] op_sel_hi:[1,1]
    v_pk_mul_f32 v[136:137], v[136:137], v[76:77] op_sel:[0,1] op_sel_hi:[1,1]
    v_pk_mul_f32 v[138:139], v[138:139], v[76:77] op_sel:[0,1] op_sel_hi:[1,1]
    v_cvt_pk_bf16_f32 v140, v132, v133
    v_cvt_pk_bf16_f32 v141, v134, v135
    v_cvt_pk_bf16_f32 v142, v136, v137
    v_cvt_pk_bf16_f32 v143, v138, v139
    buffer_store_dwordx4 v[140:143], v5, s[16:19], s63 offen offset:256 sc1
    v_accvgpr_read_b32 v144, a98
    v_accvgpr_read_b32 v145, a102
    v_accvgpr_read_b32 v146, a106
    v_accvgpr_read_b32 v147, a110
    v_accvgpr_read_b32 v148, a114
    v_accvgpr_read_b32 v149, a118
    v_accvgpr_read_b32 v150, a122
    v_accvgpr_read_b32 v151, a126
    v_pk_mul_f32 v[144:145], v[144:145], v[78:79] op_sel:[0,0] op_sel_hi:[1,0]
    v_pk_mul_f32 v[146:147], v[146:147], v[78:79] op_sel:[0,0] op_sel_hi:[1,0]
    v_pk_mul_f32 v[148:149], v[148:149], v[78:79] op_sel:[0,0] op_sel_hi:[1,0]
    v_pk_mul_f32 v[150:151], v[150:151], v[78:79] op_sel:[0,0] op_sel_hi:[1,0]
    v_cvt_pk_bf16_f32 v152, v144, v145
    v_cvt_pk_bf16_f32 v153, v146, v147
    v_cvt_pk_bf16_f32 v154, v148, v149
    v_cvt_pk_bf16_f32 v155, v150, v151
    buffer_store_dwordx4 v[152:155], v5, s[16:19], s63 offen offset:512 sc1
    v_accvgpr_read_b32 v96, a99
    v_accvgpr_read_b32 v97, a103
    v_accvgpr_read_b32 v98, a107
    v_accvgpr_read_b32 v99, a111
    v_accvgpr_read_b32 v100, a115
    v_accvgpr_read_b32 v101, a119
    v_accvgpr_read_b32 v102, a123
    v_accvgpr_read_b32 v103, a127
    v_pk_mul_f32 v[96:97], v[96:97], v[78:79] op_sel:[0,1] op_sel_hi:[1,1]
    v_pk_mul_f32 v[98:99], v[98:99], v[78:79] op_sel:[0,1] op_sel_hi:[1,1]
    v_pk_mul_f32 v[100:101], v[100:101], v[78:79] op_sel:[0,1] op_sel_hi:[1,1]
    v_pk_mul_f32 v[102:103], v[102:103], v[78:79] op_sel:[0,1] op_sel_hi:[1,1]
    v_cvt_pk_bf16_f32 v104, v96, v97
    v_cvt_pk_bf16_f32 v105, v98, v99
    v_cvt_pk_bf16_f32 v106, v100, v101
    v_cvt_pk_bf16_f32 v107, v102, v103
    buffer_store_dwordx4 v[104:107], v5, s[16:19], s63 offen offset:768 sc1
at_done:
    s_endpgm
.fill 1024, 4, 0xbf800000
.section .rodata,"a"
.p2align 6
.amdhsa_kernel standalone__kv_cache_quant_int4_int2_kv_with_per_channel_or_per_token_scales__prompt_kernel
  .amdhsa_next_free_vgpr 512
  .amdhsa_next_free_sgpr 102
  .amdhsa_accum_offset 256
  .amdhsa_group_segment_fixed_size 0
  .amdhsa_kernarg_size 80
  .amdhsa_user_sgpr_count 2
  .amdhsa_user_sgpr_kernarg_segment_ptr 1
  .amdhsa_system_sgpr_workgroup_id_x 1
  .amdhsa_float_denorm_mode_32 3
.end_amdhsa_kernel
```
